```python
import torch

def _softmax(x, axis=-1):
    return torch.softmax(x, dim=axis)

def _gelu(x):
    return torch.nn.functional.gelu(x, approximate='tanh')

def _silu(x):
    return torch.nn.functional.silu(x)

def _sigmoid(x):
    return torch.sigmoid(x)

def _layernorm(x, axis=-1, eps=1e-05):
    m = x.mean(dim=axis, keepdim=True)
    v = x.var(dim=axis, keepdim=True, unbiased=False)
    return (x - m) / torch.sqrt(v + eps)

def _scatter_add(tgt, idx, src, axis=0):
    return tgt.clone().index_add_(axis, idx, src)

def _segment_sum(src, seg, n):
    out = torch.zeros((n,) + src.shape[1:], dtype=src.dtype)
    return out.index_add_(0, seg, src)

def _pad(x, pw):
    flat = tuple((v for pair in reversed(pw) for v in pair))
    return torch.nn.functional.pad(x, flat)
kernel_name = 'interleave_layers__spectral_gfnet__memory_aug_recurrent_mem_tr__prompt'

def setup_inputs():

    _w = lambda a: (lambda t: t.to(torch.bfloat16) if t.is_floating_point() else t)(torch.as_tensor(a))

    def _A_setup():
        B, S, D = (1, 2048, 512)
        Df = D // 2 + 1
        return {'x': _w((lambda *s: torch.randn(*s, dtype=torch.bfloat16) * 0.05)(B, S, D)), 'w_r': _w((lambda *s: torch.randn(*s, dtype=torch.bfloat16) * 0.4)(S, Df) * 0.02), 'w_i': _w((lambda *s: torch.randn(*s, dtype=torch.bfloat16) * 0.4)(S, Df) * 0.02)}
    _A_in = _A_setup()

    def _B_setup():
        B, S, Dm = (1, 2048, 512)
        H, Dh = (32, 128)
        M, seg = (8, 32)
        seg = min(seg, S)
        S = S // seg * seg
        return {'x': _w((lambda *s: torch.randn(*s, dtype=torch.bfloat16) * 0.05)(B, S, Dm)), 'mem0': _w((lambda *s: torch.randn(*s, dtype=torch.bfloat16) * 0.2)(B, M, Dm)), 'Wq': _w((lambda *s: torch.randn(*s, dtype=torch.bfloat16) * 1.6)(Dm, H, Dh) * Dm ** (-0.5)), 'Wk': _w((lambda *s: torch.randn(*s, dtype=torch.bfloat16) * 1.6)(Dm, H, Dh) * Dm ** (-0.5)), 'Wv': _w((lambda *s: torch.randn(*s, dtype=torch.bfloat16) * 0.2)(Dm, H, Dh) * Dm ** (-0.5)), 'Wo': _w((lambda *s: torch.randn(*s, dtype=torch.bfloat16) * 0.2)(H, Dh, Dm) * (H * Dh) ** (-0.5)), 'seg_len': seg}
    _B_in = _B_setup()
    return {'A_x': _A_in['x'], 'A_w_r': _A_in['w_r'], 'A_w_i': _A_in['w_i'], 'B_x': _B_in['x'], 'B_mem0': _B_in['mem0'], 'B_Wq': _B_in['Wq'], 'B_Wk': _B_in['Wk'], 'B_Wv': _B_in['Wv'], 'B_Wo': _B_in['Wo'], 'B_seg_len': _B_in['seg_len']}

def reference(A_x, A_w_r, A_w_i, B_x, B_mem0, B_Wq, B_Wk, B_Wv, B_Wo, B_seg_len):

    def _A_ref(x, w_r, w_i):
        B, S, D = x.shape
        X = (lambda x, axes=(-2, -1): torch.fft.rfft2(x.float(), dim=axes))(x, axes=(-2, -1))
        W = w_r + 1j * w_i
        X = X * W
        y = (lambda x, s, axes=(-2, -1): torch.fft.irfft2(x, s=s, dim=axes).to(torch.bfloat16))(X, (S, D), axes=(-2, -1))
        return y

    def _B_ref(x, mem0, Wq, Wk, Wv, Wo, seg_len):
        B, S, Dm = x.shape
        H, Dh = (Wq.shape[1], Wq.shape[2])
        M = mem0.shape[1]
        scale = Dh ** (-0.5)
        n_seg = S // seg_len
        L = M + seg_len
        idx = torch.arange(L)
        mask = (idx[:, None] < M) | (idx[:, None] >= idx[None, :])
        mem = mem0
        outs = []
        for s in range(n_seg):
            xs = x[:, s * seg_len:(s + 1) * seg_len, :].clone()
            h = torch.concatenate([mem, xs], axis=1)
            q = torch.einsum('btd,dhe->bhte', h, Wq)
            k = torch.einsum('btd,dhe->bhte', h, Wk)
            v = torch.einsum('btd,dhe->bhte', h, Wv)
            scores = torch.einsum('bhqe,bhke->bhqk', q, k) * scale
            scores = torch.where(mask[None, None], scores, -1000000000.0)
            p = _softmax(scores, axis=-1)
            o = torch.einsum('bhqk,bhke->bhqe', p, v)
            o = torch.einsum('bhte,hed->btd', o, Wo)
            mem = o[:, :M, :].clone()
            outs.append(o[:, M:, :])
        return torch.concatenate(outs, axis=1)
    x = A_x
    x = x + _A_ref(_layernorm(x, axis=-1), A_w_r, A_w_i)
    x = x + _B_ref(_layernorm(x, axis=-1), B_mem0, B_Wq, B_Wk, B_Wv, B_Wo, B_seg_len)
    x = x + _A_ref(_layernorm(x, axis=-1), A_w_r, A_w_i)
    x = x + _B_ref(_layernorm(x, axis=-1), B_mem0, B_Wq, B_Wk, B_Wv, B_Wo, B_seg_len)
    return x
```

```asm
; @launch grid=(256,1,1) block=(256,1,1) lds=163840
.amdgcn_target "amdgcn-amd-amdhsa--gfx950"
.text
.globl interleave_layers__spectral_gfnet__memory_aug_recurrent_mem_tr__prompt_kernel
.p2align 8
.type interleave_layers__spectral_gfnet__memory_aug_recurrent_mem_tr__prompt_kernel,@function
interleave_layers__spectral_gfnet__memory_aug_recurrent_mem_tr__prompt_kernel:
s_cmp_ge_u32 s2, 256
s_cbranch_scc1 L_end
s_load_dwordx2 s[4:5], s[0:1], 96
s_load_dwordx2 s[6:7], s[0:1], 88
s_getreg_b32 s16, hwreg(HW_REG_XCC_ID)
s_and_b32 s16, s16, 15
v_lshrrev_b32 v1, 6, v0
s_nop 0
v_readfirstlane_b32 s9, v1
v_and_b32 v0, 63, v0
s_mov_b32 s11, 0
s_waitcnt lgkmcnt(0)
s_cmp_eq_u32 s9, 0
s_cbranch_scc0 L_notw0
s_and_b32 s17, s2, 127
s_lshl_b32 s17, s17, 11
s_lshr_b32 s18, s2, 7
s_lshl_b32 s18, s18, 27
s_add_u32 s17, s17, s18
s_add_u32 s17, s17, 1048576
v_lshl_add_u32 v2, v0, 4, s17
v_mov_b32 v3, 0
v_mov_b64 v[8:9], 0
v_mov_b64 v[10:11], 0
global_store_dwordx4 v2, v[8:11], s[4:5] sc1
global_store_dwordx4 v2, v[8:11], s[4:5] offset:1024 sc1
v_mov_b32 v4, 1
s_mov_b64 exec, 1
s_mov_b32 s18, 32
s_cmp_eq_u32 s16, 0
s_cbranch_scc0 L_tick
global_atomic_add v5, v3, v4, s[6:7] sc0
s_waitcnt vmcnt(0)
v_readfirstlane_b32 s18, v5
L_tick:
s_cmp_lt_u32 s18, 32
s_cbranch_scc1 L_role
global_atomic_add v5, v3, v4, s[6:7] offset:64 sc0
s_waitcnt vmcnt(0)
v_readfirstlane_b32 s18, v5
s_sub_u32 s19, 255, s18
s_add_u32 s18, s18, 32
s_cmp_ge_u32 s18, 256
s_cselect_b32 s18, s19, s18
L_role:
v_mov_b32 v5, s18
ds_write_b32 v3, v5
s_mov_b64 exec, -1
s_waitcnt lgkmcnt(0)
L_notw0:
s_barrier
v_mov_b32 v3, 0
ds_read_b32 v5, v3
s_waitcnt lgkmcnt(0)
v_readfirstlane_b32 s8, v5
s_barrier
s_cmp_ge_u32 s8, 256
s_cbranch_scc1 L_end
s_cmp_lt_u32 s8, 32
s_cbranch_scc0 L_worker
v_and_b32 v20, 15, v0
v_lshrrev_b32 v21, 4, v0
v_bfe_u32 v22, v0, 2, 2
v_and_b32 v23, 3, v0
v_lshrrev_b32 v24, 5, v0
v_bfe_u32 v25, v0, 4, 1
v_bfe_u32 v26, v0, 3, 1
v_bfe_u32 v27, v0, 2, 1
v_and_b32 v28, 7, v0
v_bfe_u32 v30, v0, 1, 1
v_mul_u32_u24 v30, 0xAAAA, v30
v_or_b32 v1, 0x4444, v30
v_cmp_gt_u32 s[32:33], 8, v20
s_cmp_eq_u32 s9, 0
s_cselect_b32 s44, 1, 0
s_mov_b32 s45, 0
v_lshlrev_b32 v30, 2, v24
v_lshl_add_u32 v30, v25, 3, v30
v_add_u32 v30, v30, v27
v_lshlrev_b32 v30, 4, v30
v_mul_u32_u24 v31, 288, v26
v_add_u32 v30, v30, v31
v_and_b32 v31, 1, v0
v_lshl_add_u32 v30, v31, 3, v30
v_add_u32 v5, 8192, v30
v_lshlrev_b32 v30, 9, v24
v_lshl_add_u32 v30, v23, 6, v30
v_lshl_add_u32 v30, v25, 5, v30
v_lshl_add_u32 v30, v22, 3, v30
v_add_u32 v6, 12288, v30
s_mul_i32 s36, s9, 576
s_add_u32 s36, s36, 8192
v_lshlrev_b32 v30, 4, v20
v_lshl_add_u32 v30, v21, 2, v30
v_add_u32 v4, s36, v30
s_lshl_b32 s36, s9, 9
v_lshlrev_b32 v30, 8, v26
v_lshl_add_u32 v30, v21, 6, v30
v_lshl_add_u32 v30, v28, 3, v30
v_add_u32 v3, s36, v30
v_lshlrev_b32 v30, 7, v21
v_lshl_add_u32 v30, v28, 4, v30
v_lshl_add_u32 v30, v26, 3, v30
v_add_u32 v7, s36, v30
v_and_b32 v31, 1, v0
v_lshl_add_u32 v31, v22, 1, v31
v_lshlrev_b32 v31, 4, v31
v_lshl_add_u32 v8, v21, 7, v31
v_lshl_add_u32 v31, v21, 8, v31
v_bfe_u32 v30, v0, 1, 1
v_lshl_add_u32 v11, v30, 7, v31
s_lshl_b32 s36, s9, 8
v_lshlrev_b32 v30, 7, v24
v_lshl_add_u32 v30, v28, 4, v30
v_lshl_add_u32 v30, v25, 3, v30
v_add_u32 v12, s36, v30
s_lshl_b32 s36, s9, 3
v_add_u32 v30, s36, v21
v_lshlrev_b32 v30, 13, v30
s_lshl_b32 s36, s8, 8
v_add_u32 v30, s36, v30
v_lshl_add_u32 v9, v20, 4, v30
s_lshl_b32 s31, s9, 11
v_lshlrev_b32 v30, 4, v0
v_add_u32 v10, s31, v30
v_bfe_u32 v30, v0, 1, 2
v_lshlrev_b32 v30, 8, v30
v_and_b32 v31, 1, v0
v_lshl_add_u32 v30, v31, 4, v30
v_lshl_add_u32 v30, v24, 5, v30
v_lshl_add_u32 v30, v25, 3, v30
s_lshr_b32 s36, s8, 2
s_lshl_b32 s36, s36, 10
s_and_b32 s37, s8, 3
s_lshl_b32 s37, s37, 6
s_add_u32 s36, s36, s37
v_add_u32 v14, s36, v30
s_lshl_b32 s36, s9, 10
v_lshlrev_b32 v30, 4, v0
v_add_u32 v15, s36, v30
s_xor_b32 s46, s31, 0x800
s_xor_b32 s47, s31, 0x1000
s_xor_b32 s48, s31, 0x1800
v_lshlrev_b32 v30, 4, v24
v_lshl_add_u32 v30, v25, 2, v30
v_lshl_add_u32 v30, v26, 3, v30
v_add_u32 v30, v30, v27
v_lshlrev_b32 v30, 6, v30
v_lshl_add_u32 v36, v23, 3, v30
v_lshlrev_b32 v30, 4, v25
v_lshl_add_u32 v30, v24, 2, v30
v_add_u32 v30, v30, v27
v_lshlrev_b32 v30, 6, v30
v_lshl_add_u32 v30, v26, 5, v30
v_lshl_add_u32 v37, v23, 3, v30
v_lshrrev_b32 v30, 2, v0
v_lshlrev_b32 v31, 13, v30
v_lshl_add_u32 v32, v23, 4, v31
v_lshlrev_b32 v31, 10, v30
v_lshl_add_u32 v33, v23, 4, v31
v_and_b32 v30, 1, v0
v_lshlrev_b32 v30, 4, v30
v_mov_b32 v31, 0x3f80
v_lshlrev_b32 v31, v30, v31
v_bfe_u32 v30, v0, 1, 2
v_cmp_eq_u32 vcc, 0, v30
s_nop 1
v_cndmask_b32 v40, 0, v31, vcc
v_cmp_eq_u32 vcc, 1, v30
s_nop 1
v_cndmask_b32 v41, 0, v31, vcc
v_cmp_eq_u32 vcc, 2, v30
s_nop 1
v_cndmask_b32 v42, 0, v31, vcc
v_cmp_eq_u32 vcc, 3, v30
s_nop 1
v_cndmask_b32 v43, 0, v31, vcc
v_lshlrev_b32 v0, 4, v0
ds_write_b128 v0, v[40:43] offset:11264
s_mul_i32 s36, s9, 36864
s_add_u32 s36, s36, 16384
v_add_u32 v2, s36, v0
v_add_u32 v36, s36, v36
v_add_u32 v37, s36, v37
s_mov_b32 s30, 0x3e0293ee
s_add_u32 s12, s4, 262144
s_addc_u32 s13, s5, 0
s_add_u32 s14, s4, 294912
s_addc_u32 s15, s5, 0
s_lshl_b32 s36, s8, 13
s_add_u32 s36, s36, 4096
s_add_u32 s16, s12, s36
s_addc_u32 s17, s13, 0
s_lshl_b32 s19, 1, s8
s_not_b32 s19, s19
s_add_u32 s20, s4, 65536
s_addc_u32 s21, s5, 0
s_add_u32 s22, s4, 73728
s_addc_u32 s23, s5, 0
s_add_u32 s26, s4, 81920
s_addc_u32 s27, s5, 0
s_mov_b32 s35, 0
s_waitcnt lgkmcnt(0)
v_mov_b64 v[40:41], -1
v_mov_b64 v[46:47], 0
v_mov_b64 v[48:49], 0
global_store_dwordx4 v10, v[46:49], s[16:17] offset:-4096 sc1
global_store_dwordx4 v10, v[46:49], s[16:17] offset:-3072 sc1
global_store_dwordx2 v14, v[40:41], s[20:21] sc1
global_store_dwordx2 v14, v[40:41], s[22:23] sc1
s_lshl_b32 s36, s8, 2
v_mov_b32 v44, s36
global_store_dword v44, v40, s[26:27] sc1
s_waitcnt vmcnt(0)
s_barrier
s_cmp_eq_u32 s9, 0
s_cbranch_scc0 L_arr0
v_mov_b32 v40, 0
v_mov_b32 v41, 1
s_mov_b64 exec, 1
global_atomic_add v40, v41, s[6:7] offset:128
s_mov_b64 exec, -1
L_arr0:
s_load_dwordx2 s[50:51], s[0:1], 40
s_load_dwordx2 s[52:53], s[0:1], 48
s_load_dwordx2 s[54:55], s[0:1], 56
s_load_dwordx2 s[56:57], s[0:1], 64
s_lshl_b32 s36, s8, 8
s_lshl_b32 s37, s9, 6
s_add_u32 s36, s36, s37
v_add_u32 v32, s36, v32
s_lshl_b32 s36, s8, 17
s_lshl_b32 s37, s9, 8
s_add_u32 s36, s36, s37
v_add_u32 v33, s36, v33
s_mul_i32 s58, s9, 36864
s_add_u32 s58, s58, 16384
s_lshl_b32 s59, s9, 1
s_waitcnt lgkmcnt(0)
s_xor_b32 s36, s59, 2
s_lshl_b32 s36, s36, 19
v_add_u32 v35, s36, v32
s_add_u32 m0, s58, 0
s_nop 0
global_load_lds_dwordx4 v35, s[50:51]
s_add_u32 m0, s58, 1024
v_add_u32 v35, 131072, v35
global_load_lds_dwordx4 v35, s[50:51]
s_add_u32 m0, s58, 2048
v_add_u32 v35, 131072, v35
global_load_lds_dwordx4 v35, s[50:51]
s_add_u32 m0, s58, 3072
v_add_u32 v35, 131072, v35
global_load_lds_dwordx4 v35, s[50:51]
s_xor_b32 s36, s59, 3
s_lshl_b32 s36, s36, 19
v_add_u32 v35, s36, v32
s_add_u32 m0, s58, 4096
s_nop 0
global_load_lds_dwordx4 v35, s[50:51]
s_add_u32 m0, s58, 5120
v_add_u32 v35, 131072, v35
global_load_lds_dwordx4 v35, s[50:51]
s_add_u32 m0, s58, 6144
v_add_u32 v35, 131072, v35
global_load_lds_dwordx4 v35, s[50:51]
s_add_u32 m0, s58, 7168
v_add_u32 v35, 131072, v35
global_load_lds_dwordx4 v35, s[50:51]
s_xor_b32 s36, s59, 4
s_lshl_b32 s36, s36, 19
v_add_u32 v35, s36, v32
s_add_u32 m0, s58, 8192
s_nop 0
global_load_lds_dwordx4 v35, s[50:51]
s_add_u32 m0, s58, 9216
v_add_u32 v35, 131072, v35
global_load_lds_dwordx4 v35, s[50:51]
s_add_u32 m0, s58, 10240
v_add_u32 v35, 131072, v35
global_load_lds_dwordx4 v35, s[50:51]
s_add_u32 m0, s58, 11264
v_add_u32 v35, 131072, v35
global_load_lds_dwordx4 v35, s[50:51]
s_xor_b32 s36, s59, 5
s_lshl_b32 s36, s36, 19
v_add_u32 v35, s36, v32
s_add_u32 m0, s58, 12288
s_nop 0
global_load_lds_dwordx4 v35, s[50:51]
s_add_u32 m0, s58, 13312
v_add_u32 v35, 131072, v35
global_load_lds_dwordx4 v35, s[50:51]
s_add_u32 m0, s58, 14336
v_add_u32 v35, 131072, v35
global_load_lds_dwordx4 v35, s[50:51]
s_add_u32 m0, s58, 15360
v_add_u32 v35, 131072, v35
global_load_lds_dwordx4 v35, s[50:51]
s_xor_b32 s36, s59, 6
s_lshl_b32 s36, s36, 19
v_add_u32 v35, s36, v32
s_add_u32 m0, s58, 16384
s_nop 0
global_load_lds_dwordx4 v35, s[50:51]
s_add_u32 m0, s58, 17408
v_add_u32 v35, 131072, v35
global_load_lds_dwordx4 v35, s[50:51]
s_add_u32 m0, s58, 18432
v_add_u32 v35, 131072, v35
global_load_lds_dwordx4 v35, s[50:51]
s_add_u32 m0, s58, 19456
v_add_u32 v35, 131072, v35
global_load_lds_dwordx4 v35, s[50:51]
s_xor_b32 s36, s59, 7
s_lshl_b32 s36, s36, 19
v_add_u32 v35, s36, v32
s_add_u32 m0, s58, 20480
s_nop 0
global_load_lds_dwordx4 v35, s[50:51]
s_add_u32 m0, s58, 21504
v_add_u32 v35, 131072, v35
global_load_lds_dwordx4 v35, s[50:51]
s_add_u32 m0, s58, 22528
v_add_u32 v35, 131072, v35
global_load_lds_dwordx4 v35, s[50:51]
s_add_u32 m0, s58, 23552
v_add_u32 v35, 131072, v35
global_load_lds_dwordx4 v35, s[50:51]
s_xor_b32 s36, s59, 1
s_lshl_b32 s36, s36, 19
v_add_u32 v35, s36, v32
s_add_u32 m0, s58, 24576
s_nop 0
global_load_lds_dwordx4 v35, s[52:53]
s_add_u32 m0, s58, 25600
v_add_u32 v35, 131072, v35
global_load_lds_dwordx4 v35, s[52:53]
s_add_u32 m0, s58, 26624
v_add_u32 v35, 131072, v35
global_load_lds_dwordx4 v35, s[52:53]
s_add_u32 m0, s58, 27648
v_add_u32 v35, 131072, v35
global_load_lds_dwordx4 v35, s[52:53]
s_xor_b32 s36, s59, 4
s_lshl_b32 s36, s36, 19
v_add_u32 v35, s36, v32
s_add_u32 m0, s58, 28672
s_nop 0
global_load_lds_dwordx4 v35, s[52:53]
s_add_u32 m0, s58, 29696
v_add_u32 v35, 131072, v35
global_load_lds_dwordx4 v35, s[52:53]
s_add_u32 m0, s58, 30720
v_add_u32 v35, 131072, v35
global_load_lds_dwordx4 v35, s[52:53]
s_add_u32 m0, s58, 31744
v_add_u32 v35, 131072, v35
global_load_lds_dwordx4 v35, s[52:53]
s_xor_b32 s36, s59, 5
s_lshl_b32 s36, s36, 19
v_add_u32 v35, s36, v32
s_add_u32 m0, s58, 32768
s_nop 0
global_load_lds_dwordx4 v35, s[52:53]
s_add_u32 m0, s58, 33792
v_add_u32 v35, 131072, v35
global_load_lds_dwordx4 v35, s[52:53]
s_add_u32 m0, s58, 34816
v_add_u32 v35, 131072, v35
global_load_lds_dwordx4 v35, s[52:53]
s_add_u32 m0, s58, 35840
v_add_u32 v35, 131072, v35
global_load_lds_dwordx4 v35, s[52:53]
s_waitcnt vmcnt(32)
ds_read_b64_tr_b16 a[0:1], v36 offset:0
ds_read_b64_tr_b16 a[2:3], v36 offset:128
ds_read_b64_tr_b16 a[4:5], v36 offset:2048
ds_read_b64_tr_b16 a[6:7], v36 offset:2176
ds_read_b64_tr_b16 a[8:9], v36 offset:32
ds_read_b64_tr_b16 a[10:11], v36 offset:160
ds_read_b64_tr_b16 a[12:13], v36 offset:2080
ds_read_b64_tr_b16 a[14:15], v36 offset:2208
s_waitcnt lgkmcnt(0)
s_xor_b32 s36, s59, 6
s_lshl_b32 s36, s36, 19
v_add_u32 v35, s36, v32
s_add_u32 m0, s58, 0
s_nop 0
global_load_lds_dwordx4 v35, s[52:53]
s_add_u32 m0, s58, 1024
v_add_u32 v35, 131072, v35
global_load_lds_dwordx4 v35, s[52:53]
s_add_u32 m0, s58, 2048
v_add_u32 v35, 131072, v35
global_load_lds_dwordx4 v35, s[52:53]
s_add_u32 m0, s58, 3072
v_add_u32 v35, 131072, v35
global_load_lds_dwordx4 v35, s[52:53]
s_waitcnt vmcnt(32)
ds_read_b64_tr_b16 a[16:17], v36 offset:4096
ds_read_b64_tr_b16 a[18:19], v36 offset:4224
ds_read_b64_tr_b16 a[20:21], v36 offset:6144
ds_read_b64_tr_b16 a[22:23], v36 offset:6272
ds_read_b64_tr_b16 a[24:25], v36 offset:4128
ds_read_b64_tr_b16 a[26:27], v36 offset:4256
ds_read_b64_tr_b16 a[28:29], v36 offset:6176
ds_read_b64_tr_b16 a[30:31], v36 offset:6304
s_waitcnt lgkmcnt(0)
s_xor_b32 s36, s59, 7
s_lshl_b32 s36, s36, 19
v_add_u32 v35, s36, v32
s_add_u32 m0, s58, 4096
s_nop 0
global_load_lds_dwordx4 v35, s[52:53]
s_add_u32 m0, s58, 5120
v_add_u32 v35, 131072, v35
global_load_lds_dwordx4 v35, s[52:53]
s_add_u32 m0, s58, 6144
v_add_u32 v35, 131072, v35
global_load_lds_dwordx4 v35, s[52:53]
s_add_u32 m0, s58, 7168
v_add_u32 v35, 131072, v35
global_load_lds_dwordx4 v35, s[52:53]
s_waitcnt vmcnt(32)
ds_read_b64_tr_b16 a[32:33], v36 offset:8192
ds_read_b64_tr_b16 a[34:35], v36 offset:8320
ds_read_b64_tr_b16 a[36:37], v36 offset:10240
ds_read_b64_tr_b16 a[38:39], v36 offset:10368
ds_read_b64_tr_b16 a[40:41], v36 offset:8224
ds_read_b64_tr_b16 a[42:43], v36 offset:8352
ds_read_b64_tr_b16 a[44:45], v36 offset:10272
ds_read_b64_tr_b16 a[46:47], v36 offset:10400
s_waitcnt lgkmcnt(0)
s_xor_b32 s36, s59, 0
s_lshl_b32 s36, s36, 19
v_add_u32 v35, s36, v32
s_add_u32 m0, s58, 8192
s_nop 0
global_load_lds_dwordx4 v35, s[54:55]
s_add_u32 m0, s58, 9216
v_add_u32 v35, 131072, v35
global_load_lds_dwordx4 v35, s[54:55]
s_add_u32 m0, s58, 10240
v_add_u32 v35, 131072, v35
global_load_lds_dwordx4 v35, s[54:55]
s_add_u32 m0, s58, 11264
v_add_u32 v35, 131072, v35
global_load_lds_dwordx4 v35, s[54:55]
s_waitcnt vmcnt(32)
ds_read_b64_tr_b16 a[48:49], v36 offset:12288
ds_read_b64_tr_b16 a[50:51], v36 offset:12416
ds_read_b64_tr_b16 a[52:53], v36 offset:14336
ds_read_b64_tr_b16 a[54:55], v36 offset:14464
ds_read_b64_tr_b16 a[56:57], v36 offset:12320
ds_read_b64_tr_b16 a[58:59], v36 offset:12448
ds_read_b64_tr_b16 a[60:61], v36 offset:14368
ds_read_b64_tr_b16 a[62:63], v36 offset:14496
s_waitcnt lgkmcnt(0)
s_xor_b32 s36, s59, 1
s_lshl_b32 s36, s36, 19
v_add_u32 v35, s36, v32
s_add_u32 m0, s58, 12288
s_nop 0
global_load_lds_dwordx4 v35, s[54:55]
s_add_u32 m0, s58, 13312
v_add_u32 v35, 131072, v35
global_load_lds_dwordx4 v35, s[54:55]
s_add_u32 m0, s58, 14336
v_add_u32 v35, 131072, v35
global_load_lds_dwordx4 v35, s[54:55]
s_add_u32 m0, s58, 15360
v_add_u32 v35, 131072, v35
global_load_lds_dwordx4 v35, s[54:55]
s_waitcnt vmcnt(32)
ds_read_b64_tr_b16 a[64:65], v36 offset:16384
ds_read_b64_tr_b16 a[66:67], v36 offset:16512
ds_read_b64_tr_b16 a[68:69], v36 offset:18432
ds_read_b64_tr_b16 a[70:71], v36 offset:18560
ds_read_b64_tr_b16 a[72:73], v36 offset:16416
ds_read_b64_tr_b16 a[74:75], v36 offset:16544
ds_read_b64_tr_b16 a[76:77], v36 offset:18464
ds_read_b64_tr_b16 a[78:79], v36 offset:18592
s_waitcnt lgkmcnt(0)
s_xor_b32 s36, s59, 2
s_lshl_b32 s36, s36, 19
v_add_u32 v35, s36, v32
s_add_u32 m0, s58, 16384
s_nop 0
global_load_lds_dwordx4 v35, s[54:55]
s_add_u32 m0, s58, 17408
v_add_u32 v35, 131072, v35
global_load_lds_dwordx4 v35, s[54:55]
s_add_u32 m0, s58, 18432
v_add_u32 v35, 131072, v35
global_load_lds_dwordx4 v35, s[54:55]
s_add_u32 m0, s58, 19456
v_add_u32 v35, 131072, v35
global_load_lds_dwordx4 v35, s[54:55]
s_waitcnt vmcnt(32)
ds_read_b64_tr_b16 a[80:81], v36 offset:20480
ds_read_b64_tr_b16 a[82:83], v36 offset:20608
ds_read_b64_tr_b16 a[84:85], v36 offset:22528
ds_read_b64_tr_b16 a[86:87], v36 offset:22656
ds_read_b64_tr_b16 a[88:89], v36 offset:20512
ds_read_b64_tr_b16 a[90:91], v36 offset:20640
ds_read_b64_tr_b16 a[92:93], v36 offset:22560
ds_read_b64_tr_b16 a[94:95], v36 offset:22688
s_waitcnt lgkmcnt(0)
s_xor_b32 s36, s59, 3
s_lshl_b32 s36, s36, 19
v_add_u32 v35, s36, v32
s_add_u32 m0, s58, 20480
s_nop 0
global_load_lds_dwordx4 v35, s[54:55]
s_add_u32 m0, s58, 21504
v_add_u32 v35, 131072, v35
global_load_lds_dwordx4 v35, s[54:55]
s_add_u32 m0, s58, 22528
v_add_u32 v35, 131072, v35
global_load_lds_dwordx4 v35, s[54:55]
s_add_u32 m0, s58, 23552
v_add_u32 v35, 131072, v35
global_load_lds_dwordx4 v35, s[54:55]
s_waitcnt vmcnt(32)
ds_read_b64_tr_b16 a[96:97], v36 offset:24576
ds_read_b64_tr_b16 a[98:99], v36 offset:24704
ds_read_b64_tr_b16 a[100:101], v36 offset:26624
ds_read_b64_tr_b16 a[102:103], v36 offset:26752
ds_read_b64_tr_b16 a[104:105], v36 offset:24608
ds_read_b64_tr_b16 a[106:107], v36 offset:24736
ds_read_b64_tr_b16 a[108:109], v36 offset:26656
ds_read_b64_tr_b16 a[110:111], v36 offset:26784
s_waitcnt lgkmcnt(0)
s_xor_b32 s36, s59, 4
s_lshl_b32 s36, s36, 19
v_add_u32 v35, s36, v32
s_add_u32 m0, s58, 24576
s_nop 0
global_load_lds_dwordx4 v35, s[54:55]
s_add_u32 m0, s58, 25600
v_add_u32 v35, 131072, v35
global_load_lds_dwordx4 v35, s[54:55]
s_add_u32 m0, s58, 26624
v_add_u32 v35, 131072, v35
global_load_lds_dwordx4 v35, s[54:55]
s_add_u32 m0, s58, 27648
v_add_u32 v35, 131072, v35
global_load_lds_dwordx4 v35, s[54:55]
s_waitcnt vmcnt(32)
ds_read_b64_tr_b16 a[112:113], v36 offset:28672
ds_read_b64_tr_b16 a[114:115], v36 offset:28800
ds_read_b64_tr_b16 a[116:117], v36 offset:30720
ds_read_b64_tr_b16 a[118:119], v36 offset:30848
ds_read_b64_tr_b16 a[120:121], v36 offset:28704
ds_read_b64_tr_b16 a[122:123], v36 offset:28832
ds_read_b64_tr_b16 a[124:125], v36 offset:30752
ds_read_b64_tr_b16 a[126:127], v36 offset:30880
s_waitcnt lgkmcnt(0)
s_xor_b32 s36, s59, 5
s_lshl_b32 s36, s36, 19
v_add_u32 v35, s36, v32
s_add_u32 m0, s58, 28672
s_nop 0
global_load_lds_dwordx4 v35, s[54:55]
s_add_u32 m0, s58, 29696
v_add_u32 v35, 131072, v35
global_load_lds_dwordx4 v35, s[54:55]
s_add_u32 m0, s58, 30720
v_add_u32 v35, 131072, v35
global_load_lds_dwordx4 v35, s[54:55]
s_add_u32 m0, s58, 31744
v_add_u32 v35, 131072, v35
global_load_lds_dwordx4 v35, s[54:55]
s_waitcnt vmcnt(32)
ds_read_b64_tr_b16 a[128:129], v36 offset:32768
ds_read_b64_tr_b16 a[130:131], v36 offset:32896
ds_read_b64_tr_b16 a[132:133], v36 offset:34816
ds_read_b64_tr_b16 a[134:135], v36 offset:34944
ds_read_b64_tr_b16 a[136:137], v36 offset:32800
ds_read_b64_tr_b16 a[138:139], v36 offset:32928
ds_read_b64_tr_b16 a[140:141], v36 offset:34848
ds_read_b64_tr_b16 a[142:143], v36 offset:34976
s_waitcnt lgkmcnt(0)
s_xor_b32 s36, s59, 6
s_lshl_b32 s36, s36, 19
v_add_u32 v35, s36, v32
s_add_u32 m0, s58, 32768
s_nop 0
global_load_lds_dwordx4 v35, s[54:55]
s_add_u32 m0, s58, 33792
v_add_u32 v35, 131072, v35
global_load_lds_dwordx4 v35, s[54:55]
s_add_u32 m0, s58, 34816
v_add_u32 v35, 131072, v35
global_load_lds_dwordx4 v35, s[54:55]
s_add_u32 m0, s58, 35840
v_add_u32 v35, 131072, v35
global_load_lds_dwordx4 v35, s[54:55]
s_waitcnt vmcnt(32)
ds_read_b64_tr_b16 a[144:145], v36 offset:0
ds_read_b64_tr_b16 a[146:147], v36 offset:128
ds_read_b64_tr_b16 a[148:149], v36 offset:2048
ds_read_b64_tr_b16 a[150:151], v36 offset:2176
ds_read_b64_tr_b16 a[152:153], v36 offset:32
ds_read_b64_tr_b16 a[154:155], v36 offset:160
ds_read_b64_tr_b16 a[156:157], v36 offset:2080
ds_read_b64_tr_b16 a[158:159], v36 offset:2208
s_waitcnt lgkmcnt(0)
v_add_u32 v35, 0, v33
s_add_u32 m0, s58, 0
s_nop 0
global_load_lds_dwordx4 v35, s[56:57]
s_add_u32 m0, s58, 1024
v_add_u32 v35, 16384, v35
global_load_lds_dwordx4 v35, s[56:57]
s_add_u32 m0, s58, 2048
v_add_u32 v35, 16384, v35
global_load_lds_dwordx4 v35, s[56:57]
s_add_u32 m0, s58, 3072
v_add_u32 v35, 16384, v35
global_load_lds_dwordx4 v35, s[56:57]
s_waitcnt vmcnt(32)
ds_read_b64_tr_b16 a[160:161], v36 offset:4096
ds_read_b64_tr_b16 a[162:163], v36 offset:4224
ds_read_b64_tr_b16 a[164:165], v36 offset:6144
ds_read_b64_tr_b16 a[166:167], v36 offset:6272
ds_read_b64_tr_b16 a[168:169], v36 offset:4128
ds_read_b64_tr_b16 a[170:171], v36 offset:4256
ds_read_b64_tr_b16 a[172:173], v36 offset:6176
ds_read_b64_tr_b16 a[174:175], v36 offset:6304
s_waitcnt lgkmcnt(0)
v_add_u32 v35, 65536, v33
s_add_u32 m0, s58, 4096
s_nop 0
global_load_lds_dwordx4 v35, s[56:57]
s_add_u32 m0, s58, 5120
v_add_u32 v35, 16384, v35
global_load_lds_dwordx4 v35, s[56:57]
s_add_u32 m0, s58, 6144
v_add_u32 v35, 16384, v35
global_load_lds_dwordx4 v35, s[56:57]
s_add_u32 m0, s58, 7168
v_add_u32 v35, 16384, v35
global_load_lds_dwordx4 v35, s[56:57]
s_waitcnt vmcnt(32)
ds_read_b64_tr_b16 a[176:177], v36 offset:8192
ds_read_b64_tr_b16 a[178:179], v36 offset:8320
ds_read_b64_tr_b16 a[180:181], v36 offset:10240
ds_read_b64_tr_b16 a[182:183], v36 offset:10368
ds_read_b64_tr_b16 a[184:185], v36 offset:8224
ds_read_b64_tr_b16 a[186:187], v36 offset:8352
ds_read_b64_tr_b16 a[188:189], v36 offset:10272
ds_read_b64_tr_b16 a[190:191], v36 offset:10400
s_waitcnt lgkmcnt(0)
v_add_u32 v35, 64, v33
s_add_u32 m0, s58, 8192
s_nop 0
global_load_lds_dwordx4 v35, s[56:57]
s_add_u32 m0, s58, 9216
v_add_u32 v35, 16384, v35
global_load_lds_dwordx4 v35, s[56:57]
s_add_u32 m0, s58, 10240
v_add_u32 v35, 16384, v35
global_load_lds_dwordx4 v35, s[56:57]
s_add_u32 m0, s58, 11264
v_add_u32 v35, 16384, v35
global_load_lds_dwordx4 v35, s[56:57]
s_waitcnt vmcnt(32)
ds_read_b64_tr_b16 a[192:193], v36 offset:12288
ds_read_b64_tr_b16 a[194:195], v36 offset:12416
ds_read_b64_tr_b16 a[196:197], v36 offset:14336
ds_read_b64_tr_b16 a[198:199], v36 offset:14464
ds_read_b64_tr_b16 a[200:201], v36 offset:12320
ds_read_b64_tr_b16 a[202:203], v36 offset:12448
ds_read_b64_tr_b16 a[204:205], v36 offset:14368
ds_read_b64_tr_b16 a[206:207], v36 offset:14496
s_waitcnt lgkmcnt(0)
v_add_u32 v35, 65600, v33
s_add_u32 m0, s58, 12288
s_nop 0
global_load_lds_dwordx4 v35, s[56:57]
s_add_u32 m0, s58, 13312
v_add_u32 v35, 16384, v35
global_load_lds_dwordx4 v35, s[56:57]
s_add_u32 m0, s58, 14336
v_add_u32 v35, 16384, v35
global_load_lds_dwordx4 v35, s[56:57]
s_add_u32 m0, s58, 15360
v_add_u32 v35, 16384, v35
global_load_lds_dwordx4 v35, s[56:57]
s_waitcnt vmcnt(32)
ds_read_b64_tr_b16 a[208:209], v36 offset:16384
ds_read_b64_tr_b16 a[210:211], v36 offset:16512
ds_read_b64_tr_b16 a[212:213], v36 offset:18432
ds_read_b64_tr_b16 a[214:215], v36 offset:18560
ds_read_b64_tr_b16 a[216:217], v36 offset:16416
ds_read_b64_tr_b16 a[218:219], v36 offset:16544
ds_read_b64_tr_b16 a[220:221], v36 offset:18464
ds_read_b64_tr_b16 a[222:223], v36 offset:18592
s_waitcnt lgkmcnt(0)
v_add_u32 v35, 128, v33
s_add_u32 m0, s58, 16384
s_nop 0
global_load_lds_dwordx4 v35, s[56:57]
s_add_u32 m0, s58, 17408
v_add_u32 v35, 16384, v35
global_load_lds_dwordx4 v35, s[56:57]
s_add_u32 m0, s58, 18432
v_add_u32 v35, 16384, v35
global_load_lds_dwordx4 v35, s[56:57]
s_add_u32 m0, s58, 19456
v_add_u32 v35, 16384, v35
global_load_lds_dwordx4 v35, s[56:57]
s_waitcnt vmcnt(32)
ds_read_b64_tr_b16 a[224:225], v36 offset:20480
ds_read_b64_tr_b16 a[226:227], v36 offset:20608
ds_read_b64_tr_b16 a[228:229], v36 offset:22528
ds_read_b64_tr_b16 a[230:231], v36 offset:22656
ds_read_b64_tr_b16 a[232:233], v36 offset:20512
ds_read_b64_tr_b16 a[234:235], v36 offset:20640
ds_read_b64_tr_b16 a[236:237], v36 offset:22560
ds_read_b64_tr_b16 a[238:239], v36 offset:22688
s_waitcnt lgkmcnt(0)
s_xor_b32 s36, s59, 0
s_lshl_b32 s36, s36, 19
v_add_u32 v35, s36, v32
s_add_u32 m0, s58, 20480
s_nop 0
global_load_lds_dwordx4 v35, s[50:51]
s_add_u32 m0, s58, 21504
v_add_u32 v35, 131072, v35
global_load_lds_dwordx4 v35, s[50:51]
s_add_u32 m0, s58, 22528
v_add_u32 v35, 131072, v35
global_load_lds_dwordx4 v35, s[50:51]
s_add_u32 m0, s58, 23552
v_add_u32 v35, 131072, v35
global_load_lds_dwordx4 v35, s[50:51]
s_waitcnt vmcnt(32)
ds_read_b64_tr_b16 a[240:241], v36 offset:24576
ds_read_b64_tr_b16 a[242:243], v36 offset:24704
ds_read_b64_tr_b16 a[244:245], v36 offset:26624
ds_read_b64_tr_b16 a[246:247], v36 offset:26752
ds_read_b64_tr_b16 a[248:249], v36 offset:24608
ds_read_b64_tr_b16 a[250:251], v36 offset:24736
ds_read_b64_tr_b16 a[252:253], v36 offset:26656
ds_read_b64_tr_b16 a[254:255], v36 offset:26784
s_waitcnt lgkmcnt(0)
s_xor_b32 s36, s59, 1
s_lshl_b32 s36, s36, 19
v_add_u32 v35, s36, v32
s_add_u32 m0, s58, 24576
s_nop 0
global_load_lds_dwordx4 v35, s[50:51]
s_add_u32 m0, s58, 25600
v_add_u32 v35, 131072, v35
global_load_lds_dwordx4 v35, s[50:51]
s_add_u32 m0, s58, 26624
v_add_u32 v35, 131072, v35
global_load_lds_dwordx4 v35, s[50:51]
s_add_u32 m0, s58, 27648
v_add_u32 v35, 131072, v35
global_load_lds_dwordx4 v35, s[50:51]
s_waitcnt vmcnt(32)
ds_read_b64_tr_b16 v[144:145], v36 offset:28672
ds_read_b64_tr_b16 v[146:147], v36 offset:28800
ds_read_b64_tr_b16 v[148:149], v36 offset:30720
ds_read_b64_tr_b16 v[150:151], v36 offset:30848
ds_read_b64_tr_b16 v[152:153], v36 offset:28704
ds_read_b64_tr_b16 v[154:155], v36 offset:28832
ds_read_b64_tr_b16 v[156:157], v36 offset:30752
ds_read_b64_tr_b16 v[158:159], v36 offset:30880
s_waitcnt lgkmcnt(0)
s_xor_b32 s36, s59, 0
s_lshl_b32 s36, s36, 19
v_add_u32 v35, s36, v32
s_add_u32 m0, s58, 28672
s_nop 0
global_load_lds_dwordx4 v35, s[52:53]
s_add_u32 m0, s58, 29696
v_add_u32 v35, 131072, v35
global_load_lds_dwordx4 v35, s[52:53]
s_add_u32 m0, s58, 30720
v_add_u32 v35, 131072, v35
global_load_lds_dwordx4 v35, s[52:53]
s_add_u32 m0, s58, 31744
v_add_u32 v35, 131072, v35
global_load_lds_dwordx4 v35, s[52:53]
s_waitcnt vmcnt(32)
ds_read_b64_tr_b16 v[160:161], v36 offset:32768
ds_read_b64_tr_b16 v[162:163], v36 offset:32896
ds_read_b64_tr_b16 v[164:165], v36 offset:34816
ds_read_b64_tr_b16 v[166:167], v36 offset:34944
ds_read_b64_tr_b16 v[168:169], v36 offset:32800
ds_read_b64_tr_b16 v[170:171], v36 offset:32928
ds_read_b64_tr_b16 v[172:173], v36 offset:34848
ds_read_b64_tr_b16 v[174:175], v36 offset:34976
s_waitcnt lgkmcnt(0)
s_xor_b32 s36, s59, 2
s_lshl_b32 s36, s36, 19
v_add_u32 v35, s36, v32
s_add_u32 m0, s58, 32768
s_nop 0
global_load_lds_dwordx4 v35, s[52:53]
s_add_u32 m0, s58, 33792
v_add_u32 v35, 131072, v35
global_load_lds_dwordx4 v35, s[52:53]
s_add_u32 m0, s58, 34816
v_add_u32 v35, 131072, v35
global_load_lds_dwordx4 v35, s[52:53]
s_add_u32 m0, s58, 35840
v_add_u32 v35, 131072, v35
global_load_lds_dwordx4 v35, s[52:53]
s_waitcnt vmcnt(32)
ds_read_b64_tr_b16 v[176:177], v37 offset:0
ds_read_b64_tr_b16 v[178:179], v37 offset:128
ds_read_b64_tr_b16 v[180:181], v37 offset:512
ds_read_b64_tr_b16 v[182:183], v37 offset:640
ds_read_b64_tr_b16 v[184:185], v37 offset:2048
ds_read_b64_tr_b16 v[186:187], v37 offset:2176
ds_read_b64_tr_b16 v[188:189], v37 offset:2560
ds_read_b64_tr_b16 v[190:191], v37 offset:2688
s_waitcnt lgkmcnt(0)
s_xor_b32 s36, s59, 3
s_lshl_b32 s36, s36, 19
v_add_u32 v35, s36, v32
s_add_u32 m0, s58, 0
s_nop 0
global_load_lds_dwordx4 v35, s[52:53]
s_add_u32 m0, s58, 1024
v_add_u32 v35, 131072, v35
global_load_lds_dwordx4 v35, s[52:53]
s_add_u32 m0, s58, 2048
v_add_u32 v35, 131072, v35
global_load_lds_dwordx4 v35, s[52:53]
s_add_u32 m0, s58, 3072
v_add_u32 v35, 131072, v35
global_load_lds_dwordx4 v35, s[52:53]
s_waitcnt vmcnt(32)
ds_read_b64_tr_b16 v[192:193], v37 offset:4096
ds_read_b64_tr_b16 v[194:195], v37 offset:4224
ds_read_b64_tr_b16 v[196:197], v37 offset:4608
ds_read_b64_tr_b16 v[198:199], v37 offset:4736
ds_read_b64_tr_b16 v[200:201], v37 offset:6144
ds_read_b64_tr_b16 v[202:203], v37 offset:6272
ds_read_b64_tr_b16 v[204:205], v37 offset:6656
ds_read_b64_tr_b16 v[206:207], v37 offset:6784
s_waitcnt lgkmcnt(0)
s_xor_b32 s36, s59, 7
s_lshl_b32 s36, s36, 19
v_add_u32 v35, s36, v32
s_add_u32 m0, s58, 4096
s_nop 0
global_load_lds_dwordx4 v35, s[54:55]
s_add_u32 m0, s58, 5120
v_add_u32 v35, 131072, v35
global_load_lds_dwordx4 v35, s[54:55]
s_add_u32 m0, s58, 6144
v_add_u32 v35, 131072, v35
global_load_lds_dwordx4 v35, s[54:55]
s_add_u32 m0, s58, 7168
v_add_u32 v35, 131072, v35
global_load_lds_dwordx4 v35, s[54:55]
s_waitcnt vmcnt(32)
ds_read_b64_tr_b16 v[208:209], v37 offset:8192
ds_read_b64_tr_b16 v[210:211], v37 offset:8320
ds_read_b64_tr_b16 v[212:213], v37 offset:8704
ds_read_b64_tr_b16 v[214:215], v37 offset:8832
ds_read_b64_tr_b16 v[216:217], v37 offset:10240
ds_read_b64_tr_b16 v[218:219], v37 offset:10368
ds_read_b64_tr_b16 v[220:221], v37 offset:10752
ds_read_b64_tr_b16 v[222:223], v37 offset:10880
s_waitcnt lgkmcnt(0)
v_add_u32 v35, 65664, v33
s_add_u32 m0, s58, 8192
s_nop 0
global_load_lds_dwordx4 v35, s[56:57]
s_add_u32 m0, s58, 9216
v_add_u32 v35, 16384, v35
global_load_lds_dwordx4 v35, s[56:57]
s_add_u32 m0, s58, 10240
v_add_u32 v35, 16384, v35
global_load_lds_dwordx4 v35, s[56:57]
s_add_u32 m0, s58, 11264
v_add_u32 v35, 16384, v35
global_load_lds_dwordx4 v35, s[56:57]
s_waitcnt vmcnt(32)
ds_read_b64_tr_b16 v[224:225], v37 offset:12288
ds_read_b64_tr_b16 v[226:227], v37 offset:12416
ds_read_b64_tr_b16 v[228:229], v37 offset:12800
ds_read_b64_tr_b16 v[230:231], v37 offset:12928
ds_read_b64_tr_b16 v[232:233], v37 offset:14336
ds_read_b64_tr_b16 v[234:235], v37 offset:14464
ds_read_b64_tr_b16 v[236:237], v37 offset:14848
ds_read_b64_tr_b16 v[238:239], v37 offset:14976
s_waitcnt lgkmcnt(0)
v_add_u32 v35, 192, v33
s_add_u32 m0, s58, 12288
s_nop 0
global_load_lds_dwordx4 v35, s[56:57]
s_add_u32 m0, s58, 13312
v_add_u32 v35, 16384, v35
global_load_lds_dwordx4 v35, s[56:57]
s_add_u32 m0, s58, 14336
v_add_u32 v35, 16384, v35
global_load_lds_dwordx4 v35, s[56:57]
s_add_u32 m0, s58, 15360
v_add_u32 v35, 16384, v35
global_load_lds_dwordx4 v35, s[56:57]
s_waitcnt vmcnt(32)
ds_read_b64_tr_b16 v[240:241], v37 offset:16384
ds_read_b64_tr_b16 v[242:243], v37 offset:16512
ds_read_b64_tr_b16 v[244:245], v37 offset:16896
ds_read_b64_tr_b16 v[246:247], v37 offset:17024
ds_read_b64_tr_b16 v[248:249], v37 offset:18432
ds_read_b64_tr_b16 v[250:251], v37 offset:18560
ds_read_b64_tr_b16 v[252:253], v37 offset:18944
ds_read_b64_tr_b16 v[254:255], v37 offset:19072
s_waitcnt lgkmcnt(0)
v_add_u32 v35, 65728, v33
s_add_u32 m0, s58, 16384
s_nop 0
global_load_lds_dwordx4 v35, s[56:57]
s_add_u32 m0, s58, 17408
v_add_u32 v35, 16384, v35
global_load_lds_dwordx4 v35, s[56:57]
s_add_u32 m0, s58, 18432
v_add_u32 v35, 16384, v35
global_load_lds_dwordx4 v35, s[56:57]
s_add_u32 m0, s58, 19456
v_add_u32 v35, 16384, v35
global_load_lds_dwordx4 v35, s[56:57]
s_waitcnt vmcnt(32)
ds_read_b64_tr_b16 v[96:97], v36 offset:20480
ds_read_b64_tr_b16 v[98:99], v36 offset:20608
ds_read_b64_tr_b16 v[100:101], v36 offset:22528
ds_read_b64_tr_b16 v[102:103], v36 offset:22656
ds_read_b64_tr_b16 v[104:105], v36 offset:20512
ds_read_b64_tr_b16 v[106:107], v36 offset:20640
ds_read_b64_tr_b16 v[108:109], v36 offset:22560
ds_read_b64_tr_b16 v[110:111], v36 offset:22688
s_waitcnt lgkmcnt(0)
ds_write_b128 v2, v[96:99] offset:20480
ds_write_b128 v2, v[100:103] offset:21504
ds_write_b128 v2, v[104:107] offset:22528
ds_write_b128 v2, v[108:111] offset:23552
s_waitcnt lgkmcnt(0)
s_waitcnt vmcnt(28)
ds_read_b64_tr_b16 v[96:97], v36 offset:24576
ds_read_b64_tr_b16 v[98:99], v36 offset:24704
ds_read_b64_tr_b16 v[100:101], v36 offset:26624
ds_read_b64_tr_b16 v[102:103], v36 offset:26752
ds_read_b64_tr_b16 v[104:105], v36 offset:24608
ds_read_b64_tr_b16 v[106:107], v36 offset:24736
ds_read_b64_tr_b16 v[108:109], v36 offset:26656
ds_read_b64_tr_b16 v[110:111], v36 offset:26784
s_waitcnt lgkmcnt(0)
ds_write_b128 v2, v[96:99] offset:24576
ds_write_b128 v2, v[100:103] offset:25600
ds_write_b128 v2, v[104:107] offset:26624
ds_write_b128 v2, v[108:111] offset:27648
s_waitcnt lgkmcnt(0)
s_waitcnt vmcnt(24)
ds_read_b64_tr_b16 v[96:97], v36 offset:28672
ds_read_b64_tr_b16 v[98:99], v36 offset:28800
ds_read_b64_tr_b16 v[100:101], v36 offset:30720
ds_read_b64_tr_b16 v[102:103], v36 offset:30848
ds_read_b64_tr_b16 v[104:105], v36 offset:28704
ds_read_b64_tr_b16 v[106:107], v36 offset:28832
ds_read_b64_tr_b16 v[108:109], v36 offset:30752
ds_read_b64_tr_b16 v[110:111], v36 offset:30880
s_waitcnt lgkmcnt(0)
ds_write_b128 v2, v[96:99] offset:28672
ds_write_b128 v2, v[100:103] offset:29696
ds_write_b128 v2, v[104:107] offset:30720
ds_write_b128 v2, v[108:111] offset:31744
s_waitcnt lgkmcnt(0)
s_waitcnt vmcnt(20)
ds_read_b64_tr_b16 v[96:97], v36 offset:32768
ds_read_b64_tr_b16 v[98:99], v36 offset:32896
ds_read_b64_tr_b16 v[100:101], v36 offset:34816
ds_read_b64_tr_b16 v[102:103], v36 offset:34944
ds_read_b64_tr_b16 v[104:105], v36 offset:32800
ds_read_b64_tr_b16 v[106:107], v36 offset:32928
ds_read_b64_tr_b16 v[108:109], v36 offset:34848
ds_read_b64_tr_b16 v[110:111], v36 offset:34976
s_waitcnt lgkmcnt(0)
ds_write_b128 v2, v[96:99] offset:32768
ds_write_b128 v2, v[100:103] offset:33792
ds_write_b128 v2, v[104:107] offset:34816
ds_write_b128 v2, v[108:111] offset:35840
s_waitcnt lgkmcnt(0)
s_waitcnt vmcnt(16)
ds_read_b64_tr_b16 v[96:97], v36 offset:0
ds_read_b64_tr_b16 v[98:99], v36 offset:128
ds_read_b64_tr_b16 v[100:101], v36 offset:2048
ds_read_b64_tr_b16 v[102:103], v36 offset:2176
ds_read_b64_tr_b16 v[104:105], v36 offset:32
ds_read_b64_tr_b16 v[106:107], v36 offset:160
ds_read_b64_tr_b16 v[108:109], v36 offset:2080
ds_read_b64_tr_b16 v[110:111], v36 offset:2208
s_waitcnt lgkmcnt(0)
ds_write_b128 v2, v[96:99] offset:0
ds_write_b128 v2, v[100:103] offset:1024
ds_write_b128 v2, v[104:107] offset:2048
ds_write_b128 v2, v[108:111] offset:3072
s_waitcnt lgkmcnt(0)
s_waitcnt vmcnt(12)
ds_read_b64_tr_b16 v[96:97], v36 offset:4096
ds_read_b64_tr_b16 v[98:99], v36 offset:4224
ds_read_b64_tr_b16 v[100:101], v36 offset:6144
ds_read_b64_tr_b16 v[102:103], v36 offset:6272
ds_read_b64_tr_b16 v[104:105], v36 offset:4128
ds_read_b64_tr_b16 v[106:107], v36 offset:4256
ds_read_b64_tr_b16 v[108:109], v36 offset:6176
ds_read_b64_tr_b16 v[110:111], v36 offset:6304
s_waitcnt lgkmcnt(0)
ds_write_b128 v2, v[96:99] offset:4096
ds_write_b128 v2, v[100:103] offset:5120
ds_write_b128 v2, v[104:107] offset:6144
ds_write_b128 v2, v[108:111] offset:7168
s_waitcnt lgkmcnt(0)
s_waitcnt vmcnt(8)
ds_read_b64_tr_b16 v[96:97], v37 offset:8192
ds_read_b64_tr_b16 v[98:99], v37 offset:8320
ds_read_b64_tr_b16 v[100:101], v37 offset:8704
ds_read_b64_tr_b16 v[102:103], v37 offset:8832
ds_read_b64_tr_b16 v[104:105], v37 offset:10240
ds_read_b64_tr_b16 v[106:107], v37 offset:10368
ds_read_b64_tr_b16 v[108:109], v37 offset:10752
ds_read_b64_tr_b16 v[110:111], v37 offset:10880
s_waitcnt lgkmcnt(0)
ds_write_b128 v2, v[96:99] offset:8192
ds_write_b128 v2, v[100:103] offset:9216
ds_write_b128 v2, v[104:107] offset:10240
ds_write_b128 v2, v[108:111] offset:11264
s_waitcnt lgkmcnt(0)
s_waitcnt vmcnt(4)
ds_read_b64_tr_b16 v[96:97], v37 offset:12288
ds_read_b64_tr_b16 v[98:99], v37 offset:12416
ds_read_b64_tr_b16 v[100:101], v37 offset:12800
ds_read_b64_tr_b16 v[102:103], v37 offset:12928
ds_read_b64_tr_b16 v[104:105], v37 offset:14336
ds_read_b64_tr_b16 v[106:107], v37 offset:14464
ds_read_b64_tr_b16 v[108:109], v37 offset:14848
ds_read_b64_tr_b16 v[110:111], v37 offset:14976
s_waitcnt lgkmcnt(0)
ds_write_b128 v2, v[96:99] offset:12288
ds_write_b128 v2, v[100:103] offset:13312
ds_write_b128 v2, v[104:107] offset:14336
ds_write_b128 v2, v[108:111] offset:15360
s_waitcnt lgkmcnt(0)
s_waitcnt vmcnt(0)
ds_read_b64_tr_b16 v[96:97], v37 offset:16384
ds_read_b64_tr_b16 v[98:99], v37 offset:16512
ds_read_b64_tr_b16 v[100:101], v37 offset:16896
ds_read_b64_tr_b16 v[102:103], v37 offset:17024
ds_read_b64_tr_b16 v[104:105], v37 offset:18432
ds_read_b64_tr_b16 v[106:107], v37 offset:18560
ds_read_b64_tr_b16 v[108:109], v37 offset:18944
ds_read_b64_tr_b16 v[110:111], v37 offset:19072
s_waitcnt lgkmcnt(0)
ds_write_b128 v2, v[96:99] offset:16384
ds_write_b128 v2, v[100:103] offset:17408
ds_write_b128 v2, v[104:107] offset:18432
ds_write_b128 v2, v[108:111] offset:19456
s_waitcnt lgkmcnt(0)
s_mov_b32 s34, 0
v_mov_b32 v40, 0
L_cw0:
global_load_dword v41, v40, s[6:7] offset:128 sc1
global_load_dword v42, v40, s[6:7] offset:64 sc1
s_add_u32 s34, s34, 1
s_cmp_gt_u32 s34, 400000
s_cbranch_scc1 L_fail
s_waitcnt vmcnt(0)
v_cmp_ne_u32 vcc, 0x100, v41
s_cbranch_vccnz L_cw0
v_cmp_lt_u32 vcc, 0xe0, v42
s_cbranch_vccnz L_chain_s
L_chain_f:
s_load_dwordx2 s[50:51], s[0:1], 32
s_lshl_b32 s36, s8, 14
s_lshl_b32 s37, s9, 12
s_add_u32 s36, s36, s37
s_add_u32 s37, s36, 25165824
s_add_u32 s24, s4, s37
s_addc_u32 s25, s5, 0
s_lshl_b32 s36, s8, 12
s_add_u32 s36, s36, 12451840
s_add_u32 s28, s4, s36
s_addc_u32 s29, s5, 0
s_mov_b32 s10, -1
v_and_b32 v34, 0x70, v8
v_lshlrev_b32 v34, 6, v34
v_bfe_u32 v35, v0, 8, 2
v_lshl_add_u32 v34, v35, 5, v34
v_bfe_u32 v35, v0, 5, 1
v_lshl_add_u32 v34, v35, 4, v34
s_lshl_b32 s36, s9, 8
v_add_u32 v34, s36, v34
s_waitcnt lgkmcnt(0)
global_load_dwordx4 v[16:19], v34, s[50:51]
global_load_dwordx4 v[20:23], v34, s[50:51] offset:128
s_lshl_b32 s36, s8, 10
s_add_u32 s36, s36, 1081344
s_add_u32 s56, s4, s36
s_addc_u32 s57, s5, 0
s_lshl_b32 s36, s9, 2
s_add_u32 s36, s36, 768
s_add_u32 s52, s56, s36
s_addc_u32 s53, s57, 0
s_mov_b32 s54, 4
s_mov_b32 s55, 0x20000
s_mov_b32 s34, 0
s_mov_b64 exec, 15
v_lshlrev_b32 v132, 3, v0
L_kvr_1:
global_load_dwordx4 v[128:131], v132, s[56:57] sc1
s_add_u32 s34, s34, 1
s_cmp_gt_u32 s34, 400000
s_cbranch_scc1 L_fail
s_waitcnt vmcnt(0)
v_min3_u32 v128, v128, v129, v130
v_min_u32 v128, v128, v131
s_nop 0
v_readlane_b32 s36, v128, 0
v_readlane_b32 s37, v128, 1
v_readlane_b32 s38, v128, 2
v_readlane_b32 s39, v128, 3
s_min_u32 s36, s36, s37
s_min_u32 s38, s38, s39
s_min_u32 s36, s36, s38
s_lshl_b32 s49, s36, 2
s_sub_u32 s49, s49, 2
s_cmp_eq_u32 s36, 16
s_cselect_b32 s49, 100, s49
s_cmp_lt_i32 s10, s49
s_cbranch_scc0 L_kvr_1
s_mov_b64 exec, -1
ds_read_b128 v[96:99], v2 offset:20480
ds_read_b128 v[100:103], v2 offset:21504
ds_read_b128 v[104:107], v2 offset:22528
ds_read_b128 v[108:111], v2 offset:23552
ds_read_b128 v[112:115], v2 offset:24576
ds_read_b128 v[116:119], v2 offset:25600
ds_read_b128 v[120:123], v2 offset:26624
ds_read_b128 v[124:127], v2 offset:27648
ds_read_b128 v[48:51], v2 offset:28672
ds_read_b128 v[52:55], v2 offset:29696
ds_read_b128 v[56:59], v2 offset:30720
ds_read_b128 v[60:63], v2 offset:31744
v_mov_b64 v[64:65], 0
v_mov_b64 v[66:67], 0
v_mov_b64 v[68:69], 0
v_mov_b64 v[70:71], 0
v_mov_b64 v[72:73], 0
v_mov_b64 v[74:75], 0
v_mov_b64 v[76:77], 0
v_mov_b64 v[78:79], 0
global_load_dwordx4 v[128:131], v11, s[24:25] offset:0 sc1
global_load_dwordx4 v[132:135], v11, s[24:25] offset:1024 sc1
global_load_dwordx4 v[136:139], v0, s[24:25] offset:2048 sc1
global_load_dwordx4 v[140:143], v0, s[24:25] offset:3072 sc1
s_waitcnt vmcnt(0) lgkmcnt(0)
v_mov_b64 v[88:89], v[128:129]
v_mov_b64 v[90:91], v[130:131]
v_mov_b64 v[92:93], v[132:133]
v_mov_b64 v[94:95], v[134:135]
v_mov_b64 v[80:81], v[136:137]
v_mov_b64 v[82:83], v[138:139]
v_mov_b64 v[84:85], v[142:143]
v_mov_b64 v[86:87], v[140:141]
s_waitcnt lgkmcnt(0)
ds_write_b128 v10, v[16:19] offset:0
ds_write_b128 v10, v[20:23] offset:1024
s_branch L_ch_topf
L_ch_p1rf:
s_mov_b64 exec, 1
global_store_dword v84, v82, s[26:27]
s_mov_b64 exec, -1
s_add_u32 s34, s34, 1
s_cmp_gt_u32 s34, 400000
s_cbranch_scc1 L_fail
global_load_dwordx4 v[16:19], v0, s[16:17] offset:-4096 sc1
global_load_dwordx4 v[20:23], v0, s[16:17] offset:-3072 sc1
global_load_dwordx4 v[24:27], v0, s[16:17] offset:-2048 sc1
global_load_dwordx4 v[28:31], v0, s[16:17] offset:-1024 sc1
global_load_dwordx4 v[32:35], v0, s[16:17] offset:0 sc1
global_load_dwordx4 v[36:39], v0, s[16:17] offset:1024 sc1
global_load_dwordx4 v[40:43], v0, s[16:17] offset:2048 sc1
global_load_dwordx4 v[44:47], v0, s[16:17] offset:3072 sc1
s_branch L_ch_p1bf
L_ch_p2rf:
s_mov_b64 s[42:43], vcc
v_bfe_u32 v24, v0, 2, 7
v_mov_b32 v25, -1
s_mov_b32 exec_hi, 0
s_mov_b32 exec_lo, s19
L_ch_p2wf:
global_load_dword v25, v24, s[26:27] sc1
s_add_u32 s34, s34, 1
s_cmp_gt_u32 s34, 400000
s_cbranch_scc1 L_fail
s_waitcnt vmcnt(40)
v_cmp_ne_u32 vcc, s35, v25
s_cbranch_vccnz L_ch_p2wf
s_mov_b64 exec, -1
s_mov_b64 exec, s[42:43]
global_load_dwordx4 v[16:19], v10, s[20:21] sc1
global_load_dwordx4 v[20:23], v10, s[20:21] offset:1024 sc1
s_mov_b64 exec, -1
s_branch L_ch_p2f
L_ch_kvwf:
s_mov_b32 s34, 0
s_mov_b64 exec, 15
v_lshlrev_b32 v132, 3, v0
L_kvr_2:
global_load_dwordx4 v[128:131], v132, s[56:57] sc1
s_add_u32 s34, s34, 1
s_cmp_gt_u32 s34, 400000
s_cbranch_scc1 L_fail
s_waitcnt vmcnt(0)
v_min3_u32 v128, v128, v129, v130
v_min_u32 v128, v128, v131
s_nop 0
v_readlane_b32 s36, v128, 0
v_readlane_b32 s37, v128, 1
v_readlane_b32 s38, v128, 2
v_readlane_b32 s39, v128, 3
s_min_u32 s36, s36, s37
s_min_u32 s38, s38, s39
s_min_u32 s36, s36, s38
s_lshl_b32 s49, s36, 2
s_sub_u32 s49, s49, 2
s_cmp_eq_u32 s36, 16
s_cselect_b32 s49, 100, s49
s_cmp_lt_i32 s10, s49
s_cbranch_scc0 L_kvr_2
s_mov_b64 exec, -1
s_branch L_ch_kvbf
L_ch_nrf:
ds_read_b128 v[96:99], v2 offset:20480
ds_read_b128 v[100:103], v2 offset:21504
ds_read_b128 v[104:107], v2 offset:22528
ds_read_b128 v[108:111], v2 offset:23552
ds_read_b128 v[112:115], v2 offset:24576
ds_read_b128 v[116:119], v2 offset:25600
ds_read_b128 v[120:123], v2 offset:26624
ds_read_b128 v[124:127], v2 offset:27648
ds_read_b128 v[48:51], v2 offset:28672
ds_read_b128 v[52:55], v2 offset:29696
ds_read_b128 v[56:59], v2 offset:30720
ds_read_b128 v[60:63], v2 offset:31744
v_mov_b64 v[64:65], 0
v_mov_b64 v[66:67], 0
v_mov_b64 v[68:69], 0
v_mov_b64 v[70:71], 0
v_mov_b64 v[72:73], 0
v_mov_b64 v[74:75], 0
v_mov_b64 v[76:77], 0
v_mov_b64 v[78:79], 0
s_waitcnt vmcnt(2) lgkmcnt(12)
v_mov_b64 v[88:89], v[128:129]
v_mov_b64 v[90:91], v[130:131]
v_mov_b64 v[92:93], v[132:133]
v_mov_b64 v[94:95], v[134:135]
v_mov_b64 v[80:81], v[136:137]
v_mov_b64 v[82:83], v[138:139]
v_mov_b64 v[84:85], v[142:143]
v_mov_b64 v[86:87], v[140:141]
s_mov_b32 s34, 0
s_cmp_eq_u32 s9, 1
s_cbranch_scc0 L_ch_nbf
v_bfe_u32 v24, v0, 2, 7
v_mov_b32 v25, -1
s_mov_b32 exec_hi, 0
s_mov_b32 exec_lo, s19
L_ch_pff:
global_load_dword v25, v24, s[26:27] sc1
s_add_u32 s34, s34, 1
s_cmp_gt_u32 s34, 400000
s_cbranch_scc1 L_fail
s_waitcnt vmcnt(40)
v_cmp_ne_u32 vcc, s35, v25
s_cbranch_vccnz L_ch_pff
s_mov_b64 exec, -1
L_ch_nbf:
s_barrier
global_load_dwordx4 v[16:19], v10, s[20:21] sc1
global_load_dwordx4 v[20:23], v10, s[20:21] offset:1024 sc1
s_mov_b32 s34, 0
s_branch L_ch_p2cf
L_ch_commf:
s_nop 15
s_nop 15
s_nop 15
s_nop 15
s_nop 15
global_load_dwordx4 v[16:19], v0, s[16:17] offset:-4096 sc1
global_load_dwordx4 v[20:23], v0, s[16:17] offset:-3072 sc1
global_load_dwordx4 v[24:27], v0, s[16:17] offset:-2048 sc1
global_load_dwordx4 v[28:31], v0, s[16:17] offset:-1024 sc1
global_load_dwordx4 v[32:35], v0, s[16:17] offset:0 sc1
global_load_dwordx4 v[36:39], v0, s[16:17] offset:1024 sc1
global_load_dwordx4 v[40:43], v0, s[16:17] offset:2048 sc1
global_load_dwordx4 v[44:47], v0, s[16:17] offset:3072 sc1
s_lshl_b32 s36, s8, 2
v_mov_b32 v84, s36
v_mov_b32 v85, s35
v_mov_b64 v[82:83], -1
s_mov_b32 s34, 0
s_waitcnt lgkmcnt(0)
L_ch_p1bf:
s_nop 9
s_mov_b64 exec, 1
global_store_dword v84, v85, s[26:27]
s_mov_b64 exec, -1
s_waitcnt vmcnt(8)
v_mfma_f32_16x16x32_bf16 v[92:95], v[16:19], v[88:91], 0
v_xor_b32 v80, s18, v16
s_waitcnt vmcnt(7)
v_mfma_f32_16x16x32_bf16 v[92:95], v[20:23], v[88:91], v[92:95]
v_bitop3_b32 v80, v80, v20, s18 bitop3:0xf6
s_waitcnt vmcnt(6)
v_mfma_f32_16x16x32_bf16 v[92:95], v[24:27], v[88:91], v[92:95]
v_bitop3_b32 v80, v80, v24, s18 bitop3:0xf6
s_waitcnt vmcnt(5)
v_mfma_f32_16x16x32_bf16 v[92:95], v[28:31], v[88:91], v[92:95]
v_bitop3_b32 v80, v80, v28, s18 bitop3:0xf6
s_waitcnt vmcnt(4)
v_mfma_f32_16x16x32_bf16 v[92:95], v[32:35], v[88:91], v[92:95]
v_bitop3_b32 v80, v80, v32, s18 bitop3:0xf6
s_waitcnt vmcnt(3)
v_mfma_f32_16x16x32_bf16 v[92:95], v[36:39], v[88:91], v[92:95]
v_bitop3_b32 v80, v80, v36, s18 bitop3:0xf6
s_waitcnt vmcnt(2)
v_mfma_f32_16x16x32_bf16 v[92:95], v[40:43], v[88:91], v[92:95]
v_bitop3_b32 v80, v80, v40, s18 bitop3:0xf6
s_waitcnt vmcnt(1)
v_mfma_f32_16x16x32_bf16 v[92:95], v[44:47], v[88:91], v[92:95]
v_bitop3_b32 v80, v80, v44, s18 bitop3:0xf6
v_and_b32 v80, 1, v80
v_cmp_ne_u32 vcc, 0, v80
s_cbranch_vccnz L_ch_p1rf
s_mov_b64 exec, s[32:33]
s_nop 2
v_cvt_pk_bf16_f32 v92, v92, v93
v_cvt_pk_bf16_f32 v93, v94, v95
global_store_dwordx2 v14, v[92:93], s[20:21]
global_store_dwordx2 v14, v[82:83], s[22:23]
s_mov_b64 exec, -1
s_mov_b32 s34, 0
s_barrier
global_load_dwordx4 v[16:19], v10, s[20:21] sc1
global_load_dwordx4 v[20:23], v10, s[20:21] offset:1024 sc1
ds_read_b128 v[96:99], v2 offset:20480
ds_read_b128 v[100:103], v2 offset:21504
ds_read_b128 v[104:107], v2 offset:22528
ds_read_b128 v[108:111], v2 offset:23552
ds_read_b128 v[112:115], v2 offset:24576
ds_read_b128 v[116:119], v2 offset:25600
ds_read_b128 v[120:123], v2 offset:26624
ds_read_b128 v[124:127], v2 offset:27648
ds_read_b128 v[48:51], v2 offset:28672
ds_read_b128 v[52:55], v2 offset:29696
ds_read_b128 v[56:59], v2 offset:30720
ds_read_b128 v[60:63], v2 offset:31744
v_mov_b64 v[64:65], 0
v_mov_b64 v[66:67], 0
v_mov_b64 v[68:69], 0
v_mov_b64 v[70:71], 0
v_mov_b64 v[72:73], 0
v_mov_b64 v[74:75], 0
v_mov_b64 v[76:77], 0
v_mov_b64 v[78:79], 0
v_mov_b64 v[88:89], v[128:129]
v_mov_b64 v[90:91], v[130:131]
v_mov_b64 v[92:93], v[132:133]
v_mov_b64 v[94:95], v[134:135]
v_mov_b64 v[80:81], v[136:137]
v_mov_b64 v[82:83], v[138:139]
v_mov_b64 v[84:85], v[142:143]
v_mov_b64 v[86:87], v[140:141]
L_ch_p2cf:
s_waitcnt lgkmcnt(0)
L_ch_p2f:
s_waitcnt vmcnt(1)
ds_write_b128 v10, v[16:19] offset:0
s_waitcnt vmcnt(0)
ds_write_b128 v10, v[20:23] offset:1024
v_max3_u32 v13, v16, v18, v20
v_max_u32 v13, v13, v22
v_cmp_eq_u32 vcc, -1, v13
s_cbranch_vccnz L_ch_p2rf
L_ch_topf:
v_smfmac_f32_16x16x64_bf16 v[64:67], v[16:19], v[96:103], v1
v_add_u32 v28, s46, v0
v_smfmac_f32_16x16x64_bf16 v[68:71], v[16:19], v[104:111], v1
v_add_u32 v36, s47, v0
v_smfmac_f32_16x16x64_bf16 v[64:67], v[20:23], v[112:119], v1
s_waitcnt lgkmcnt(0)
s_barrier
ds_read_b128 v[24:27], v28 offset:0
v_add_u32 v44, s48, v0
v_smfmac_f32_16x16x64_bf16 v[68:71], v[20:23], v[120:127], v1
s_add_u32 s24, s24, 524288
ds_read_b128 v[28:31], v28 offset:1024
v_smfmac_f32_16x16x64_bf16 v[72:75], v[16:19], v[48:55], v1
s_addc_u32 s25, s25, 0
ds_read_b128 v[32:35], v36 offset:0
v_smfmac_f32_16x16x64_bf16 v[76:79], v[16:19], v[56:63], v1
s_cmp_lt_i32 s10, s49
ds_read_b128 v[36:39], v36 offset:1024
v_smfmac_f32_16x16x64_bf16 v[72:75], v[20:23], a[96:103], v1
s_cbranch_scc0 L_ch_kvwf
L_ch_kvbf:
ds_read_b128 v[40:43], v44 offset:0
v_smfmac_f32_16x16x64_bf16 v[76:79], v[20:23], a[104:111], v1
s_waitcnt lgkmcnt(4)
ds_read_b128 v[44:47], v44 offset:1024
v_smfmac_f32_16x16x64_bf16 v[64:67], v[24:27], a[0:7], v1
s_waitcnt lgkmcnt(4)
global_load_dwordx4 v[128:131], v11, s[24:25] offset:0 sc1
v_smfmac_f32_16x16x64_bf16 v[64:67], v[28:31], a[16:23], v1
s_waitcnt lgkmcnt(3)
ds_read_b128 v[52:55], v15 offset:12288
v_smfmac_f32_16x16x64_bf16 v[64:67], v[32:35], a[32:39], v1
s_waitcnt lgkmcnt(3)
ds_read_b128 v[96:99], v2 offset:32768
v_smfmac_f32_16x16x64_bf16 v[64:67], v[36:39], a[48:55], v1
s_waitcnt lgkmcnt(3)
global_load_dwordx4 v[132:135], v11, s[24:25] offset:1024 sc1
v_smfmac_f32_16x16x64_bf16 v[64:67], v[40:43], a[64:71], v1
s_waitcnt lgkmcnt(2)
ds_read_b128 v[100:103], v2 offset:33792
v_smfmac_f32_16x16x64_bf16 v[64:67], v[44:47], a[80:87], v1
s_max_i32 s42, s10, 0
ds_read_b128 v[112:115], v2 offset:0
v_mov_b32 v13, s42
v_smfmac_f32_16x16x64_bf16 v[68:71], v[24:27], a[8:15], v1
s_add_u32 s10, s10, 1
global_load_dwordx4 v[136:139], v0, s[24:25] offset:2048 sc1
v_smfmac_f32_16x16x64_bf16 v[68:71], v[28:31], a[24:31], v1
s_add_u32 s35, s35, 1
ds_read_b128 v[116:119], v2 offset:1024
v_add_f32 v64, v64, v66
v_smfmac_f32_16x16x64_bf16 v[68:71], v[32:35], a[40:47], v1
s_and_b32 s18, s35, 1
ds_read_b128 v[104:107], v2 offset:34816
v_add_f32 v65, v65, v67
v_smfmac_f32_16x16x64_bf16 v[68:71], v[36:39], a[56:63], v1
global_load_dwordx4 v[140:143], v0, s[24:25] offset:3072 sc1
v_cvt_pk_bf16_f32 v48, v64, v65
v_smfmac_f32_16x16x64_bf16 v[68:71], v[40:43], a[72:79], v1
ds_read_b128 v[108:111], v2 offset:35840
v_mov_b64 v[64:65], 0
v_smfmac_f32_16x16x64_bf16 v[68:71], v[44:47], a[88:95], v1
s_waitcnt lgkmcnt(2)
ds_read_b128 v[120:123], v2 offset:2048
v_mov_b64 v[66:67], 0
v_smfmac_f32_16x16x64_bf16 v[72:75], v[24:27], v[96:103], v1
ds_read_b128 v[124:127], v2 offset:3072
v_smfmac_f32_16x16x64_bf16 v[72:75], v[28:31], v[112:119], v1
s_mov_b64 s[36:37], s[20:21]
ds_read_b128 v[96:99], v2 offset:4096
v_add_f32 v68, v68, v70
v_smfmac_f32_16x16x64_bf16 v[72:75], v[32:35], a[112:119], v1
s_mov_b64 s[20:21], s[22:23]
ds_read_b128 v[100:103], v2 offset:5120
v_add_f32 v69, v69, v71
v_smfmac_f32_16x16x64_bf16 v[72:75], v[36:39], a[128:135], v1
s_mov_b64 s[22:23], s[36:37]
global_store_dwordx4 v15, v[52:55], s[28:29] sc1
v_cvt_pk_bf16_f32 v49, v68, v69
v_smfmac_f32_16x16x64_bf16 v[72:75], v[40:43], a[144:151], v1
ds_write2_b32 v4, v48, v49 offset0:0 offset1:72
v_mov_b64 v[68:69], 0
v_smfmac_f32_16x16x64_bf16 v[72:75], v[44:47], a[160:167], v1
s_waitcnt lgkmcnt(3)
ds_read_b128 v[112:115], v2 offset:6144
v_mov_b64 v[70:71], 0
v_smfmac_f32_16x16x64_bf16 v[76:79], v[24:27], v[104:111], v1
ds_read_b128 v[116:119], v2 offset:7168
v_smfmac_f32_16x16x64_bf16 v[76:79], v[28:31], v[120:127], v1
buffer_store_dword v13, v0, s[52:55], 0 offen sc1
v_mov_b64 v[104:105], 0
v_smfmac_f32_16x16x64_bf16 v[76:79], v[32:35], a[120:127], v1
s_waitcnt lgkmcnt(2)
s_barrier
ds_read_b64_tr_b16 v[48:49], v5 offset:0
v_smfmac_f32_16x16x64_bf16 v[76:79], v[36:39], a[136:143], v1
s_add_u32 s28, s28, 0x20000
ds_read_b64_tr_b16 v[50:51], v5 offset:32
v_mov_b64 v[106:107], 0
v_smfmac_f32_16x16x64_bf16 v[76:79], v[40:43], a[152:159], v1
s_addc_u32 s29, s29, 0
ds_read_b64_tr_b16 v[52:53], v5 offset:576
v_add_f32 v72, v72, v74
v_smfmac_f32_16x16x64_bf16 v[76:79], v[44:47], a[168:175], v1
ds_read_b64_tr_b16 v[54:55], v5 offset:608
v_add_f32 v73, v73, v75
v_smfmac_f32_16x16x64_bf16 v[104:107], v[16:19], a[176:183], v1
ds_read_b64_tr_b16 v[56:57], v5 offset:1152
v_cvt_pk_bf16_f32 v74, v72, v73
v_smfmac_f32_16x16x64_bf16 v[104:107], v[20:23], a[192:199], v1
ds_read_b64_tr_b16 v[58:59], v5 offset:1184
v_add_f32 v76, v76, v78
v_smfmac_f32_16x16x64_bf16 v[104:107], v[24:27], a[208:215], v1
ds_read_b64_tr_b16 v[60:61], v5 offset:1728
v_add_f32 v77, v77, v79
v_smfmac_f32_16x16x64_bf16 v[104:107], v[28:31], a[224:231], v1
s_waitcnt lgkmcnt(3)
ds_read_b64_tr_b16 v[62:63], v5 offset:1760
v_cvt_pk_bf16_f32 v75, v76, v77
v_smfmac_f32_16x16x64_bf16 v[64:67], v[88:91], v[48:55], v1
ds_write_b64 v3, v[74:75] offset:12288
v_smfmac_f32_16x16x64_bf16 v[104:107], v[32:35], a[240:247], v1
ds_read_b128 v[120:123], v2 offset:18432
v_mov_b64 v[108:109], 0
v_smfmac_f32_16x16x64_bf16 v[104:107], v[36:39], v[144:151], v1
s_waitcnt lgkmcnt(2)
ds_read_b128 v[124:127], v2 offset:19456
v_mov_b64 v[110:111], 0
v_smfmac_f32_16x16x64_bf16 v[64:67], v[92:95], v[56:63], v1
v_smfmac_f32_16x16x64_bf16 v[104:107], v[40:43], v[160:167], v1
v_smfmac_f32_16x16x64_bf16 v[104:107], v[44:47], v[96:103], v1
s_waitcnt lgkmcnt(2)
s_barrier
ds_read_b64_tr_b16 v[72:73], v6 offset:0
ds_read_b64_tr_b16 v[74:75], v6 offset:256
v_add_f32 v64, v64, v66
v_smfmac_f32_16x16x64_bf16 v[108:111], v[16:19], a[184:191], v1
ds_read_b64_tr_b16 v[76:77], v6 offset:1024
ds_read_b64_tr_b16 v[78:79], v6 offset:1280
v_add_f32 v65, v65, v67
v_smfmac_f32_16x16x64_bf16 v[108:111], v[20:23], a[200:207], v1
ds_write_b64 v12, v[64:65] offset:0
v_add_f32 v104, v104, v106
v_smfmac_f32_16x16x64_bf16 v[108:111], v[24:27], a[216:223], v1
ds_read_b128 v[96:99], v2 offset:12288
v_add_f32 v105, v105, v107
v_smfmac_f32_16x16x64_bf16 v[108:111], v[28:31], a[232:239], v1
s_waitcnt lgkmcnt(4)
ds_read_b128 v[100:103], v2 offset:13312
v_cvt_pk_bf16_f32 v88, v104, v105
v_smfmac_f32_16x16x64_bf16 v[68:71], v[72:75], v[48:55], v1
s_waitcnt lgkmcnt(3)
v_smfmac_f32_16x16x64_bf16 v[68:71], v[76:79], v[56:63], v1
s_waitcnt lgkmcnt(2)
s_barrier
ds_read_b128 v[64:67], v0 offset:0
v_smfmac_f32_16x16x64_bf16 v[108:111], v[32:35], a[248:255], v1
v_mov_b64 v[48:49], 0
v_smfmac_f32_16x16x64_bf16 v[108:111], v[36:39], v[152:159], v1
v_add_f32 v68, v68, v70
v_smfmac_f32_16x16x64_bf16 v[108:111], v[40:43], v[168:175], v1
v_add_f32 v69, v69, v71
v_smfmac_f32_16x16x64_bf16 v[108:111], v[44:47], v[112:119], v1
s_waitcnt lgkmcnt(0)
v_max3_f32 v16, v64, v65, v68
v_max3_f32 v17, v66, v67, v69
v_max_f32 v16, v16, v17
v_mov_b64 v[50:51], 0
v_mov_b64 v[52:53], 0
v_max_f32_dpp v16, v16, v16 row_ror:8 row_mask:0xf bank_mask:0xf
v_mov_b32 v17, v16
v_add_f32 v108, v108, v110
v_add_f32 v109, v109, v111
v_permlane16_swap_b32 v16, v17
v_max_f32 v16, v16, v17
v_mov_b32 v17, v16
v_cvt_pk_bf16_f32 v89, v108, v109
v_mov_b64 v[54:55], 0
v_permlane32_swap_b32 v16, v17
v_max_f32 v16, v16, v17
v_mul_f32 v16, s30, v16
v_fma_f32 v68, v68, s30, -v16
v_fma_f32 v69, v69, s30, -v16
v_exp_f32 v68, v68
v_exp_f32 v69, v69
v_fma_f32 v64, v64, s30, -v16
v_cvt_pk_bf16_f32 v17, v68, v69
v_fma_f32 v65, v65, s30, -v16
v_cndmask_b32 v24, 0, v17, s[32:33]
v_cndmask_b32 v25, v17, 0, s[32:33]
v_fma_f32 v66, v66, s30, -v16
v_fma_f32 v67, v67, s30, -v16
v_mfma_f32_16x16x16_bf16 v[72:75], v[88:89], v[24:25], 0
v_exp_f32 v64, v64
v_exp_f32 v65, v65
v_exp_f32 v66, v66
v_exp_f32 v67, v67
v_cvt_pk_bf16_f32 v20, v64, v65
v_cvt_pk_bf16_f32 v21, v66, v67
v_add_f32 v17, v68, v69
v_mov_b32_dpp v22, v20 row_ror:8 row_mask:0xf bank_mask:0xf
v_mov_b32_dpp v23, v21 row_ror:8 row_mask:0xf bank_mask:0xf
v_add_f32 v18, v64, v65
v_add_f32 v19, v66, v67
v_mfma_f32_16x16x32_bf16 v[28:31], v[80:83], v[20:23], v[72:75]
v_fma_f32 v18, v17, 0.5, v18
v_add_f32 v18, v18, v19
v_mfma_f32_16x16x32_bf16 v[72:75], v[84:87], v[20:23], v[72:75]
v_mov_b64 v[56:57], 0
v_add_f32_dpp v18, v18, v18 row_ror:8 row_mask:0xf bank_mask:0xf
v_mov_b32 v17, v18
v_mov_b64 v[58:59], 0
v_mov_b64 v[60:61], 0
v_permlane16_swap_b32 v18, v17
v_add_f32 v18, v18, v17
v_mov_b32 v17, v18
v_cndmask_b32 v72, v72, v28, s[32:33]
v_cndmask_b32 v73, v73, v29, s[32:33]
v_permlane32_swap_b32 v18, v17
v_add_f32 v18, v18, v17
v_rcp_f32 v18, v18
v_cndmask_b32 v74, v74, v30, s[32:33]
v_cndmask_b32 v75, v75, v31, s[32:33]
v_pk_mul_f32 v[72:73], v[72:73], v[18:19] op_sel_hi:[1,0]
v_pk_mul_f32 v[74:75], v[74:75], v[18:19] op_sel_hi:[1,0]
v_cvt_pk_bf16_f32 v72, v72, v73
v_cvt_pk_bf16_f32 v73, v74, v75
ds_write_b64 v7, v[72:73] offset:2048
s_cmp_eq_u32 s10, 63
s_cbranch_scc1 L_ch_lastf
v_mov_b64 v[62:63], 0
s_waitcnt lgkmcnt(0)
s_barrier
ds_read_b128 v[32:35], v8 offset:2048
ds_read_b128 v[36:39], v8 offset:2560
ds_read_b128 v[40:43], v8 offset:3072
ds_read_b128 v[44:47], v8 offset:3584
s_waitcnt lgkmcnt(3)
v_smfmac_f32_16x16x64_bf16 v[48:51], v[32:35], v[176:183], v1
s_waitcnt lgkmcnt(2)
ds_read_b128 v[64:67], v2 offset:8192
v_smfmac_f32_16x16x64_bf16 v[48:51], v[36:39], v[184:191], v1
s_waitcnt lgkmcnt(2)
ds_read_b128 v[68:71], v2 offset:9216
v_smfmac_f32_16x16x64_bf16 v[48:51], v[40:43], v[192:199], v1
s_waitcnt lgkmcnt(2)
ds_read_b128 v[72:75], v2 offset:10240
v_smfmac_f32_16x16x64_bf16 v[48:51], v[44:47], v[200:207], v1
ds_read_b128 v[76:79], v2 offset:11264
v_smfmac_f32_16x16x64_bf16 v[52:55], v[32:35], v[208:215], v1
ds_read_b128 v[104:107], v2 offset:14336
v_smfmac_f32_16x16x64_bf16 v[52:55], v[36:39], v[216:223], v1
ds_read_b128 v[108:111], v2 offset:15360
v_cvt_pk_bf16_f32 v16, v48, v49
v_smfmac_f32_16x16x64_bf16 v[52:55], v[40:43], v[224:231], v1
ds_read_b128 v[112:115], v2 offset:16384
v_cvt_pk_bf16_f32 v17, v50, v51
v_smfmac_f32_16x16x64_bf16 v[52:55], v[44:47], v[232:239], v1
ds_read_b128 v[116:119], v2 offset:17408
v_and_or_b32 v16, v16, -2, s18
v_smfmac_f32_16x16x64_bf16 v[56:59], v[32:35], v[240:247], v1
ds_write_b64 v3, v[88:89] offset:14336
v_smfmac_f32_16x16x64_bf16 v[56:59], v[36:39], v[248:255], v1
s_waitcnt lgkmcnt(5)
ds_read_b128 v[88:91], v0 offset:11264
v_cvt_pk_bf16_f32 v18, v52, v53
v_smfmac_f32_16x16x64_bf16 v[56:59], v[40:43], v[64:71], v1
v_cvt_pk_bf16_f32 v19, v54, v55
v_smfmac_f32_16x16x64_bf16 v[56:59], v[44:47], v[72:79], v1
s_waitcnt lgkmcnt(2)
global_store_dwordx4 v9, v[16:19], s[12:13]
v_smfmac_f32_16x16x64_bf16 v[60:63], v[32:35], v[96:103], v1
v_smfmac_f32_16x16x64_bf16 v[60:63], v[36:39], v[104:111], v1
v_cvt_pk_bf16_f32 v20, v56, v57
v_smfmac_f32_16x16x64_bf16 v[60:63], v[40:43], v[112:119], v1
v_cvt_pk_bf16_f32 v21, v58, v59
v_smfmac_f32_16x16x64_bf16 v[60:63], v[44:47], v[120:127], v1
s_cmp_lg_u32 s9, 0
v_and_or_b32 v20, v20, -2, s18
s_nop 5
v_cvt_pk_bf16_f32 v22, v60, v61
v_cvt_pk_bf16_f32 v23, v62, v63
global_store_dwordx4 v9, v[20:23], s[14:15]
s_cbranch_scc1 L_ch_nrf
s_branch L_ch_commf
L_ch_lastf:
ds_write_b64 v3, v[88:89] offset:14336
s_waitcnt lgkmcnt(0)
s_barrier
ds_read_b128 v[52:55], v15 offset:12288
s_waitcnt lgkmcnt(0)
global_store_dwordx4 v15, v[52:55], s[28:29] sc1
s_mov_b64 s[36:37], s[20:21]
s_mov_b64 s[20:21], s[22:23]
s_mov_b64 s[22:23], s[36:37]
s_sub_u32 s35, s35, 1
s_waitcnt vmcnt(0) lgkmcnt(0)
v_mov_b32 v13, 64
buffer_store_dword v13, v0, s[52:55], 0 offen sc1
s_barrier
s_add_u32 s4, s4, 134217728
s_addc_u32 s5, s5, 0
s_add_u32 s11, s11, 1
s_cmp_lt_u32 s11, 2
s_cbranch_scc1 L_chain_f
s_branch L_done
L_chain_s:
s_load_dwordx2 s[50:51], s[0:1], 32
s_lshl_b32 s36, s8, 14
s_lshl_b32 s37, s9, 12
s_add_u32 s36, s36, s37
s_add_u32 s37, s36, 25165824
s_add_u32 s24, s4, s37
s_addc_u32 s25, s5, 0
s_lshl_b32 s36, s8, 12
s_add_u32 s36, s36, 12451840
s_add_u32 s28, s4, s36
s_addc_u32 s29, s5, 0
s_mov_b32 s10, -1
v_and_b32 v34, 0x70, v8
v_lshlrev_b32 v34, 6, v34
v_bfe_u32 v35, v0, 8, 2
v_lshl_add_u32 v34, v35, 5, v34
v_bfe_u32 v35, v0, 5, 1
v_lshl_add_u32 v34, v35, 4, v34
s_lshl_b32 s36, s9, 8
v_add_u32 v34, s36, v34
s_waitcnt lgkmcnt(0)
global_load_dwordx4 v[16:19], v34, s[50:51]
global_load_dwordx4 v[20:23], v34, s[50:51] offset:128
s_lshl_b32 s36, s8, 10
s_add_u32 s36, s36, 1081344
s_add_u32 s56, s4, s36
s_addc_u32 s57, s5, 0
s_lshl_b32 s36, s9, 2
s_add_u32 s36, s36, 768
s_add_u32 s52, s56, s36
s_addc_u32 s53, s57, 0
s_mov_b32 s54, 4
s_mov_b32 s55, 0x20000
s_mov_b32 s34, 0
s_mov_b64 exec, 15
v_lshlrev_b32 v132, 3, v0
L_kvr_3:
global_load_dwordx4 v[128:131], v132, s[56:57] sc1
s_add_u32 s34, s34, 1
s_cmp_gt_u32 s34, 400000
s_cbranch_scc1 L_fail
s_waitcnt vmcnt(0)
v_min3_u32 v128, v128, v129, v130
v_min_u32 v128, v128, v131
s_nop 0
v_readlane_b32 s36, v128, 0
v_readlane_b32 s37, v128, 1
v_readlane_b32 s38, v128, 2
v_readlane_b32 s39, v128, 3
s_min_u32 s36, s36, s37
s_min_u32 s38, s38, s39
s_min_u32 s36, s36, s38
s_lshl_b32 s49, s36, 2
s_sub_u32 s49, s49, 2
s_cmp_eq_u32 s36, 16
s_cselect_b32 s49, 100, s49
s_cmp_lt_i32 s10, s49
s_cbranch_scc0 L_kvr_3
s_mov_b64 exec, -1
ds_read_b128 v[96:99], v2 offset:20480
ds_read_b128 v[100:103], v2 offset:21504
ds_read_b128 v[104:107], v2 offset:22528
ds_read_b128 v[108:111], v2 offset:23552
ds_read_b128 v[112:115], v2 offset:24576
ds_read_b128 v[116:119], v2 offset:25600
ds_read_b128 v[120:123], v2 offset:26624
ds_read_b128 v[124:127], v2 offset:27648
ds_read_b128 v[48:51], v2 offset:28672
ds_read_b128 v[52:55], v2 offset:29696
ds_read_b128 v[56:59], v2 offset:30720
ds_read_b128 v[60:63], v2 offset:31744
v_mov_b64 v[64:65], 0
v_mov_b64 v[66:67], 0
v_mov_b64 v[68:69], 0
v_mov_b64 v[70:71], 0
v_mov_b64 v[72:73], 0
v_mov_b64 v[74:75], 0
v_mov_b64 v[76:77], 0
v_mov_b64 v[78:79], 0
global_load_dwordx4 v[128:131], v11, s[24:25] offset:0 sc1
global_load_dwordx4 v[132:135], v11, s[24:25] offset:1024 sc1
global_load_dwordx4 v[136:139], v0, s[24:25] offset:2048 sc1
global_load_dwordx4 v[140:143], v0, s[24:25] offset:3072 sc1
s_waitcnt vmcnt(0) lgkmcnt(0)
v_mov_b64 v[88:89], v[128:129]
v_mov_b64 v[90:91], v[130:131]
v_mov_b64 v[92:93], v[132:133]
v_mov_b64 v[94:95], v[134:135]
v_mov_b64 v[80:81], v[136:137]
v_mov_b64 v[82:83], v[138:139]
v_mov_b64 v[84:85], v[142:143]
v_mov_b64 v[86:87], v[140:141]
s_waitcnt lgkmcnt(0)
ds_write_b128 v10, v[16:19] offset:0
ds_write_b128 v10, v[20:23] offset:1024
s_branch L_ch_tops
L_ch_p1rs:
s_mov_b64 exec, 1
global_store_dword v84, v82, s[26:27] sc1
s_mov_b64 exec, -1
s_add_u32 s34, s34, 1
s_cmp_gt_u32 s34, 400000
s_cbranch_scc1 L_fail
global_load_dwordx4 v[16:19], v0, s[16:17] offset:-4096 sc1
global_load_dwordx4 v[20:23], v0, s[16:17] offset:-3072 sc1
global_load_dwordx4 v[24:27], v0, s[16:17] offset:-2048 sc1
global_load_dwordx4 v[28:31], v0, s[16:17] offset:-1024 sc1
global_load_dwordx4 v[32:35], v0, s[16:17] offset:0 sc1
global_load_dwordx4 v[36:39], v0, s[16:17] offset:1024 sc1
global_load_dwordx4 v[40:43], v0, s[16:17] offset:2048 sc1
global_load_dwordx4 v[44:47], v0, s[16:17] offset:3072 sc1
s_branch L_ch_p1bs
L_ch_p2rs:
s_mov_b64 s[42:43], vcc
v_bfe_u32 v24, v0, 2, 7
v_mov_b32 v25, -1
s_mov_b32 exec_hi, 0
s_mov_b32 exec_lo, s19
L_ch_p2ws:
global_load_dword v25, v24, s[26:27] sc1
s_add_u32 s34, s34, 1
s_cmp_gt_u32 s34, 400000
s_cbranch_scc1 L_fail
s_waitcnt vmcnt(40)
v_cmp_ne_u32 vcc, s35, v25
s_cbranch_vccnz L_ch_p2ws
s_mov_b64 exec, -1
s_mov_b64 exec, s[42:43]
global_load_dwordx4 v[16:19], v10, s[20:21] sc1
global_load_dwordx4 v[20:23], v10, s[20:21] offset:1024 sc1
s_mov_b64 exec, -1
s_branch L_ch_p2s
L_ch_kvws:
s_mov_b32 s34, 0
s_mov_b64 exec, 15
v_lshlrev_b32 v132, 3, v0
L_kvr_4:
global_load_dwordx4 v[128:131], v132, s[56:57] sc1
s_add_u32 s34, s34, 1
s_cmp_gt_u32 s34, 400000
s_cbranch_scc1 L_fail
s_waitcnt vmcnt(0)
v_min3_u32 v128, v128, v129, v130
v_min_u32 v128, v128, v131
s_nop 0
v_readlane_b32 s36, v128, 0
v_readlane_b32 s37, v128, 1
v_readlane_b32 s38, v128, 2
v_readlane_b32 s39, v128, 3
s_min_u32 s36, s36, s37
s_min_u32 s38, s38, s39
s_min_u32 s36, s36, s38
s_lshl_b32 s49, s36, 2
s_sub_u32 s49, s49, 2
s_cmp_eq_u32 s36, 16
s_cselect_b32 s49, 100, s49
s_cmp_lt_i32 s10, s49
s_cbranch_scc0 L_kvr_4
s_mov_b64 exec, -1
s_branch L_ch_kvbs
L_ch_nrs:
ds_read_b128 v[96:99], v2 offset:20480
ds_read_b128 v[100:103], v2 offset:21504
ds_read_b128 v[104:107], v2 offset:22528
ds_read_b128 v[108:111], v2 offset:23552
ds_read_b128 v[112:115], v2 offset:24576
ds_read_b128 v[116:119], v2 offset:25600
ds_read_b128 v[120:123], v2 offset:26624
ds_read_b128 v[124:127], v2 offset:27648
ds_read_b128 v[48:51], v2 offset:28672
ds_read_b128 v[52:55], v2 offset:29696
ds_read_b128 v[56:59], v2 offset:30720
ds_read_b128 v[60:63], v2 offset:31744
v_mov_b64 v[64:65], 0
v_mov_b64 v[66:67], 0
v_mov_b64 v[68:69], 0
v_mov_b64 v[70:71], 0
v_mov_b64 v[72:73], 0
v_mov_b64 v[74:75], 0
v_mov_b64 v[76:77], 0
v_mov_b64 v[78:79], 0
s_waitcnt vmcnt(2) lgkmcnt(12)
v_mov_b64 v[88:89], v[128:129]
v_mov_b64 v[90:91], v[130:131]
v_mov_b64 v[92:93], v[132:133]
v_mov_b64 v[94:95], v[134:135]
v_mov_b64 v[80:81], v[136:137]
v_mov_b64 v[82:83], v[138:139]
v_mov_b64 v[84:85], v[142:143]
v_mov_b64 v[86:87], v[140:141]
s_mov_b32 s34, 0
s_cmp_eq_u32 s9, 1
s_cbranch_scc0 L_ch_nbs
v_bfe_u32 v24, v0, 2, 7
v_mov_b32 v25, -1
s_mov_b32 exec_hi, 0
s_mov_b32 exec_lo, s19
L_ch_pfs:
global_load_dword v25, v24, s[26:27] sc1
s_add_u32 s34, s34, 1
s_cmp_gt_u32 s34, 400000
s_cbranch_scc1 L_fail
s_waitcnt vmcnt(40)
v_cmp_ne_u32 vcc, s35, v25
s_cbranch_vccnz L_ch_pfs
s_mov_b64 exec, -1
L_ch_nbs:
s_barrier
global_load_dwordx4 v[16:19], v10, s[20:21] sc1
global_load_dwordx4 v[20:23], v10, s[20:21] offset:1024 sc1
s_mov_b32 s34, 0
s_branch L_ch_p2cs
L_ch_comms:
s_nop 15
s_nop 15
s_nop 15
s_nop 15
s_nop 15
global_load_dwordx4 v[16:19], v0, s[16:17] offset:-4096 sc1
global_load_dwordx4 v[20:23], v0, s[16:17] offset:-3072 sc1
global_load_dwordx4 v[24:27], v0, s[16:17] offset:-2048 sc1
global_load_dwordx4 v[28:31], v0, s[16:17] offset:-1024 sc1
global_load_dwordx4 v[32:35], v0, s[16:17] offset:0 sc1
global_load_dwordx4 v[36:39], v0, s[16:17] offset:1024 sc1
global_load_dwordx4 v[40:43], v0, s[16:17] offset:2048 sc1
global_load_dwordx4 v[44:47], v0, s[16:17] offset:3072 sc1
s_lshl_b32 s36, s8, 2
v_mov_b32 v84, s36
v_mov_b32 v85, s35
v_mov_b64 v[82:83], -1
s_mov_b32 s34, 0
s_waitcnt lgkmcnt(0)
L_ch_p1bs:
s_nop 9
s_mov_b64 exec, 1
global_store_dword v84, v85, s[26:27] sc1
s_mov_b64 exec, -1
s_waitcnt vmcnt(8)
v_mfma_f32_16x16x32_bf16 v[92:95], v[16:19], v[88:91], 0
v_xor_b32 v80, s18, v16
s_waitcnt vmcnt(7)
v_mfma_f32_16x16x32_bf16 v[92:95], v[20:23], v[88:91], v[92:95]
v_bitop3_b32 v80, v80, v20, s18 bitop3:0xf6
s_waitcnt vmcnt(6)
v_mfma_f32_16x16x32_bf16 v[92:95], v[24:27], v[88:91], v[92:95]
v_bitop3_b32 v80, v80, v24, s18 bitop3:0xf6
s_waitcnt vmcnt(5)
v_mfma_f32_16x16x32_bf16 v[92:95], v[28:31], v[88:91], v[92:95]
v_bitop3_b32 v80, v80, v28, s18 bitop3:0xf6
s_waitcnt vmcnt(4)
v_mfma_f32_16x16x32_bf16 v[92:95], v[32:35], v[88:91], v[92:95]
v_bitop3_b32 v80, v80, v32, s18 bitop3:0xf6
s_waitcnt vmcnt(3)
v_mfma_f32_16x16x32_bf16 v[92:95], v[36:39], v[88:91], v[92:95]
v_bitop3_b32 v80, v80, v36, s18 bitop3:0xf6
s_waitcnt vmcnt(2)
v_mfma_f32_16x16x32_bf16 v[92:95], v[40:43], v[88:91], v[92:95]
v_bitop3_b32 v80, v80, v40, s18 bitop3:0xf6
s_waitcnt vmcnt(1)
v_mfma_f32_16x16x32_bf16 v[92:95], v[44:47], v[88:91], v[92:95]
v_bitop3_b32 v80, v80, v44, s18 bitop3:0xf6
v_and_b32 v80, 1, v80
v_cmp_ne_u32 vcc, 0, v80
s_cbranch_vccnz L_ch_p1rs
s_mov_b64 exec, s[32:33]
s_nop 2
v_cvt_pk_bf16_f32 v92, v92, v93
v_cvt_pk_bf16_f32 v93, v94, v95
global_store_dwordx2 v14, v[92:93], s[20:21] sc1
global_store_dwordx2 v14, v[82:83], s[22:23] sc1
s_mov_b64 exec, -1
s_mov_b32 s34, 0
s_barrier
global_load_dwordx4 v[16:19], v10, s[20:21] sc1
global_load_dwordx4 v[20:23], v10, s[20:21] offset:1024 sc1
ds_read_b128 v[96:99], v2 offset:20480
ds_read_b128 v[100:103], v2 offset:21504
ds_read_b128 v[104:107], v2 offset:22528
ds_read_b128 v[108:111], v2 offset:23552
ds_read_b128 v[112:115], v2 offset:24576
ds_read_b128 v[116:119], v2 offset:25600
ds_read_b128 v[120:123], v2 offset:26624
ds_read_b128 v[124:127], v2 offset:27648
ds_read_b128 v[48:51], v2 offset:28672
ds_read_b128 v[52:55], v2 offset:29696
ds_read_b128 v[56:59], v2 offset:30720
ds_read_b128 v[60:63], v2 offset:31744
v_mov_b64 v[64:65], 0
v_mov_b64 v[66:67], 0
v_mov_b64 v[68:69], 0
v_mov_b64 v[70:71], 0
v_mov_b64 v[72:73], 0
v_mov_b64 v[74:75], 0
v_mov_b64 v[76:77], 0
v_mov_b64 v[78:79], 0
v_mov_b64 v[88:89], v[128:129]
v_mov_b64 v[90:91], v[130:131]
v_mov_b64 v[92:93], v[132:133]
v_mov_b64 v[94:95], v[134:135]
v_mov_b64 v[80:81], v[136:137]
v_mov_b64 v[82:83], v[138:139]
v_mov_b64 v[84:85], v[142:143]
v_mov_b64 v[86:87], v[140:141]
L_ch_p2cs:
s_waitcnt lgkmcnt(0)
L_ch_p2s:
s_waitcnt vmcnt(1)
ds_write_b128 v10, v[16:19] offset:0
s_waitcnt vmcnt(0)
ds_write_b128 v10, v[20:23] offset:1024
v_max3_u32 v13, v16, v18, v20
v_max_u32 v13, v13, v22
v_cmp_eq_u32 vcc, -1, v13
s_cbranch_vccnz L_ch_p2rs
L_ch_tops:
v_smfmac_f32_16x16x64_bf16 v[64:67], v[16:19], v[96:103], v1
v_add_u32 v28, s46, v0
v_smfmac_f32_16x16x64_bf16 v[68:71], v[16:19], v[104:111], v1
v_add_u32 v36, s47, v0
v_smfmac_f32_16x16x64_bf16 v[64:67], v[20:23], v[112:119], v1
s_waitcnt lgkmcnt(0)
s_barrier
ds_read_b128 v[24:27], v28 offset:0
v_add_u32 v44, s48, v0
v_smfmac_f32_16x16x64_bf16 v[68:71], v[20:23], v[120:127], v1
s_add_u32 s24, s24, 524288
ds_read_b128 v[28:31], v28 offset:1024
v_smfmac_f32_16x16x64_bf16 v[72:75], v[16:19], v[48:55], v1
s_addc_u32 s25, s25, 0
ds_read_b128 v[32:35], v36 offset:0
v_smfmac_f32_16x16x64_bf16 v[76:79], v[16:19], v[56:63], v1
s_cmp_lt_i32 s10, s49
ds_read_b128 v[36:39], v36 offset:1024
v_smfmac_f32_16x16x64_bf16 v[72:75], v[20:23], a[96:103], v1
s_cbranch_scc0 L_ch_kvws
L_ch_kvbs:
ds_read_b128 v[40:43], v44 offset:0
v_smfmac_f32_16x16x64_bf16 v[76:79], v[20:23], a[104:111], v1
s_waitcnt lgkmcnt(4)
ds_read_b128 v[44:47], v44 offset:1024
v_smfmac_f32_16x16x64_bf16 v[64:67], v[24:27], a[0:7], v1
s_waitcnt lgkmcnt(4)
global_load_dwordx4 v[128:131], v11, s[24:25] offset:0 sc1
v_smfmac_f32_16x16x64_bf16 v[64:67], v[28:31], a[16:23], v1
s_waitcnt lgkmcnt(3)
ds_read_b128 v[52:55], v15 offset:12288
v_smfmac_f32_16x16x64_bf16 v[64:67], v[32:35], a[32:39], v1
s_waitcnt lgkmcnt(3)
ds_read_b128 v[96:99], v2 offset:32768
v_smfmac_f32_16x16x64_bf16 v[64:67], v[36:39], a[48:55], v1
s_waitcnt lgkmcnt(3)
global_load_dwordx4 v[132:135], v11, s[24:25] offset:1024 sc1
v_smfmac_f32_16x16x64_bf16 v[64:67], v[40:43], a[64:71], v1
s_waitcnt lgkmcnt(2)
ds_read_b128 v[100:103], v2 offset:33792
v_smfmac_f32_16x16x64_bf16 v[64:67], v[44:47], a[80:87], v1
s_max_i32 s42, s10, 0
ds_read_b128 v[112:115], v2 offset:0
v_mov_b32 v13, s42
v_smfmac_f32_16x16x64_bf16 v[68:71], v[24:27], a[8:15], v1
s_add_u32 s10, s10, 1
global_load_dwordx4 v[136:139], v0, s[24:25] offset:2048 sc1
v_smfmac_f32_16x16x64_bf16 v[68:71], v[28:31], a[24:31], v1
s_add_u32 s35, s35, 1
ds_read_b128 v[116:119], v2 offset:1024
v_add_f32 v64, v64, v66
v_smfmac_f32_16x16x64_bf16 v[68:71], v[32:35], a[40:47], v1
s_and_b32 s18, s35, 1
ds_read_b128 v[104:107], v2 offset:34816
v_add_f32 v65, v65, v67
v_smfmac_f32_16x16x64_bf16 v[68:71], v[36:39], a[56:63], v1
global_load_dwordx4 v[140:143], v0, s[24:25] offset:3072 sc1
v_cvt_pk_bf16_f32 v48, v64, v65
v_smfmac_f32_16x16x64_bf16 v[68:71], v[40:43], a[72:79], v1
ds_read_b128 v[108:111], v2 offset:35840
v_mov_b64 v[64:65], 0
v_smfmac_f32_16x16x64_bf16 v[68:71], v[44:47], a[88:95], v1
s_waitcnt lgkmcnt(2)
ds_read_b128 v[120:123], v2 offset:2048
v_mov_b64 v[66:67], 0
v_smfmac_f32_16x16x64_bf16 v[72:75], v[24:27], v[96:103], v1
ds_read_b128 v[124:127], v2 offset:3072
v_smfmac_f32_16x16x64_bf16 v[72:75], v[28:31], v[112:119], v1
s_mov_b64 s[36:37], s[20:21]
ds_read_b128 v[96:99], v2 offset:4096
v_add_f32 v68, v68, v70
v_smfmac_f32_16x16x64_bf16 v[72:75], v[32:35], a[112:119], v1
s_mov_b64 s[20:21], s[22:23]
ds_read_b128 v[100:103], v2 offset:5120
v_add_f32 v69, v69, v71
v_smfmac_f32_16x16x64_bf16 v[72:75], v[36:39], a[128:135], v1
s_mov_b64 s[22:23], s[36:37]
global_store_dwordx4 v15, v[52:55], s[28:29] sc1
v_cvt_pk_bf16_f32 v49, v68, v69
v_smfmac_f32_16x16x64_bf16 v[72:75], v[40:43], a[144:151], v1
ds_write2_b32 v4, v48, v49 offset0:0 offset1:72
v_mov_b64 v[68:69], 0
v_smfmac_f32_16x16x64_bf16 v[72:75], v[44:47], a[160:167], v1
s_waitcnt lgkmcnt(3)
ds_read_b128 v[112:115], v2 offset:6144
v_mov_b64 v[70:71], 0
v_smfmac_f32_16x16x64_bf16 v[76:79], v[24:27], v[104:111], v1
ds_read_b128 v[116:119], v2 offset:7168
v_smfmac_f32_16x16x64_bf16 v[76:79], v[28:31], v[120:127], v1
buffer_store_dword v13, v0, s[52:55], 0 offen sc1
v_mov_b64 v[104:105], 0
v_smfmac_f32_16x16x64_bf16 v[76:79], v[32:35], a[120:127], v1
s_waitcnt lgkmcnt(2)
s_barrier
ds_read_b64_tr_b16 v[48:49], v5 offset:0
v_smfmac_f32_16x16x64_bf16 v[76:79], v[36:39], a[136:143], v1
s_add_u32 s28, s28, 0x20000
ds_read_b64_tr_b16 v[50:51], v5 offset:32
v_mov_b64 v[106:107], 0
v_smfmac_f32_16x16x64_bf16 v[76:79], v[40:43], a[152:159], v1
s_addc_u32 s29, s29, 0
ds_read_b64_tr_b16 v[52:53], v5 offset:576
v_add_f32 v72, v72, v74
v_smfmac_f32_16x16x64_bf16 v[76:79], v[44:47], a[168:175], v1
ds_read_b64_tr_b16 v[54:55], v5 offset:608
v_add_f32 v73, v73, v75
v_smfmac_f32_16x16x64_bf16 v[104:107], v[16:19], a[176:183], v1
ds_read_b64_tr_b16 v[56:57], v5 offset:1152
v_cvt_pk_bf16_f32 v74, v72, v73
v_smfmac_f32_16x16x64_bf16 v[104:107], v[20:23], a[192:199], v1
ds_read_b64_tr_b16 v[58:59], v5 offset:1184
v_add_f32 v76, v76, v78
v_smfmac_f32_16x16x64_bf16 v[104:107], v[24:27], a[208:215], v1
ds_read_b64_tr_b16 v[60:61], v5 offset:1728
v_add_f32 v77, v77, v79
v_smfmac_f32_16x16x64_bf16 v[104:107], v[28:31], a[224:231], v1
s_waitcnt lgkmcnt(3)
ds_read_b64_tr_b16 v[62:63], v5 offset:1760
v_cvt_pk_bf16_f32 v75, v76, v77
v_smfmac_f32_16x16x64_bf16 v[64:67], v[88:91], v[48:55], v1
ds_write_b64 v3, v[74:75] offset:12288
v_smfmac_f32_16x16x64_bf16 v[104:107], v[32:35], a[240:247], v1
ds_read_b128 v[120:123], v2 offset:18432
v_mov_b64 v[108:109], 0
v_smfmac_f32_16x16x64_bf16 v[104:107], v[36:39], v[144:151], v1
s_waitcnt lgkmcnt(2)
ds_read_b128 v[124:127], v2 offset:19456
v_mov_b64 v[110:111], 0
v_smfmac_f32_16x16x64_bf16 v[64:67], v[92:95], v[56:63], v1
v_smfmac_f32_16x16x64_bf16 v[104:107], v[40:43], v[160:167], v1
v_smfmac_f32_16x16x64_bf16 v[104:107], v[44:47], v[96:103], v1
s_waitcnt lgkmcnt(2)
s_barrier
ds_read_b64_tr_b16 v[72:73], v6 offset:0
ds_read_b64_tr_b16 v[74:75], v6 offset:256
v_add_f32 v64, v64, v66
v_smfmac_f32_16x16x64_bf16 v[108:111], v[16:19], a[184:191], v1
ds_read_b64_tr_b16 v[76:77], v6 offset:1024
ds_read_b64_tr_b16 v[78:79], v6 offset:1280
v_add_f32 v65, v65, v67
v_smfmac_f32_16x16x64_bf16 v[108:111], v[20:23], a[200:207], v1
ds_write_b64 v12, v[64:65] offset:0
v_add_f32 v104, v104, v106
v_smfmac_f32_16x16x64_bf16 v[108:111], v[24:27], a[216:223], v1
ds_read_b128 v[96:99], v2 offset:12288
v_add_f32 v105, v105, v107
v_smfmac_f32_16x16x64_bf16 v[108:111], v[28:31], a[232:239], v1
s_waitcnt lgkmcnt(4)
ds_read_b128 v[100:103], v2 offset:13312
v_cvt_pk_bf16_f32 v88, v104, v105
v_smfmac_f32_16x16x64_bf16 v[68:71], v[72:75], v[48:55], v1
s_waitcnt lgkmcnt(3)
v_smfmac_f32_16x16x64_bf16 v[68:71], v[76:79], v[56:63], v1
s_waitcnt lgkmcnt(2)
s_barrier
ds_read_b128 v[64:67], v0 offset:0
v_smfmac_f32_16x16x64_bf16 v[108:111], v[32:35], a[248:255], v1
v_mov_b64 v[48:49], 0
v_smfmac_f32_16x16x64_bf16 v[108:111], v[36:39], v[152:159], v1
v_add_f32 v68, v68, v70
v_smfmac_f32_16x16x64_bf16 v[108:111], v[40:43], v[168:175], v1
v_add_f32 v69, v69, v71
v_smfmac_f32_16x16x64_bf16 v[108:111], v[44:47], v[112:119], v1
s_waitcnt lgkmcnt(0)
v_max3_f32 v16, v64, v65, v68
v_max3_f32 v17, v66, v67, v69
v_max_f32 v16, v16, v17
v_mov_b64 v[50:51], 0
v_mov_b64 v[52:53], 0
v_max_f32_dpp v16, v16, v16 row_ror:8 row_mask:0xf bank_mask:0xf
v_mov_b32 v17, v16
v_add_f32 v108, v108, v110
v_add_f32 v109, v109, v111
v_permlane16_swap_b32 v16, v17
v_max_f32 v16, v16, v17
v_mov_b32 v17, v16
v_cvt_pk_bf16_f32 v89, v108, v109
v_mov_b64 v[54:55], 0
v_permlane32_swap_b32 v16, v17
v_max_f32 v16, v16, v17
v_mul_f32 v16, s30, v16
v_fma_f32 v68, v68, s30, -v16
v_fma_f32 v69, v69, s30, -v16
v_exp_f32 v68, v68
v_exp_f32 v69, v69
v_fma_f32 v64, v64, s30, -v16
v_cvt_pk_bf16_f32 v17, v68, v69
v_fma_f32 v65, v65, s30, -v16
v_cndmask_b32 v24, 0, v17, s[32:33]
v_cndmask_b32 v25, v17, 0, s[32:33]
v_fma_f32 v66, v66, s30, -v16
v_fma_f32 v67, v67, s30, -v16
v_mfma_f32_16x16x16_bf16 v[72:75], v[88:89], v[24:25], 0
v_exp_f32 v64, v64
v_exp_f32 v65, v65
v_exp_f32 v66, v66
v_exp_f32 v67, v67
v_cvt_pk_bf16_f32 v20, v64, v65
v_cvt_pk_bf16_f32 v21, v66, v67
v_add_f32 v17, v68, v69
v_mov_b32_dpp v22, v20 row_ror:8 row_mask:0xf bank_mask:0xf
v_mov_b32_dpp v23, v21 row_ror:8 row_mask:0xf bank_mask:0xf
v_add_f32 v18, v64, v65
v_add_f32 v19, v66, v67
v_mfma_f32_16x16x32_bf16 v[28:31], v[80:83], v[20:23], v[72:75]
v_fma_f32 v18, v17, 0.5, v18
v_add_f32 v18, v18, v19
v_mfma_f32_16x16x32_bf16 v[72:75], v[84:87], v[20:23], v[72:75]
v_mov_b64 v[56:57], 0
v_add_f32_dpp v18, v18, v18 row_ror:8 row_mask:0xf bank_mask:0xf
v_mov_b32 v17, v18
v_mov_b64 v[58:59], 0
v_mov_b64 v[60:61], 0
v_permlane16_swap_b32 v18, v17
v_add_f32 v18, v18, v17
v_mov_b32 v17, v18
v_cndmask_b32 v72, v72, v28, s[32:33]
v_cndmask_b32 v73, v73, v29, s[32:33]
v_permlane32_swap_b32 v18, v17
v_add_f32 v18, v18, v17
v_rcp_f32 v18, v18
v_cndmask_b32 v74, v74, v30, s[32:33]
v_cndmask_b32 v75, v75, v31, s[32:33]
v_pk_mul_f32 v[72:73], v[72:73], v[18:19] op_sel_hi:[1,0]
v_pk_mul_f32 v[74:75], v[74:75], v[18:19] op_sel_hi:[1,0]
v_cvt_pk_bf16_f32 v72, v72, v73
v_cvt_pk_bf16_f32 v73, v74, v75
ds_write_b64 v7, v[72:73] offset:2048
s_cmp_eq_u32 s10, 63
s_cbranch_scc1 L_ch_lasts
v_mov_b64 v[62:63], 0
s_waitcnt lgkmcnt(0)
s_barrier
ds_read_b128 v[32:35], v8 offset:2048
ds_read_b128 v[36:39], v8 offset:2560
ds_read_b128 v[40:43], v8 offset:3072
ds_read_b128 v[44:47], v8 offset:3584
s_waitcnt lgkmcnt(3)
v_smfmac_f32_16x16x64_bf16 v[48:51], v[32:35], v[176:183], v1
s_waitcnt lgkmcnt(2)
ds_read_b128 v[64:67], v2 offset:8192
v_smfmac_f32_16x16x64_bf16 v[48:51], v[36:39], v[184:191], v1
s_waitcnt lgkmcnt(2)
ds_read_b128 v[68:71], v2 offset:9216
v_smfmac_f32_16x16x64_bf16 v[48:51], v[40:43], v[192:199], v1
s_waitcnt lgkmcnt(2)
ds_read_b128 v[72:75], v2 offset:10240
v_smfmac_f32_16x16x64_bf16 v[48:51], v[44:47], v[200:207], v1
ds_read_b128 v[76:79], v2 offset:11264
v_smfmac_f32_16x16x64_bf16 v[52:55], v[32:35], v[208:215], v1
ds_read_b128 v[104:107], v2 offset:14336
v_smfmac_f32_16x16x64_bf16 v[52:55], v[36:39], v[216:223], v1
ds_read_b128 v[108:111], v2 offset:15360
v_cvt_pk_bf16_f32 v16, v48, v49
v_smfmac_f32_16x16x64_bf16 v[52:55], v[40:43], v[224:231], v1
ds_read_b128 v[112:115], v2 offset:16384
v_cvt_pk_bf16_f32 v17, v50, v51
v_smfmac_f32_16x16x64_bf16 v[52:55], v[44:47], v[232:239], v1
ds_read_b128 v[116:119], v2 offset:17408
v_and_or_b32 v16, v16, -2, s18
v_smfmac_f32_16x16x64_bf16 v[56:59], v[32:35], v[240:247], v1
ds_write_b64 v3, v[88:89] offset:14336
v_smfmac_f32_16x16x64_bf16 v[56:59], v[36:39], v[248:255], v1
s_waitcnt lgkmcnt(5)
ds_read_b128 v[88:91], v0 offset:11264
v_cvt_pk_bf16_f32 v18, v52, v53
v_smfmac_f32_16x16x64_bf16 v[56:59], v[40:43], v[64:71], v1
v_cvt_pk_bf16_f32 v19, v54, v55
v_smfmac_f32_16x16x64_bf16 v[56:59], v[44:47], v[72:79], v1
s_waitcnt lgkmcnt(2)
global_store_dwordx4 v9, v[16:19], s[12:13] sc1
v_smfmac_f32_16x16x64_bf16 v[60:63], v[32:35], v[96:103], v1
v_smfmac_f32_16x16x64_bf16 v[60:63], v[36:39], v[104:111], v1
v_cvt_pk_bf16_f32 v20, v56, v57
v_smfmac_f32_16x16x64_bf16 v[60:63], v[40:43], v[112:119], v1
v_cvt_pk_bf16_f32 v21, v58, v59
v_smfmac_f32_16x16x64_bf16 v[60:63], v[44:47], v[120:127], v1
s_cmp_lg_u32 s9, 0
v_and_or_b32 v20, v20, -2, s18
s_nop 5
v_cvt_pk_bf16_f32 v22, v60, v61
v_cvt_pk_bf16_f32 v23, v62, v63
global_store_dwordx4 v9, v[20:23], s[14:15] sc1
s_cbranch_scc1 L_ch_nrs
s_branch L_ch_comms
L_ch_lasts:
ds_write_b64 v3, v[88:89] offset:14336
s_waitcnt lgkmcnt(0)
s_barrier
ds_read_b128 v[52:55], v15 offset:12288
s_waitcnt lgkmcnt(0)
global_store_dwordx4 v15, v[52:55], s[28:29] sc1
s_mov_b64 s[36:37], s[20:21]
s_mov_b64 s[20:21], s[22:23]
s_mov_b64 s[22:23], s[36:37]
s_sub_u32 s35, s35, 1
s_waitcnt vmcnt(0) lgkmcnt(0)
v_mov_b32 v13, 64
buffer_store_dword v13, v0, s[52:55], 0 offen sc1
s_barrier
s_add_u32 s4, s4, 134217728
s_addc_u32 s5, s5, 0
s_add_u32 s11, s11, 1
s_cmp_lt_u32 s11, 2
s_cbranch_scc1 L_chain_s
s_branch L_done
L_worker:
s_sub_u32 s8, s8, 32
v_mov_b32 v1, v0
v_lshlrev_b32 v0, 4, v0
s_mov_b32 s15, 0
s_waitcnt vmcnt(0)
s_barrier
s_cmp_eq_u32 s9, 0
s_cbranch_scc0 L_arr1
v_mov_b32 v40, 0
v_mov_b32 v41, 1
s_mov_b64 exec, 1
global_atomic_add v40, v41, s[6:7] offset:128
s_mov_b64 exec, -1
L_arr1:
s_lshr_b32 s46, s8, 6
s_bfe_u32 s47, s8, 0x50001
s_and_b32 s48, s8, 1
s_lshr_b32 s50, s8, 4
s_and_b32 s53, s8, 15
s_and_b32 s51, s8, 7
s_bfe_u32 s52, s8, 0x10003
s_sub_u32 s61, s8, 132
s_and_b32 s60, s61, 3
s_lshr_b32 s61, s61, 2
s_mov_b32 s14, s61
s_mov_b32 s62, 23
s_cmp_lt_u32 s8, 132
s_cbranch_scc1 L_layer
L_t1:
s_lshl_b32 s16, s60, 7
s_lshl_b32 s17, s9, 5
s_add_u32 s16, s16, s17
v_and_b32 v4, 31, v1
v_add_u32 v4, s16, v4
v_lshrrev_b32 v2, 1, v4
v_and_b32 v5, 1, v4
v_cmp_eq_u32 vcc, 1, v4
v_mov_b32 v3, 0x100
s_nop 0
v_cndmask_b32 v2, v2, v3, vcc
v_cndmask_b32 v5, v5, 0, vcc
v_cvt_f32_u32 v2, v2
v_mul_f32 v2, 0x3b000000, v2
v_cvt_f32_u32 v5, v5
v_mul_f32 v5, 0x3e800000, v5
v_lshrrev_b32 v3, 5, v1
v_lshlrev_b32 v3, 3, v3
v_cvt_f32_u32 v3, v3
v_fma_f32 v3, v3, v2, v5
v_fract_f32 v3, v3
v_cos_f32 v8, v3
v_fmamk_f32 v9, v2, 0x3f800000, v3
v_cos_f32 v9, v9
v_fmamk_f32 v10, v2, 0x40000000, v3
v_cos_f32 v10, v10
v_fmamk_f32 v11, v2, 0x40400000, v3
v_cos_f32 v11, v11
v_fmamk_f32 v12, v2, 0x40800000, v3
v_cos_f32 v12, v12
v_fmamk_f32 v13, v2, 0x40a00000, v3
v_cos_f32 v13, v13
v_fmamk_f32 v14, v2, 0x40c00000, v3
v_cos_f32 v14, v14
v_fmamk_f32 v15, v2, 0x40e00000, v3
v_cos_f32 v15, v15
v_fmamk_f32 v3, v2, 0x41800000, v3
v_fract_f32 v3, v3
v_cvt_pk_bf16_f32 v128, v8, v9
v_cvt_pk_bf16_f32 v129, v10, v11
v_cvt_pk_bf16_f32 v130, v12, v13
v_cvt_pk_bf16_f32 v131, v14, v15
v_cos_f32 v8, v3
v_fmamk_f32 v9, v2, 0x3f800000, v3
v_cos_f32 v9, v9
v_fmamk_f32 v10, v2, 0x40000000, v3
v_cos_f32 v10, v10
v_fmamk_f32 v11, v2, 0x40400000, v3
v_cos_f32 v11, v11
v_fmamk_f32 v12, v2, 0x40800000, v3
v_cos_f32 v12, v12
v_fmamk_f32 v13, v2, 0x40a00000, v3
v_cos_f32 v13, v13
v_fmamk_f32 v14, v2, 0x40c00000, v3
v_cos_f32 v14, v14
v_fmamk_f32 v15, v2, 0x40e00000, v3
v_cos_f32 v15, v15
v_fmamk_f32 v3, v2, 0x41800000, v3
v_fract_f32 v3, v3
v_cvt_pk_bf16_f32 v132, v8, v9
v_cvt_pk_bf16_f32 v133, v10, v11
v_cvt_pk_bf16_f32 v134, v12, v13
v_cvt_pk_bf16_f32 v135, v14, v15
v_cos_f32 v8, v3
v_fmamk_f32 v9, v2, 0x3f800000, v3
v_cos_f32 v9, v9
v_fmamk_f32 v10, v2, 0x40000000, v3
v_cos_f32 v10, v10
v_fmamk_f32 v11, v2, 0x40400000, v3
v_cos_f32 v11, v11
v_fmamk_f32 v12, v2, 0x40800000, v3
v_cos_f32 v12, v12
v_fmamk_f32 v13, v2, 0x40a00000, v3
v_cos_f32 v13, v13
v_fmamk_f32 v14, v2, 0x40c00000, v3
v_cos_f32 v14, v14
v_fmamk_f32 v15, v2, 0x40e00000, v3
v_cos_f32 v15, v15
v_fmamk_f32 v3, v2, 0x41800000, v3
v_fract_f32 v3, v3
v_cvt_pk_bf16_f32 v136, v8, v9
v_cvt_pk_bf16_f32 v137, v10, v11
v_cvt_pk_bf16_f32 v138, v12, v13
v_cvt_pk_bf16_f32 v139, v14, v15
v_cos_f32 v8, v3
v_fmamk_f32 v9, v2, 0x3f800000, v3
v_cos_f32 v9, v9
v_fmamk_f32 v10, v2, 0x40000000, v3
v_cos_f32 v10, v10
v_fmamk_f32 v11, v2, 0x40400000, v3
v_cos_f32 v11, v11
v_fmamk_f32 v12, v2, 0x40800000, v3
v_cos_f32 v12, v12
v_fmamk_f32 v13, v2, 0x40a00000, v3
v_cos_f32 v13, v13
v_fmamk_f32 v14, v2, 0x40c00000, v3
v_cos_f32 v14, v14
v_fmamk_f32 v15, v2, 0x40e00000, v3
v_cos_f32 v15, v15
v_fmamk_f32 v3, v2, 0x41800000, v3
v_fract_f32 v3, v3
v_cvt_pk_bf16_f32 v140, v8, v9
v_cvt_pk_bf16_f32 v141, v10, v11
v_cvt_pk_bf16_f32 v142, v12, v13
v_cvt_pk_bf16_f32 v143, v14, v15
v_cos_f32 v8, v3
v_fmamk_f32 v9, v2, 0x3f800000, v3
v_cos_f32 v9, v9
v_fmamk_f32 v10, v2, 0x40000000, v3
v_cos_f32 v10, v10
v_fmamk_f32 v11, v2, 0x40400000, v3
v_cos_f32 v11, v11
v_fmamk_f32 v12, v2, 0x40800000, v3
v_cos_f32 v12, v12
v_fmamk_f32 v13, v2, 0x40a00000, v3
v_cos_f32 v13, v13
v_fmamk_f32 v14, v2, 0x40c00000, v3
v_cos_f32 v14, v14
v_fmamk_f32 v15, v2, 0x40e00000, v3
v_cos_f32 v15, v15
v_fmamk_f32 v3, v2, 0x41800000, v3
v_fract_f32 v3, v3
v_cvt_pk_bf16_f32 v144, v8, v9
v_cvt_pk_bf16_f32 v145, v10, v11
v_cvt_pk_bf16_f32 v146, v12, v13
v_cvt_pk_bf16_f32 v147, v14, v15
v_cos_f32 v8, v3
v_fmamk_f32 v9, v2, 0x3f800000, v3
v_cos_f32 v9, v9
v_fmamk_f32 v10, v2, 0x40000000, v3
v_cos_f32 v10, v10
v_fmamk_f32 v11, v2, 0x40400000, v3
v_cos_f32 v11, v11
v_fmamk_f32 v12, v2, 0x40800000, v3
v_cos_f32 v12, v12
v_fmamk_f32 v13, v2, 0x40a00000, v3
v_cos_f32 v13, v13
v_fmamk_f32 v14, v2, 0x40c00000, v3
v_cos_f32 v14, v14
v_fmamk_f32 v15, v2, 0x40e00000, v3
v_cos_f32 v15, v15
v_fmamk_f32 v3, v2, 0x41800000, v3
v_fract_f32 v3, v3
v_cvt_pk_bf16_f32 v148, v8, v9
v_cvt_pk_bf16_f32 v149, v10, v11
v_cvt_pk_bf16_f32 v150, v12, v13
v_cvt_pk_bf16_f32 v151, v14, v15
v_cos_f32 v8, v3
v_fmamk_f32 v9, v2, 0x3f800000, v3
v_cos_f32 v9, v9
v_fmamk_f32 v10, v2, 0x40000000, v3
v_cos_f32 v10, v10
v_fmamk_f32 v11, v2, 0x40400000, v3
v_cos_f32 v11, v11
v_fmamk_f32 v12, v2, 0x40800000, v3
v_cos_f32 v12, v12
v_fmamk_f32 v13, v2, 0x40a00000, v3
v_cos_f32 v13, v13
v_fmamk_f32 v14, v2, 0x40c00000, v3
v_cos_f32 v14, v14
v_fmamk_f32 v15, v2, 0x40e00000, v3
v_cos_f32 v15, v15
v_fmamk_f32 v3, v2, 0x41800000, v3
v_fract_f32 v3, v3
v_cvt_pk_bf16_f32 v152, v8, v9
v_cvt_pk_bf16_f32 v153, v10, v11
v_cvt_pk_bf16_f32 v154, v12, v13
v_cvt_pk_bf16_f32 v155, v14, v15
v_cos_f32 v8, v3
v_fmamk_f32 v9, v2, 0x3f800000, v3
v_cos_f32 v9, v9
v_fmamk_f32 v10, v2, 0x40000000, v3
v_cos_f32 v10, v10
v_fmamk_f32 v11, v2, 0x40400000, v3
v_cos_f32 v11, v11
v_fmamk_f32 v12, v2, 0x40800000, v3
v_cos_f32 v12, v12
v_fmamk_f32 v13, v2, 0x40a00000, v3
v_cos_f32 v13, v13
v_fmamk_f32 v14, v2, 0x40c00000, v3
v_cos_f32 v14, v14
v_fmamk_f32 v15, v2, 0x40e00000, v3
v_cos_f32 v15, v15
v_fmamk_f32 v3, v2, 0x41800000, v3
v_fract_f32 v3, v3
v_cvt_pk_bf16_f32 v156, v8, v9
v_cvt_pk_bf16_f32 v157, v10, v11
v_cvt_pk_bf16_f32 v158, v12, v13
v_cvt_pk_bf16_f32 v159, v14, v15
v_cos_f32 v8, v3
v_fmamk_f32 v9, v2, 0x3f800000, v3
v_cos_f32 v9, v9
v_fmamk_f32 v10, v2, 0x40000000, v3
v_cos_f32 v10, v10
v_fmamk_f32 v11, v2, 0x40400000, v3
v_cos_f32 v11, v11
v_fmamk_f32 v12, v2, 0x40800000, v3
v_cos_f32 v12, v12
v_fmamk_f32 v13, v2, 0x40a00000, v3
v_cos_f32 v13, v13
v_fmamk_f32 v14, v2, 0x40c00000, v3
v_cos_f32 v14, v14
v_fmamk_f32 v15, v2, 0x40e00000, v3
v_cos_f32 v15, v15
v_fmamk_f32 v3, v2, 0x41800000, v3
v_fract_f32 v3, v3
v_cvt_pk_bf16_f32 v160, v8, v9
v_cvt_pk_bf16_f32 v161, v10, v11
v_cvt_pk_bf16_f32 v162, v12, v13
v_cvt_pk_bf16_f32 v163, v14, v15
v_cos_f32 v8, v3
v_fmamk_f32 v9, v2, 0x3f800000, v3
v_cos_f32 v9, v9
v_fmamk_f32 v10, v2, 0x40000000, v3
v_cos_f32 v10, v10
v_fmamk_f32 v11, v2, 0x40400000, v3
v_cos_f32 v11, v11
v_fmamk_f32 v12, v2, 0x40800000, v3
v_cos_f32 v12, v12
v_fmamk_f32 v13, v2, 0x40a00000, v3
v_cos_f32 v13, v13
v_fmamk_f32 v14, v2, 0x40c00000, v3
v_cos_f32 v14, v14
v_fmamk_f32 v15, v2, 0x40e00000, v3
v_cos_f32 v15, v15
v_fmamk_f32 v3, v2, 0x41800000, v3
v_fract_f32 v3, v3
v_cvt_pk_bf16_f32 v164, v8, v9
v_cvt_pk_bf16_f32 v165, v10, v11
v_cvt_pk_bf16_f32 v166, v12, v13
v_cvt_pk_bf16_f32 v167, v14, v15
v_cos_f32 v8, v3
v_fmamk_f32 v9, v2, 0x3f800000, v3
v_cos_f32 v9, v9
v_fmamk_f32 v10, v2, 0x40000000, v3
v_cos_f32 v10, v10
v_fmamk_f32 v11, v2, 0x40400000, v3
v_cos_f32 v11, v11
v_fmamk_f32 v12, v2, 0x40800000, v3
v_cos_f32 v12, v12
v_fmamk_f32 v13, v2, 0x40a00000, v3
v_cos_f32 v13, v13
v_fmamk_f32 v14, v2, 0x40c00000, v3
v_cos_f32 v14, v14
v_fmamk_f32 v15, v2, 0x40e00000, v3
v_cos_f32 v15, v15
v_fmamk_f32 v3, v2, 0x41800000, v3
v_fract_f32 v3, v3
v_cvt_pk_bf16_f32 v168, v8, v9
v_cvt_pk_bf16_f32 v169, v10, v11
v_cvt_pk_bf16_f32 v170, v12, v13
v_cvt_pk_bf16_f32 v171, v14, v15
v_cos_f32 v8, v3
v_fmamk_f32 v9, v2, 0x3f800000, v3
v_cos_f32 v9, v9
v_fmamk_f32 v10, v2, 0x40000000, v3
v_cos_f32 v10, v10
v_fmamk_f32 v11, v2, 0x40400000, v3
v_cos_f32 v11, v11
v_fmamk_f32 v12, v2, 0x40800000, v3
v_cos_f32 v12, v12
v_fmamk_f32 v13, v2, 0x40a00000, v3
v_cos_f32 v13, v13
v_fmamk_f32 v14, v2, 0x40c00000, v3
v_cos_f32 v14, v14
v_fmamk_f32 v15, v2, 0x40e00000, v3
v_cos_f32 v15, v15
v_fmamk_f32 v3, v2, 0x41800000, v3
v_fract_f32 v3, v3
v_cvt_pk_bf16_f32 v172, v8, v9
v_cvt_pk_bf16_f32 v173, v10, v11
v_cvt_pk_bf16_f32 v174, v12, v13
v_cvt_pk_bf16_f32 v175, v14, v15
v_cos_f32 v8, v3
v_fmamk_f32 v9, v2, 0x3f800000, v3
v_cos_f32 v9, v9
v_fmamk_f32 v10, v2, 0x40000000, v3
v_cos_f32 v10, v10
v_fmamk_f32 v11, v2, 0x40400000, v3
v_cos_f32 v11, v11
v_fmamk_f32 v12, v2, 0x40800000, v3
v_cos_f32 v12, v12
v_fmamk_f32 v13, v2, 0x40a00000, v3
v_cos_f32 v13, v13
v_fmamk_f32 v14, v2, 0x40c00000, v3
v_cos_f32 v14, v14
v_fmamk_f32 v15, v2, 0x40e00000, v3
v_cos_f32 v15, v15
v_fmamk_f32 v3, v2, 0x41800000, v3
v_fract_f32 v3, v3
v_cvt_pk_bf16_f32 v176, v8, v9
v_cvt_pk_bf16_f32 v177, v10, v11
v_cvt_pk_bf16_f32 v178, v12, v13
v_cvt_pk_bf16_f32 v179, v14, v15
v_cos_f32 v8, v3
v_fmamk_f32 v9, v2, 0x3f800000, v3
v_cos_f32 v9, v9
v_fmamk_f32 v10, v2, 0x40000000, v3
v_cos_f32 v10, v10
v_fmamk_f32 v11, v2, 0x40400000, v3
v_cos_f32 v11, v11
v_fmamk_f32 v12, v2, 0x40800000, v3
v_cos_f32 v12, v12
v_fmamk_f32 v13, v2, 0x40a00000, v3
v_cos_f32 v13, v13
v_fmamk_f32 v14, v2, 0x40c00000, v3
v_cos_f32 v14, v14
v_fmamk_f32 v15, v2, 0x40e00000, v3
v_cos_f32 v15, v15
v_fmamk_f32 v3, v2, 0x41800000, v3
v_fract_f32 v3, v3
v_cvt_pk_bf16_f32 v180, v8, v9
v_cvt_pk_bf16_f32 v181, v10, v11
v_cvt_pk_bf16_f32 v182, v12, v13
v_cvt_pk_bf16_f32 v183, v14, v15
v_cos_f32 v8, v3
v_fmamk_f32 v9, v2, 0x3f800000, v3
v_cos_f32 v9, v9
v_fmamk_f32 v10, v2, 0x40000000, v3
v_cos_f32 v10, v10
v_fmamk_f32 v11, v2, 0x40400000, v3
v_cos_f32 v11, v11
v_fmamk_f32 v12, v2, 0x40800000, v3
v_cos_f32 v12, v12
v_fmamk_f32 v13, v2, 0x40a00000, v3
v_cos_f32 v13, v13
v_fmamk_f32 v14, v2, 0x40c00000, v3
v_cos_f32 v14, v14
v_fmamk_f32 v15, v2, 0x40e00000, v3
v_cos_f32 v15, v15
v_fmamk_f32 v3, v2, 0x41800000, v3
v_fract_f32 v3, v3
v_cvt_pk_bf16_f32 v184, v8, v9
v_cvt_pk_bf16_f32 v185, v10, v11
v_cvt_pk_bf16_f32 v186, v12, v13
v_cvt_pk_bf16_f32 v187, v14, v15
v_cos_f32 v8, v3
v_fmamk_f32 v9, v2, 0x3f800000, v3
v_cos_f32 v9, v9
v_fmamk_f32 v10, v2, 0x40000000, v3
v_cos_f32 v10, v10
v_fmamk_f32 v11, v2, 0x40400000, v3
v_cos_f32 v11, v11
v_fmamk_f32 v12, v2, 0x40800000, v3
v_cos_f32 v12, v12
v_fmamk_f32 v13, v2, 0x40a00000, v3
v_cos_f32 v13, v13
v_fmamk_f32 v14, v2, 0x40c00000, v3
v_cos_f32 v14, v14
v_fmamk_f32 v15, v2, 0x40e00000, v3
v_cos_f32 v15, v15
v_fmamk_f32 v3, v2, 0x41800000, v3
v_fract_f32 v3, v3
v_cvt_pk_bf16_f32 v188, v8, v9
v_cvt_pk_bf16_f32 v189, v10, v11
v_cvt_pk_bf16_f32 v190, v12, v13
v_cvt_pk_bf16_f32 v191, v14, v15
v_cos_f32 v8, v3
v_fmamk_f32 v9, v2, 0x3f800000, v3
v_cos_f32 v9, v9
v_fmamk_f32 v10, v2, 0x40000000, v3
v_cos_f32 v10, v10
v_fmamk_f32 v11, v2, 0x40400000, v3
v_cos_f32 v11, v11
v_fmamk_f32 v12, v2, 0x40800000, v3
v_cos_f32 v12, v12
v_fmamk_f32 v13, v2, 0x40a00000, v3
v_cos_f32 v13, v13
v_fmamk_f32 v14, v2, 0x40c00000, v3
v_cos_f32 v14, v14
v_fmamk_f32 v15, v2, 0x40e00000, v3
v_cos_f32 v15, v15
v_fmamk_f32 v3, v2, 0x41800000, v3
v_fract_f32 v3, v3
v_cvt_pk_bf16_f32 v192, v8, v9
v_cvt_pk_bf16_f32 v193, v10, v11
v_cvt_pk_bf16_f32 v194, v12, v13
v_cvt_pk_bf16_f32 v195, v14, v15
v_cos_f32 v8, v3
v_fmamk_f32 v9, v2, 0x3f800000, v3
v_cos_f32 v9, v9
v_fmamk_f32 v10, v2, 0x40000000, v3
v_cos_f32 v10, v10
v_fmamk_f32 v11, v2, 0x40400000, v3
v_cos_f32 v11, v11
v_fmamk_f32 v12, v2, 0x40800000, v3
v_cos_f32 v12, v12
v_fmamk_f32 v13, v2, 0x40a00000, v3
v_cos_f32 v13, v13
v_fmamk_f32 v14, v2, 0x40c00000, v3
v_cos_f32 v14, v14
v_fmamk_f32 v15, v2, 0x40e00000, v3
v_cos_f32 v15, v15
v_fmamk_f32 v3, v2, 0x41800000, v3
v_fract_f32 v3, v3
v_cvt_pk_bf16_f32 v196, v8, v9
v_cvt_pk_bf16_f32 v197, v10, v11
v_cvt_pk_bf16_f32 v198, v12, v13
v_cvt_pk_bf16_f32 v199, v14, v15
v_cos_f32 v8, v3
v_fmamk_f32 v9, v2, 0x3f800000, v3
v_cos_f32 v9, v9
v_fmamk_f32 v10, v2, 0x40000000, v3
v_cos_f32 v10, v10
v_fmamk_f32 v11, v2, 0x40400000, v3
v_cos_f32 v11, v11
v_fmamk_f32 v12, v2, 0x40800000, v3
v_cos_f32 v12, v12
v_fmamk_f32 v13, v2, 0x40a00000, v3
v_cos_f32 v13, v13
v_fmamk_f32 v14, v2, 0x40c00000, v3
v_cos_f32 v14, v14
v_fmamk_f32 v15, v2, 0x40e00000, v3
v_cos_f32 v15, v15
v_fmamk_f32 v3, v2, 0x41800000, v3
v_fract_f32 v3, v3
v_cvt_pk_bf16_f32 v200, v8, v9
v_cvt_pk_bf16_f32 v201, v10, v11
v_cvt_pk_bf16_f32 v202, v12, v13
v_cvt_pk_bf16_f32 v203, v14, v15
v_cos_f32 v8, v3
v_fmamk_f32 v9, v2, 0x3f800000, v3
v_cos_f32 v9, v9
v_fmamk_f32 v10, v2, 0x40000000, v3
v_cos_f32 v10, v10
v_fmamk_f32 v11, v2, 0x40400000, v3
v_cos_f32 v11, v11
v_fmamk_f32 v12, v2, 0x40800000, v3
v_cos_f32 v12, v12
v_fmamk_f32 v13, v2, 0x40a00000, v3
v_cos_f32 v13, v13
v_fmamk_f32 v14, v2, 0x40c00000, v3
v_cos_f32 v14, v14
v_fmamk_f32 v15, v2, 0x40e00000, v3
v_cos_f32 v15, v15
v_fmamk_f32 v3, v2, 0x41800000, v3
v_fract_f32 v3, v3
v_cvt_pk_bf16_f32 v204, v8, v9
v_cvt_pk_bf16_f32 v205, v10, v11
v_cvt_pk_bf16_f32 v206, v12, v13
v_cvt_pk_bf16_f32 v207, v14, v15
v_cos_f32 v8, v3
v_fmamk_f32 v9, v2, 0x3f800000, v3
v_cos_f32 v9, v9
v_fmamk_f32 v10, v2, 0x40000000, v3
v_cos_f32 v10, v10
v_fmamk_f32 v11, v2, 0x40400000, v3
v_cos_f32 v11, v11
v_fmamk_f32 v12, v2, 0x40800000, v3
v_cos_f32 v12, v12
v_fmamk_f32 v13, v2, 0x40a00000, v3
v_cos_f32 v13, v13
v_fmamk_f32 v14, v2, 0x40c00000, v3
v_cos_f32 v14, v14
v_fmamk_f32 v15, v2, 0x40e00000, v3
v_cos_f32 v15, v15
v_fmamk_f32 v3, v2, 0x41800000, v3
v_fract_f32 v3, v3
v_cvt_pk_bf16_f32 v208, v8, v9
v_cvt_pk_bf16_f32 v209, v10, v11
v_cvt_pk_bf16_f32 v210, v12, v13
v_cvt_pk_bf16_f32 v211, v14, v15
v_cos_f32 v8, v3
v_fmamk_f32 v9, v2, 0x3f800000, v3
v_cos_f32 v9, v9
v_fmamk_f32 v10, v2, 0x40000000, v3
v_cos_f32 v10, v10
v_fmamk_f32 v11, v2, 0x40400000, v3
v_cos_f32 v11, v11
v_fmamk_f32 v12, v2, 0x40800000, v3
v_cos_f32 v12, v12
v_fmamk_f32 v13, v2, 0x40a00000, v3
v_cos_f32 v13, v13
v_fmamk_f32 v14, v2, 0x40c00000, v3
v_cos_f32 v14, v14
v_fmamk_f32 v15, v2, 0x40e00000, v3
v_cos_f32 v15, v15
v_fmamk_f32 v3, v2, 0x41800000, v3
v_fract_f32 v3, v3
v_cvt_pk_bf16_f32 v212, v8, v9
v_cvt_pk_bf16_f32 v213, v10, v11
v_cvt_pk_bf16_f32 v214, v12, v13
v_cvt_pk_bf16_f32 v215, v14, v15
v_cos_f32 v8, v3
v_fmamk_f32 v9, v2, 0x3f800000, v3
v_cos_f32 v9, v9
v_fmamk_f32 v10, v2, 0x40000000, v3
v_cos_f32 v10, v10
v_fmamk_f32 v11, v2, 0x40400000, v3
v_cos_f32 v11, v11
v_fmamk_f32 v12, v2, 0x40800000, v3
v_cos_f32 v12, v12
v_fmamk_f32 v13, v2, 0x40a00000, v3
v_cos_f32 v13, v13
v_fmamk_f32 v14, v2, 0x40c00000, v3
v_cos_f32 v14, v14
v_fmamk_f32 v15, v2, 0x40e00000, v3
v_cos_f32 v15, v15
v_fmamk_f32 v3, v2, 0x41800000, v3
v_fract_f32 v3, v3
v_cvt_pk_bf16_f32 v216, v8, v9
v_cvt_pk_bf16_f32 v217, v10, v11
v_cvt_pk_bf16_f32 v218, v12, v13
v_cvt_pk_bf16_f32 v219, v14, v15
v_cos_f32 v8, v3
v_fmamk_f32 v9, v2, 0x3f800000, v3
v_cos_f32 v9, v9
v_fmamk_f32 v10, v2, 0x40000000, v3
v_cos_f32 v10, v10
v_fmamk_f32 v11, v2, 0x40400000, v3
v_cos_f32 v11, v11
v_fmamk_f32 v12, v2, 0x40800000, v3
v_cos_f32 v12, v12
v_fmamk_f32 v13, v2, 0x40a00000, v3
v_cos_f32 v13, v13
v_fmamk_f32 v14, v2, 0x40c00000, v3
v_cos_f32 v14, v14
v_fmamk_f32 v15, v2, 0x40e00000, v3
v_cos_f32 v15, v15
v_fmamk_f32 v3, v2, 0x41800000, v3
v_fract_f32 v3, v3
v_cvt_pk_bf16_f32 v220, v8, v9
v_cvt_pk_bf16_f32 v221, v10, v11
v_cvt_pk_bf16_f32 v222, v12, v13
v_cvt_pk_bf16_f32 v223, v14, v15
v_cos_f32 v8, v3
v_fmamk_f32 v9, v2, 0x3f800000, v3
v_cos_f32 v9, v9
v_fmamk_f32 v10, v2, 0x40000000, v3
v_cos_f32 v10, v10
v_fmamk_f32 v11, v2, 0x40400000, v3
v_cos_f32 v11, v11
v_fmamk_f32 v12, v2, 0x40800000, v3
v_cos_f32 v12, v12
v_fmamk_f32 v13, v2, 0x40a00000, v3
v_cos_f32 v13, v13
v_fmamk_f32 v14, v2, 0x40c00000, v3
v_cos_f32 v14, v14
v_fmamk_f32 v15, v2, 0x40e00000, v3
v_cos_f32 v15, v15
v_fmamk_f32 v3, v2, 0x41800000, v3
v_fract_f32 v3, v3
v_cvt_pk_bf16_f32 v224, v8, v9
v_cvt_pk_bf16_f32 v225, v10, v11
v_cvt_pk_bf16_f32 v226, v12, v13
v_cvt_pk_bf16_f32 v227, v14, v15
v_cos_f32 v8, v3
v_fmamk_f32 v9, v2, 0x3f800000, v3
v_cos_f32 v9, v9
v_fmamk_f32 v10, v2, 0x40000000, v3
v_cos_f32 v10, v10
v_fmamk_f32 v11, v2, 0x40400000, v3
v_cos_f32 v11, v11
v_fmamk_f32 v12, v2, 0x40800000, v3
v_cos_f32 v12, v12
v_fmamk_f32 v13, v2, 0x40a00000, v3
v_cos_f32 v13, v13
v_fmamk_f32 v14, v2, 0x40c00000, v3
v_cos_f32 v14, v14
v_fmamk_f32 v15, v2, 0x40e00000, v3
v_cos_f32 v15, v15
v_fmamk_f32 v3, v2, 0x41800000, v3
v_fract_f32 v3, v3
v_cvt_pk_bf16_f32 v228, v8, v9
v_cvt_pk_bf16_f32 v229, v10, v11
v_cvt_pk_bf16_f32 v230, v12, v13
v_cvt_pk_bf16_f32 v231, v14, v15
v_cos_f32 v8, v3
v_fmamk_f32 v9, v2, 0x3f800000, v3
v_cos_f32 v9, v9
v_fmamk_f32 v10, v2, 0x40000000, v3
v_cos_f32 v10, v10
v_fmamk_f32 v11, v2, 0x40400000, v3
v_cos_f32 v11, v11
v_fmamk_f32 v12, v2, 0x40800000, v3
v_cos_f32 v12, v12
v_fmamk_f32 v13, v2, 0x40a00000, v3
v_cos_f32 v13, v13
v_fmamk_f32 v14, v2, 0x40c00000, v3
v_cos_f32 v14, v14
v_fmamk_f32 v15, v2, 0x40e00000, v3
v_cos_f32 v15, v15
v_fmamk_f32 v3, v2, 0x41800000, v3
v_fract_f32 v3, v3
v_cvt_pk_bf16_f32 v232, v8, v9
v_cvt_pk_bf16_f32 v233, v10, v11
v_cvt_pk_bf16_f32 v234, v12, v13
v_cvt_pk_bf16_f32 v235, v14, v15
v_cos_f32 v8, v3
v_fmamk_f32 v9, v2, 0x3f800000, v3
v_cos_f32 v9, v9
v_fmamk_f32 v10, v2, 0x40000000, v3
v_cos_f32 v10, v10
v_fmamk_f32 v11, v2, 0x40400000, v3
v_cos_f32 v11, v11
v_fmamk_f32 v12, v2, 0x40800000, v3
v_cos_f32 v12, v12
v_fmamk_f32 v13, v2, 0x40a00000, v3
v_cos_f32 v13, v13
v_fmamk_f32 v14, v2, 0x40c00000, v3
v_cos_f32 v14, v14
v_fmamk_f32 v15, v2, 0x40e00000, v3
v_cos_f32 v15, v15
v_fmamk_f32 v3, v2, 0x41800000, v3
v_fract_f32 v3, v3
v_cvt_pk_bf16_f32 v236, v8, v9
v_cvt_pk_bf16_f32 v237, v10, v11
v_cvt_pk_bf16_f32 v238, v12, v13
v_cvt_pk_bf16_f32 v239, v14, v15
v_cos_f32 v8, v3
v_fmamk_f32 v9, v2, 0x3f800000, v3
v_cos_f32 v9, v9
v_fmamk_f32 v10, v2, 0x40000000, v3
v_cos_f32 v10, v10
v_fmamk_f32 v11, v2, 0x40400000, v3
v_cos_f32 v11, v11
v_fmamk_f32 v12, v2, 0x40800000, v3
v_cos_f32 v12, v12
v_fmamk_f32 v13, v2, 0x40a00000, v3
v_cos_f32 v13, v13
v_fmamk_f32 v14, v2, 0x40c00000, v3
v_cos_f32 v14, v14
v_fmamk_f32 v15, v2, 0x40e00000, v3
v_cos_f32 v15, v15
v_fmamk_f32 v3, v2, 0x41800000, v3
v_fract_f32 v3, v3
v_cvt_pk_bf16_f32 v240, v8, v9
v_cvt_pk_bf16_f32 v241, v10, v11
v_cvt_pk_bf16_f32 v242, v12, v13
v_cvt_pk_bf16_f32 v243, v14, v15
v_cos_f32 v8, v3
v_fmamk_f32 v9, v2, 0x3f800000, v3
v_cos_f32 v9, v9
v_fmamk_f32 v10, v2, 0x40000000, v3
v_cos_f32 v10, v10
v_fmamk_f32 v11, v2, 0x40400000, v3
v_cos_f32 v11, v11
v_fmamk_f32 v12, v2, 0x40800000, v3
v_cos_f32 v12, v12
v_fmamk_f32 v13, v2, 0x40a00000, v3
v_cos_f32 v13, v13
v_fmamk_f32 v14, v2, 0x40c00000, v3
v_cos_f32 v14, v14
v_fmamk_f32 v15, v2, 0x40e00000, v3
v_cos_f32 v15, v15
v_fmamk_f32 v3, v2, 0x41800000, v3
v_fract_f32 v3, v3
v_cvt_pk_bf16_f32 v244, v8, v9
v_cvt_pk_bf16_f32 v245, v10, v11
v_cvt_pk_bf16_f32 v246, v12, v13
v_cvt_pk_bf16_f32 v247, v14, v15
v_cos_f32 v8, v3
v_fmamk_f32 v9, v2, 0x3f800000, v3
v_cos_f32 v9, v9
v_fmamk_f32 v10, v2, 0x40000000, v3
v_cos_f32 v10, v10
v_fmamk_f32 v11, v2, 0x40400000, v3
v_cos_f32 v11, v11
v_fmamk_f32 v12, v2, 0x40800000, v3
v_cos_f32 v12, v12
v_fmamk_f32 v13, v2, 0x40a00000, v3
v_cos_f32 v13, v13
v_fmamk_f32 v14, v2, 0x40c00000, v3
v_cos_f32 v14, v14
v_fmamk_f32 v15, v2, 0x40e00000, v3
v_cos_f32 v15, v15
v_fmamk_f32 v3, v2, 0x41800000, v3
v_fract_f32 v3, v3
v_cvt_pk_bf16_f32 v248, v8, v9
v_cvt_pk_bf16_f32 v249, v10, v11
v_cvt_pk_bf16_f32 v250, v12, v13
v_cvt_pk_bf16_f32 v251, v14, v15
v_cos_f32 v8, v3
v_fmamk_f32 v9, v2, 0x3f800000, v3
v_cos_f32 v9, v9
v_fmamk_f32 v10, v2, 0x40000000, v3
v_cos_f32 v10, v10
v_fmamk_f32 v11, v2, 0x40400000, v3
v_cos_f32 v11, v11
v_fmamk_f32 v12, v2, 0x40800000, v3
v_cos_f32 v12, v12
v_fmamk_f32 v13, v2, 0x40a00000, v3
v_cos_f32 v13, v13
v_fmamk_f32 v14, v2, 0x40c00000, v3
v_cos_f32 v14, v14
v_fmamk_f32 v15, v2, 0x40e00000, v3
v_cos_f32 v15, v15
v_cvt_pk_bf16_f32 v252, v8, v9
v_cvt_pk_bf16_f32 v253, v10, v11
v_cvt_pk_bf16_f32 v254, v12, v13
v_cvt_pk_bf16_f32 v255, v14, v15
L_t1l:
s_cmp_eq_u32 s11, 0
s_cbranch_scc1 L_t1m
s_cmp_lg_u32 s9, 0
s_cbranch_scc1 L_wg_5
s_cmp_eq_u32 s15, 1
s_cbranch_scc1 L_sbd_7
s_mov_b32 s10, 0
v_mov_b32 v8, 0
L_sb_6:
global_load_dword v9, v8, s[6:7] offset:128 sc1
s_add_u32 s10, s10, 1
s_cmp_gt_u32 s10, 400000
s_cbranch_scc1 L_fail
s_waitcnt vmcnt(0)
v_cmp_ne_u32 vcc, 0x100, v9
s_cbranch_vccnz L_sb_6
s_mov_b32 s15, 1
L_sbd_7:
s_lshl_b32 s16, s14, 10
s_add_u32 s16, s16, 1179648
v_lshlrev_b32 v2, 7, v1
v_add_u32 v2, s16, v2
s_mov_b32 s10, 0
s_mov_b64 exec, 0xff
L_wt_8:
global_load_dwordx4 v[8:11], v2, s[4:5] offset:0 sc1
s_add_u32 s10, s10, 1
s_cmp_gt_u32 s10, 400000
s_cbranch_scc1 L_fail
s_waitcnt vmcnt(0)
v_min3_u32 v8, v8, v9, v10
v_min_u32 v8, v8, v11
v_cmp_gt_u32 vcc, 1, v8
s_cbranch_vccz L_wd_9
s_sleep 1
s_branch L_wt_8
L_wd_9:
s_mov_b64 exec, -1
L_wg_5:
s_barrier
L_t1m:
s_lshl_b32 s17, s9, 3
s_load_dwordx2 s[32:33], s[0:1], 0
s_add_u32 s20, s4, 2097152
s_addc_u32 s21, s5, 0
v_and_b32 v2, 31, v1
v_lshlrev_b32 v2, 10, v2
v_lshrrev_b32 v3, 5, v1
v_lshl_add_u32 v2, v3, 4, v2
s_lshl_b32 s18, s14, 15
s_cmp_eq_u32 s11, 0
s_cselect_b64 vcc, -1, 0
s_cselect_b32 s19, 32, 0x400
s_waitcnt lgkmcnt(0)
s_cselect_b64 s[32:33], s[32:33], s[20:21]
s_mul_i32 s20, s17, s19
s_add_u32 s18, s18, s20
s_add_u32 s32, s32, s18
s_addc_u32 s33, s33, 0
v_cndmask_b32 v2, v0, v2, vcc
s_lshl_b32 s16, s9, 13
s_add_u32 m0, s16, 0
s_nop 0
global_load_lds_dwordx4 v2, s[32:33] sc1
s_add_u32 m0, s16, 1024
v_add_u32 v2, s19, v2
global_load_lds_dwordx4 v2, s[32:33] sc1
s_add_u32 m0, s16, 2048
v_add_u32 v2, s19, v2
global_load_lds_dwordx4 v2, s[32:33] sc1
s_add_u32 m0, s16, 3072
v_add_u32 v2, s19, v2
global_load_lds_dwordx4 v2, s[32:33] sc1
s_add_u32 m0, s16, 4096
v_add_u32 v2, s19, v2
global_load_lds_dwordx4 v2, s[32:33] sc1
s_add_u32 m0, s16, 5120
v_add_u32 v2, s19, v2
global_load_lds_dwordx4 v2, s[32:33] sc1
s_add_u32 m0, s16, 6144
v_add_u32 v2, s19, v2
global_load_lds_dwordx4 v2, s[32:33] sc1
s_add_u32 m0, s16, 7168
v_add_u32 v2, s19, v2
global_load_lds_dwordx4 v2, s[32:33] sc1
s_lshl_b32 s16, s9, 13
v_add_u32 v2, s16, v0
s_waitcnt vmcnt(0)
ds_read_b128 v[32:35], v2 offset:0
ds_read_b128 v[36:39], v2 offset:1024
ds_read_b128 v[40:43], v2 offset:2048
ds_read_b128 v[44:47], v2 offset:3072
ds_read_b128 v[48:51], v2 offset:4096
ds_read_b128 v[52:55], v2 offset:5120
ds_read_b128 v[56:59], v2 offset:6144
ds_read_b128 v[60:63], v2 offset:7168
v_mov_b64 v[4:5], 0
v_mov_b64 v[6:7], 0
s_mov_b32 s17, 0x3f803f80
s_waitcnt lgkmcnt(7)
v_dot2_f32_bf16 v4, v32, s17, v4
v_dot2_f32_bf16 v5, v32, v32, v5
v_dot2_f32_bf16 v6, v33, s17, v6
v_dot2_f32_bf16 v7, v33, v33, v7
v_dot2_f32_bf16 v4, v34, s17, v4
v_dot2_f32_bf16 v5, v34, v34, v5
v_dot2_f32_bf16 v6, v35, s17, v6
v_dot2_f32_bf16 v7, v35, v35, v7
s_waitcnt lgkmcnt(6)
v_dot2_f32_bf16 v4, v36, s17, v4
v_dot2_f32_bf16 v5, v36, v36, v5
v_dot2_f32_bf16 v6, v37, s17, v6
v_dot2_f32_bf16 v7, v37, v37, v7
v_dot2_f32_bf16 v4, v38, s17, v4
v_dot2_f32_bf16 v5, v38, v38, v5
v_dot2_f32_bf16 v6, v39, s17, v6
v_dot2_f32_bf16 v7, v39, v39, v7
s_waitcnt lgkmcnt(5)
v_dot2_f32_bf16 v4, v40, s17, v4
v_dot2_f32_bf16 v5, v40, v40, v5
v_dot2_f32_bf16 v6, v41, s17, v6
v_dot2_f32_bf16 v7, v41, v41, v7
v_dot2_f32_bf16 v4, v42, s17, v4
v_dot2_f32_bf16 v5, v42, v42, v5
v_dot2_f32_bf16 v6, v43, s17, v6
v_dot2_f32_bf16 v7, v43, v43, v7
s_waitcnt lgkmcnt(4)
v_dot2_f32_bf16 v4, v44, s17, v4
v_dot2_f32_bf16 v5, v44, v44, v5
v_dot2_f32_bf16 v6, v45, s17, v6
v_dot2_f32_bf16 v7, v45, v45, v7
v_dot2_f32_bf16 v4, v46, s17, v4
v_dot2_f32_bf16 v5, v46, v46, v5
v_dot2_f32_bf16 v6, v47, s17, v6
v_dot2_f32_bf16 v7, v47, v47, v7
s_waitcnt lgkmcnt(3)
v_dot2_f32_bf16 v4, v48, s17, v4
v_dot2_f32_bf16 v5, v48, v48, v5
v_dot2_f32_bf16 v6, v49, s17, v6
v_dot2_f32_bf16 v7, v49, v49, v7
v_dot2_f32_bf16 v4, v50, s17, v4
v_dot2_f32_bf16 v5, v50, v50, v5
v_dot2_f32_bf16 v6, v51, s17, v6
v_dot2_f32_bf16 v7, v51, v51, v7
s_waitcnt lgkmcnt(2)
v_dot2_f32_bf16 v4, v52, s17, v4
v_dot2_f32_bf16 v5, v52, v52, v5
v_dot2_f32_bf16 v6, v53, s17, v6
v_dot2_f32_bf16 v7, v53, v53, v7
v_dot2_f32_bf16 v4, v54, s17, v4
v_dot2_f32_bf16 v5, v54, v54, v5
v_dot2_f32_bf16 v6, v55, s17, v6
v_dot2_f32_bf16 v7, v55, v55, v7
s_waitcnt lgkmcnt(1)
v_dot2_f32_bf16 v4, v56, s17, v4
v_dot2_f32_bf16 v5, v56, v56, v5
v_dot2_f32_bf16 v6, v57, s17, v6
v_dot2_f32_bf16 v7, v57, v57, v7
v_dot2_f32_bf16 v4, v58, s17, v4
v_dot2_f32_bf16 v5, v58, v58, v5
v_dot2_f32_bf16 v6, v59, s17, v6
v_dot2_f32_bf16 v7, v59, v59, v7
s_waitcnt lgkmcnt(0)
v_dot2_f32_bf16 v4, v60, s17, v4
v_dot2_f32_bf16 v5, v60, v60, v5
v_dot2_f32_bf16 v6, v61, s17, v6
v_dot2_f32_bf16 v7, v61, v61, v7
v_dot2_f32_bf16 v4, v62, s17, v4
v_dot2_f32_bf16 v5, v62, v62, v5
v_dot2_f32_bf16 v6, v63, s17, v6
v_dot2_f32_bf16 v7, v63, v63, v7
s_nop 2
v_add_f32 v4, v4, v6
v_add_f32 v5, v5, v7
s_lshl_b32 s16, s9, 9
v_lshl_add_u32 v3, v1, 3, s16
ds_write_b64 v3, v[4:5] offset:32768
s_waitcnt lgkmcnt(0)
s_barrier
v_and_b32 v3, 31, v1
v_lshlrev_b32 v3, 3, v3
ds_read_b64 v[64:65], v3 offset:32768
ds_read_b64 v[66:67], v3 offset:33024
ds_read_b64 v[68:69], v3 offset:33280
ds_read_b64 v[70:71], v3 offset:33536
ds_read_b64 v[72:73], v3 offset:33792
ds_read_b64 v[74:75], v3 offset:34048
ds_read_b64 v[76:77], v3 offset:34304
ds_read_b64 v[78:79], v3 offset:34560
ds_read_b128 v[32:35], v0 offset:0
ds_read_b128 v[36:39], v0 offset:1024
ds_read_b128 v[40:43], v0 offset:2048
ds_read_b128 v[44:47], v0 offset:3072
ds_read_b128 v[48:51], v0 offset:4096
ds_read_b128 v[52:55], v0 offset:5120
ds_read_b128 v[56:59], v0 offset:6144
s_waitcnt lgkmcnt(7)
v_add_f32 v64, v64, v72
v_add_f32 v65, v65, v73
v_add_f32 v66, v66, v74
v_add_f32 v67, v67, v75
v_add_f32 v68, v68, v76
v_add_f32 v69, v69, v77
v_add_f32 v70, v70, v78
v_add_f32 v71, v71, v79
v_add_f32 v64, v64, v68
v_add_f32 v65, v65, v69
v_add_f32 v66, v66, v70
v_add_f32 v67, v67, v71
v_add_f32 v64, v64, v66
v_add_f32 v65, v65, v67
v_mul_f32 v4, 0x3b000000, v64
v_mul_f32 v6, 0x3b000000, v65
v_fma_f32 v6, -v4, v4, v6
v_max_f32 v6, 0, v6
v_cvt_pk_bf16_f32 v6, v6, v6
v_lshlrev_b32 v6, 16, v6
v_add_f32 v6, 0x3727c5ac, v6
v_cvt_pk_bf16_f32 v6, v6, v6
v_lshlrev_b32 v6, 16, v6
v_sqrt_f32 v6, v6
s_nop 0
v_cvt_pk_bf16_f32 v6, v6, v6
v_lshlrev_b32 v6, 16, v6
v_rcp_f32 v5, v6
v_cvt_pk_bf16_f32 v4, v4, v4
v_lshlrev_b32 v4, 16, v4
v_mul_f32 v4, v4, v5
s_lshl_b32 s16, s9, 8
v_lshrrev_b32 v3, 1, v3
v_add_u32 v3, s16, v3
v_lshrrev_b32 v6, 5, v1
v_lshl_add_u32 v6, v6, 4, s16
v_add_u32 v3, 34816, v3
ds_read_b128 v[60:63], v0 offset:7168
s_waitcnt lgkmcnt(7)
v_mfma_f32_32x32x16_bf16 v[16:31], v[32:35], v[128:131], 0
ds_read_b128 v[32:35], v0 offset:8192
s_waitcnt lgkmcnt(7)
v_mfma_f32_32x32x16_bf16 v[16:31], v[36:39], v[132:135], v[16:31]
ds_read_b128 v[36:39], v0 offset:9216
s_waitcnt lgkmcnt(7)
v_mfma_f32_32x32x16_bf16 v[16:31], v[40:43], v[136:139], v[16:31]
ds_read_b128 v[40:43], v0 offset:10240
s_waitcnt lgkmcnt(7)
v_mfma_f32_32x32x16_bf16 v[16:31], v[44:47], v[140:143], v[16:31]
ds_read_b128 v[44:47], v0 offset:11264
s_waitcnt lgkmcnt(7)
v_mfma_f32_32x32x16_bf16 v[16:31], v[48:51], v[144:147], v[16:31]
ds_read_b128 v[48:51], v0 offset:12288
s_waitcnt lgkmcnt(7)
v_mfma_f32_32x32x16_bf16 v[16:31], v[52:55], v[148:151], v[16:31]
ds_read_b128 v[52:55], v0 offset:13312
s_waitcnt lgkmcnt(7)
v_mfma_f32_32x32x16_bf16 v[16:31], v[56:59], v[152:155], v[16:31]
ds_read_b128 v[56:59], v0 offset:14336
s_waitcnt lgkmcnt(7)
v_mfma_f32_32x32x16_bf16 v[16:31], v[60:63], v[156:159], v[16:31]
ds_read_b128 v[60:63], v0 offset:15360
s_waitcnt lgkmcnt(7)
v_mfma_f32_32x32x16_bf16 v[16:31], v[32:35], v[160:163], v[16:31]
ds_read_b128 v[32:35], v0 offset:16384
s_waitcnt lgkmcnt(7)
v_mfma_f32_32x32x16_bf16 v[16:31], v[36:39], v[164:167], v[16:31]
ds_read_b128 v[36:39], v0 offset:17408
s_waitcnt lgkmcnt(7)
v_mfma_f32_32x32x16_bf16 v[16:31], v[40:43], v[168:171], v[16:31]
ds_read_b128 v[40:43], v0 offset:18432
s_waitcnt lgkmcnt(7)
v_mfma_f32_32x32x16_bf16 v[16:31], v[44:47], v[172:175], v[16:31]
ds_read_b128 v[44:47], v0 offset:19456
s_waitcnt lgkmcnt(7)
v_mfma_f32_32x32x16_bf16 v[16:31], v[48:51], v[176:179], v[16:31]
ds_read_b128 v[48:51], v0 offset:20480
s_waitcnt lgkmcnt(7)
v_mfma_f32_32x32x16_bf16 v[16:31], v[52:55], v[180:183], v[16:31]
ds_read_b128 v[52:55], v0 offset:21504
s_waitcnt lgkmcnt(7)
v_mfma_f32_32x32x16_bf16 v[16:31], v[56:59], v[184:187], v[16:31]
ds_read_b128 v[56:59], v0 offset:22528
s_waitcnt lgkmcnt(7)
v_mfma_f32_32x32x16_bf16 v[16:31], v[60:63], v[188:191], v[16:31]
ds_read_b128 v[60:63], v0 offset:23552
s_waitcnt lgkmcnt(7)
v_mfma_f32_32x32x16_bf16 v[16:31], v[32:35], v[192:195], v[16:31]
ds_read_b128 v[32:35], v0 offset:24576
s_waitcnt lgkmcnt(7)
v_mfma_f32_32x32x16_bf16 v[16:31], v[36:39], v[196:199], v[16:31]
ds_read_b128 v[36:39], v0 offset:25600
s_waitcnt lgkmcnt(7)
v_mfma_f32_32x32x16_bf16 v[16:31], v[40:43], v[200:203], v[16:31]
ds_read_b128 v[40:43], v0 offset:26624
s_waitcnt lgkmcnt(7)
v_mfma_f32_32x32x16_bf16 v[16:31], v[44:47], v[204:207], v[16:31]
ds_read_b128 v[44:47], v0 offset:27648
s_waitcnt lgkmcnt(7)
v_mfma_f32_32x32x16_bf16 v[16:31], v[48:51], v[208:211], v[16:31]
ds_read_b128 v[48:51], v0 offset:28672
s_waitcnt lgkmcnt(7)
v_mfma_f32_32x32x16_bf16 v[16:31], v[52:55], v[212:215], v[16:31]
ds_read_b128 v[52:55], v0 offset:29696
s_waitcnt lgkmcnt(7)
v_mfma_f32_32x32x16_bf16 v[16:31], v[56:59], v[216:219], v[16:31]
ds_read_b128 v[56:59], v0 offset:30720
s_waitcnt lgkmcnt(7)
v_mfma_f32_32x32x16_bf16 v[16:31], v[60:63], v[220:223], v[16:31]
ds_read_b128 v[60:63], v0 offset:31744
s_waitcnt lgkmcnt(7)
v_mfma_f32_32x32x16_bf16 v[16:31], v[32:35], v[224:227], v[16:31]
ds_write2_b32 v3, v5, v4 offset0:0 offset1:32
s_waitcnt lgkmcnt(7)
v_mfma_f32_32x32x16_bf16 v[16:31], v[36:39], v[228:231], v[16:31]
s_waitcnt lgkmcnt(6)
v_mfma_f32_32x32x16_bf16 v[16:31], v[40:43], v[232:235], v[16:31]
ds_read_b128 v[64:67], v6 offset:34816
ds_read_b128 v[80:83], v6 offset:34944
s_waitcnt lgkmcnt(7)
v_mfma_f32_32x32x16_bf16 v[16:31], v[44:47], v[236:239], v[16:31]
ds_read_b128 v[68:71], v6 offset:34848
ds_read_b128 v[84:87], v6 offset:34976
s_waitcnt lgkmcnt(8)
v_mfma_f32_32x32x16_bf16 v[16:31], v[48:51], v[240:243], v[16:31]
ds_read_b128 v[72:75], v6 offset:34880
ds_read_b128 v[88:91], v6 offset:35008
s_waitcnt lgkmcnt(9)
v_mfma_f32_32x32x16_bf16 v[16:31], v[52:55], v[244:247], v[16:31]
ds_read_b128 v[76:79], v6 offset:34912
ds_read_b128 v[92:95], v6 offset:35040
s_waitcnt lgkmcnt(10)
v_mfma_f32_32x32x16_bf16 v[16:31], v[56:59], v[248:251], v[16:31]
s_waitcnt lgkmcnt(9)
v_mfma_f32_32x32x16_bf16 v[16:31], v[60:63], v[252:255], v[16:31]
s_or_b32 s16, s60, s9
v_and_b32 v4, 31, v1
v_or_b32 v5, s16, v4
v_cmp_eq_u32 vcc, 0, v5
v_mov_b32 v5, 0x44000000
s_nop 0
v_cndmask_b32 v5, 0, v5, vcc
s_lshl_b32 s16, s9, 11
s_add_u32 s16, s16, 36864
v_lshlrev_b32 v4, 6, v4
v_lshrrev_b32 v6, 5, v1
v_lshl_add_u32 v4, v6, 3, v4
v_add_u32 v4, s16, v4
v_add_u32 v6, s16, v0
s_waitcnt lgkmcnt(0)
v_mul_f32 v80, v80, v5
v_mul_f32 v81, v81, v5
v_mul_f32 v82, v82, v5
v_mul_f32 v83, v83, v5
v_mul_f32 v84, v84, v5
v_mul_f32 v85, v85, v5
v_mul_f32 v86, v86, v5
v_mul_f32 v87, v87, v5
v_mul_f32 v88, v88, v5
v_mul_f32 v89, v89, v5
v_mul_f32 v90, v90, v5
v_mul_f32 v91, v91, v5
v_mul_f32 v92, v92, v5
v_mul_f32 v93, v93, v5
v_mul_f32 v94, v94, v5
v_mul_f32 v95, v95, v5
v_fma_f32 v16, v16, v64, -v80
v_fma_f32 v17, v17, v65, -v81
v_fma_f32 v18, v18, v66, -v82
v_fma_f32 v19, v19, v67, -v83
v_fma_f32 v20, v20, v68, -v84
v_fma_f32 v21, v21, v69, -v85
v_fma_f32 v22, v22, v70, -v86
v_fma_f32 v23, v23, v71, -v87
v_fma_f32 v24, v24, v72, -v88
v_fma_f32 v25, v25, v73, -v89
v_fma_f32 v26, v26, v74, -v90
v_fma_f32 v27, v27, v75, -v91
v_fma_f32 v28, v28, v76, -v92
v_fma_f32 v29, v29, v77, -v93
v_fma_f32 v30, v30, v78, -v94
v_fma_f32 v31, v31, v79, -v95
v_cvt_pk_bf16_f32 v32, v16, v17
v_cvt_pk_bf16_f32 v33, v18, v19
v_cvt_pk_bf16_f32 v34, v20, v21
v_cvt_pk_bf16_f32 v35, v22, v23
v_cvt_pk_bf16_f32 v36, v24, v25
v_cvt_pk_bf16_f32 v37, v26, v27
v_cvt_pk_bf16_f32 v38, v28, v29
v_cvt_pk_bf16_f32 v39, v30, v31
ds_write_b64 v4, v[32:33] offset:0
ds_write_b64 v4, v[34:35] offset:16
ds_write_b64 v4, v[36:37] offset:32
ds_write_b64 v4, v[38:39] offset:48
s_lshl_b32 s16, s14, 15
s_lshl_b32 s17, s60, 13
s_add_u32 s16, s16, s17
s_lshl_b32 s17, s9, 11
s_add_u32 s16, s16, s17
s_add_u32 s16, s16, 6291456
s_add_u32 s34, s4, s16
s_addc_u32 s35, s5, 0
s_waitcnt lgkmcnt(0)
ds_read_b128 v[40:43], v6
ds_read_b128 v[44:47], v6 offset:1024
s_waitcnt lgkmcnt(1)
global_store_dwordx4 v0, v[40:43], s[34:35] sc1
s_waitcnt lgkmcnt(0)
global_store_dwordx4 v0, v[44:47], s[34:35] offset:1024 sc1
s_waitcnt vmcnt(0)
s_barrier
s_cmp_lg_u32 s9, 0
s_cbranch_scc1 L_t1f_10
s_cmp_eq_u32 s15, 1
s_cbranch_scc1 L_sbd_12
s_mov_b32 s10, 0
v_mov_b32 v2, 0
L_sb_11:
global_load_dword v3, v2, s[6:7] offset:128 sc1
s_add_u32 s10, s10, 1
s_cmp_gt_u32 s10, 400000
s_cbranch_scc1 L_fail
s_waitcnt vmcnt(0)
v_cmp_ne_u32 vcc, 0x100, v3
s_cbranch_vccnz L_sb_11
s_mov_b32 s15, 1
L_sbd_12:
s_lshl_b32 s16, s14, 2
s_add_u32 s16, s16, s60
s_and_b32 s17, s16, 3
s_lshl_b32 s17, s17, 2
s_lshr_b32 s16, s16, 2
s_lshl_b32 s16, s16, 7
s_add_u32 s16, s16, s17
s_add_u32 s16, s16, 1048576
v_mov_b32 v2, s16
v_mov_b32 v3, 1
s_mov_b64 exec, 1
global_store_dword v2, v3, s[4:5] sc1
s_mov_b64 exec, -1
L_t1f_10:
s_add_u32 s14, s14, s62
s_cmp_lt_u32 s14, 64
s_cbranch_scc1 L_t1l
L_layer:
s_cmp_ge_u32 s8, 132
s_cbranch_scc1 L_row
s_cmp_gt_u32 s8, 128
s_cbranch_scc1 L_q
s_lshr_b32 s16, s9, 1
s_and_b32 s45, s9, 1
s_lshl_b32 s40, s8, 1
s_add_u32 s40, s40, s16
s_add_u32 s40, s40, 1
s_min_u32 s40, s40, 255
s_lshl_b32 s17, s16, 8
s_lshl_b32 s18, s16, 6
s_cmp_eq_u32 s8, 128
s_cselect_b32 s41, s17, s40
s_cselect_b32 s40, 0, s40
s_cselect_b32 s42, 0, -1
s_cselect_b32 s44, s18, 0
s_mov_b32 s43, 0x36000000
s_cselect_b32 s43, 0x35800000, s43
s_cmp_eq_u32 s46, 0
s_cselect_b32 s16, 48, 56
s_cmp_eq_u32 s46, 2
s_cselect_b32 s16, 40, s16
s_load_dwordx2 s[36:37], s[0:1], s16
v_lshrrev_b32 v2, 3, v1
s_lshl_b32 s16, s9, 7
v_add_u32 v2, s16, v2
v_lshlrev_b32 v2, 13, v2
v_and_b32 v3, 7, v1
v_lshl_add_u32 v2, v3, 4, v2
s_and_b32 s16, s8, 63
s_lshl_b32 s16, s16, 7
v_add_u32 v2, s16, v2
s_lshl_b32 s16, s9, 14
s_waitcnt lgkmcnt(0)
s_add_u32 m0, s16, 65536
s_nop 0
global_load_lds_dwordx4 v2, s[36:37]
s_add_u32 m0, s16, 66560
v_add_u32 v2, 0x10000, v2
global_load_lds_dwordx4 v2, s[36:37]
s_add_u32 m0, s16, 67584
v_add_u32 v2, 0x10000, v2
global_load_lds_dwordx4 v2, s[36:37]
s_add_u32 m0, s16, 68608
v_add_u32 v2, 0x10000, v2
global_load_lds_dwordx4 v2, s[36:37]
s_add_u32 m0, s16, 69632
v_add_u32 v2, 0x10000, v2
global_load_lds_dwordx4 v2, s[36:37]
s_add_u32 m0, s16, 70656
v_add_u32 v2, 0x10000, v2
global_load_lds_dwordx4 v2, s[36:37]
s_add_u32 m0, s16, 71680
v_add_u32 v2, 0x10000, v2
global_load_lds_dwordx4 v2, s[36:37]
s_add_u32 m0, s16, 72704
v_add_u32 v2, 0x10000, v2
global_load_lds_dwordx4 v2, s[36:37]
s_add_u32 m0, s16, 73728
v_add_u32 v2, 0x10000, v2
global_load_lds_dwordx4 v2, s[36:37]
s_add_u32 m0, s16, 74752
v_add_u32 v2, 0x10000, v2
global_load_lds_dwordx4 v2, s[36:37]
s_add_u32 m0, s16, 75776
v_add_u32 v2, 0x10000, v2
global_load_lds_dwordx4 v2, s[36:37]
s_add_u32 m0, s16, 76800
v_add_u32 v2, 0x10000, v2
global_load_lds_dwordx4 v2, s[36:37]
s_add_u32 m0, s16, 77824
v_add_u32 v2, 0x10000, v2
global_load_lds_dwordx4 v2, s[36:37]
s_add_u32 m0, s16, 78848
v_add_u32 v2, 0x10000, v2
global_load_lds_dwordx4 v2, s[36:37]
s_add_u32 m0, s16, 79872
v_add_u32 v2, 0x10000, v2
global_load_lds_dwordx4 v2, s[36:37]
s_add_u32 m0, s16, 80896
v_add_u32 v2, 0x10000, v2
global_load_lds_dwordx4 v2, s[36:37]
s_cmp_eq_u32 s11, 0
s_cbranch_scc0 L_w1
s_load_dwordx2 s[32:33], s[0:1], 8
s_load_dwordx2 s[34:35], s[0:1], 16
v_and_b32 v2, 31, v1
s_lshl_b32 s16, s45, 5
v_add_u32 v2, s16, v2
v_lshrrev_b32 v3, 5, v1
v_lshl_add_u32 v2, v3, 8, v2
v_mul_u32_u24 v2, 514, v2
s_lshl_b32 s16, s41, 1
v_add_u32 v2, s16, v2
s_waitcnt lgkmcnt(0)
v_add_u32 v3, 0, v2
global_load_ushort v200, v3, s[32:33]
global_load_ushort v216, v3, s[34:35]
v_add_u32 v3, 32896, v2
global_load_ushort v201, v3, s[32:33]
global_load_ushort v217, v3, s[34:35]
v_add_u32 v3, 65792, v2
global_load_ushort v202, v3, s[32:33]
global_load_ushort v218, v3, s[34:35]
v_add_u32 v3, 98688, v2
global_load_ushort v203, v3, s[32:33]
global_load_ushort v219, v3, s[34:35]
v_add_u32 v3, 263168, v2
global_load_ushort v204, v3, s[32:33]
global_load_ushort v220, v3, s[34:35]
v_add_u32 v3, 296064, v2
global_load_ushort v205, v3, s[32:33]
global_load_ushort v221, v3, s[34:35]
v_add_u32 v3, 328960, v2
global_load_ushort v206, v3, s[32:33]
global_load_ushort v222, v3, s[34:35]
v_add_u32 v3, 361856, v2
global_load_ushort v207, v3, s[32:33]
global_load_ushort v223, v3, s[34:35]
v_add_u32 v3, 526336, v2
global_load_ushort v208, v3, s[32:33]
global_load_ushort v224, v3, s[34:35]
v_add_u32 v3, 559232, v2
global_load_ushort v209, v3, s[32:33]
global_load_ushort v225, v3, s[34:35]
v_add_u32 v3, 592128, v2
global_load_ushort v210, v3, s[32:33]
global_load_ushort v226, v3, s[34:35]
v_add_u32 v3, 625024, v2
global_load_ushort v211, v3, s[32:33]
global_load_ushort v227, v3, s[34:35]
v_add_u32 v3, 789504, v2
global_load_ushort v212, v3, s[32:33]
global_load_ushort v228, v3, s[34:35]
v_add_u32 v3, 822400, v2
global_load_ushort v213, v3, s[32:33]
global_load_ushort v229, v3, s[34:35]
v_add_u32 v3, 855296, v2
global_load_ushort v214, v3, s[32:33]
global_load_ushort v230, v3, s[34:35]
v_add_u32 v3, 888192, v2
global_load_ushort v215, v3, s[32:33]
global_load_ushort v231, v3, s[34:35]
L_w1:
v_and_b32 v2, 31, v1
s_lshl_b32 s16, s45, 5
v_add_u32 v2, s16, v2
v_cvt_f32_u32 v2, v2
v_mul_f32 v2, 0x3c800000, v2
v_lshrrev_b32 v3, 5, v1
v_lshlrev_b32 v3, 2, v3
v_cvt_f32_u32 v3, v3
v_mul_f32 v3, v3, v2
v_fmamk_f32 v16, v2, 0x0, v3
v_fract_f32 v16, v16
v_cos_f32 v8, v16
v_sin_f32 v16, v16
v_fmamk_f32 v17, v2, 0x3f800000, v3
v_fract_f32 v17, v17
v_cos_f32 v9, v17
v_sin_f32 v17, v17
v_fmamk_f32 v18, v2, 0x40000000, v3
v_fract_f32 v18, v18
v_cos_f32 v10, v18
v_sin_f32 v18, v18
v_fmamk_f32 v19, v2, 0x40400000, v3
v_fract_f32 v19, v19
v_cos_f32 v11, v19
v_sin_f32 v19, v19
v_fmamk_f32 v20, v2, 0x41000000, v3
v_fract_f32 v20, v20
v_cos_f32 v12, v20
v_sin_f32 v20, v20
v_fmamk_f32 v21, v2, 0x41100000, v3
v_fract_f32 v21, v21
v_cos_f32 v13, v21
v_sin_f32 v21, v21
v_fmamk_f32 v22, v2, 0x41200000, v3
v_fract_f32 v22, v22
v_cos_f32 v14, v22
v_sin_f32 v22, v22
v_fmamk_f32 v23, v2, 0x41300000, v3
v_fract_f32 v23, v23
v_cos_f32 v15, v23
v_sin_f32 v23, v23
v_cvt_pk_bf16_f32 v128, v8, v9
v_cvt_pk_bf16_f32 v144, v16, v17
v_xor_b32 v160, 0x80008000, v144
v_cvt_pk_bf16_f32 v129, v10, v11
v_cvt_pk_bf16_f32 v145, v18, v19
v_xor_b32 v161, 0x80008000, v145
v_cvt_pk_bf16_f32 v130, v12, v13
v_cvt_pk_bf16_f32 v146, v20, v21
v_xor_b32 v162, 0x80008000, v146
v_cvt_pk_bf16_f32 v131, v14, v15
v_cvt_pk_bf16_f32 v147, v22, v23
v_xor_b32 v163, 0x80008000, v147
v_fmamk_f32 v16, v2, 0x41800000, v3
v_fract_f32 v16, v16
v_cos_f32 v8, v16
v_sin_f32 v16, v16
v_fmamk_f32 v17, v2, 0x41880000, v3
v_fract_f32 v17, v17
v_cos_f32 v9, v17
v_sin_f32 v17, v17
v_fmamk_f32 v18, v2, 0x41900000, v3
v_fract_f32 v18, v18
v_cos_f32 v10, v18
v_sin_f32 v18, v18
v_fmamk_f32 v19, v2, 0x41980000, v3
v_fract_f32 v19, v19
v_cos_f32 v11, v19
v_sin_f32 v19, v19
v_fmamk_f32 v20, v2, 0x41c00000, v3
v_fract_f32 v20, v20
v_cos_f32 v12, v20
v_sin_f32 v20, v20
v_fmamk_f32 v21, v2, 0x41c80000, v3
v_fract_f32 v21, v21
v_cos_f32 v13, v21
v_sin_f32 v21, v21
v_fmamk_f32 v22, v2, 0x41d00000, v3
v_fract_f32 v22, v22
v_cos_f32 v14, v22
v_sin_f32 v22, v22
v_fmamk_f32 v23, v2, 0x41d80000, v3
v_fract_f32 v23, v23
v_cos_f32 v15, v23
v_sin_f32 v23, v23
v_cvt_pk_bf16_f32 v132, v8, v9
v_cvt_pk_bf16_f32 v148, v16, v17
v_xor_b32 v164, 0x80008000, v148
v_cvt_pk_bf16_f32 v133, v10, v11
v_cvt_pk_bf16_f32 v149, v18, v19
v_xor_b32 v165, 0x80008000, v149
v_cvt_pk_bf16_f32 v134, v12, v13
v_cvt_pk_bf16_f32 v150, v20, v21
v_xor_b32 v166, 0x80008000, v150
v_cvt_pk_bf16_f32 v135, v14, v15
v_cvt_pk_bf16_f32 v151, v22, v23
v_xor_b32 v167, 0x80008000, v151
v_fmamk_f32 v16, v2, 0x42000000, v3
v_fract_f32 v16, v16
v_cos_f32 v8, v16
v_sin_f32 v16, v16
v_fmamk_f32 v17, v2, 0x42040000, v3
v_fract_f32 v17, v17
v_cos_f32 v9, v17
v_sin_f32 v17, v17
v_fmamk_f32 v18, v2, 0x42080000, v3
v_fract_f32 v18, v18
v_cos_f32 v10, v18
v_sin_f32 v18, v18
v_fmamk_f32 v19, v2, 0x420c0000, v3
v_fract_f32 v19, v19
v_cos_f32 v11, v19
v_sin_f32 v19, v19
v_fmamk_f32 v20, v2, 0x42200000, v3
v_fract_f32 v20, v20
v_cos_f32 v12, v20
v_sin_f32 v20, v20
v_fmamk_f32 v21, v2, 0x42240000, v3
v_fract_f32 v21, v21
v_cos_f32 v13, v21
v_sin_f32 v21, v21
v_fmamk_f32 v22, v2, 0x42280000, v3
v_fract_f32 v22, v22
v_cos_f32 v14, v22
v_sin_f32 v22, v22
v_fmamk_f32 v23, v2, 0x422c0000, v3
v_fract_f32 v23, v23
v_cos_f32 v15, v23
v_sin_f32 v23, v23
v_cvt_pk_bf16_f32 v136, v8, v9
v_cvt_pk_bf16_f32 v152, v16, v17
v_xor_b32 v168, 0x80008000, v152
v_cvt_pk_bf16_f32 v137, v10, v11
v_cvt_pk_bf16_f32 v153, v18, v19
v_xor_b32 v169, 0x80008000, v153
v_cvt_pk_bf16_f32 v138, v12, v13
v_cvt_pk_bf16_f32 v154, v20, v21
v_xor_b32 v170, 0x80008000, v154
v_cvt_pk_bf16_f32 v139, v14, v15
v_cvt_pk_bf16_f32 v155, v22, v23
v_xor_b32 v171, 0x80008000, v155
v_fmamk_f32 v16, v2, 0x42400000, v3
v_fract_f32 v16, v16
v_cos_f32 v8, v16
v_sin_f32 v16, v16
v_fmamk_f32 v17, v2, 0x42440000, v3
v_fract_f32 v17, v17
v_cos_f32 v9, v17
v_sin_f32 v17, v17
v_fmamk_f32 v18, v2, 0x42480000, v3
v_fract_f32 v18, v18
v_cos_f32 v10, v18
v_sin_f32 v18, v18
v_fmamk_f32 v19, v2, 0x424c0000, v3
v_fract_f32 v19, v19
v_cos_f32 v11, v19
v_sin_f32 v19, v19
v_fmamk_f32 v20, v2, 0x42600000, v3
v_fract_f32 v20, v20
v_cos_f32 v12, v20
v_sin_f32 v20, v20
v_fmamk_f32 v21, v2, 0x42640000, v3
v_fract_f32 v21, v21
v_cos_f32 v13, v21
v_sin_f32 v21, v21
v_fmamk_f32 v22, v2, 0x42680000, v3
v_fract_f32 v22, v22
v_cos_f32 v14, v22
v_sin_f32 v22, v22
v_fmamk_f32 v23, v2, 0x426c0000, v3
v_fract_f32 v23, v23
v_cos_f32 v15, v23
v_sin_f32 v23, v23
v_cvt_pk_bf16_f32 v140, v8, v9
v_cvt_pk_bf16_f32 v156, v16, v17
v_xor_b32 v172, 0x80008000, v156
v_cvt_pk_bf16_f32 v141, v10, v11
v_cvt_pk_bf16_f32 v157, v18, v19
v_xor_b32 v173, 0x80008000, v157
v_cvt_pk_bf16_f32 v142, v12, v13
v_cvt_pk_bf16_f32 v158, v20, v21
v_xor_b32 v174, 0x80008000, v158
v_cvt_pk_bf16_f32 v143, v14, v15
v_cvt_pk_bf16_f32 v159, v22, v23
v_xor_b32 v175, 0x80008000, v159
v_and_b32 v2, 31, v1
v_cvt_f32_u32 v2, v2
v_mul_f32 v2, 0x3d000000, v2
v_lshrrev_b32 v3, 5, v1
v_lshlrev_b32 v3, 2, v3
v_cvt_f32_u32 v3, v3
v_mul_f32 v3, v3, v2
v_fmamk_f32 v16, v2, 0x0, v3
v_fract_f32 v16, v16
v_cos_f32 v8, v16
v_sin_f32 v16, v16
v_fmamk_f32 v17, v2, 0x3f800000, v3
v_fract_f32 v17, v17
v_cos_f32 v9, v17
v_sin_f32 v17, v17
v_fmamk_f32 v18, v2, 0x40000000, v3
v_fract_f32 v18, v18
v_cos_f32 v10, v18
v_sin_f32 v18, v18
v_fmamk_f32 v19, v2, 0x40400000, v3
v_fract_f32 v19, v19
v_cos_f32 v11, v19
v_sin_f32 v19, v19
v_fmamk_f32 v20, v2, 0x41000000, v3
v_fract_f32 v20, v20
v_cos_f32 v12, v20
v_sin_f32 v20, v20
v_fmamk_f32 v21, v2, 0x41100000, v3
v_fract_f32 v21, v21
v_cos_f32 v13, v21
v_sin_f32 v21, v21
v_fmamk_f32 v22, v2, 0x41200000, v3
v_fract_f32 v22, v22
v_cos_f32 v14, v22
v_sin_f32 v22, v22
v_fmamk_f32 v23, v2, 0x41300000, v3
v_fract_f32 v23, v23
v_cos_f32 v15, v23
v_sin_f32 v23, v23
v_cvt_pk_bf16_f32 v176, v8, v9
v_cvt_pk_bf16_f32 v184, v16, v17
v_xor_b32 v192, 0x80008000, v184
v_cvt_pk_bf16_f32 v177, v10, v11
v_cvt_pk_bf16_f32 v185, v18, v19
v_xor_b32 v193, 0x80008000, v185
v_cvt_pk_bf16_f32 v178, v12, v13
v_cvt_pk_bf16_f32 v186, v20, v21
v_xor_b32 v194, 0x80008000, v186
v_cvt_pk_bf16_f32 v179, v14, v15
v_cvt_pk_bf16_f32 v187, v22, v23
v_xor_b32 v195, 0x80008000, v187
v_fmamk_f32 v16, v2, 0x41800000, v3
v_fract_f32 v16, v16
v_cos_f32 v8, v16
v_sin_f32 v16, v16
v_fmamk_f32 v17, v2, 0x41880000, v3
v_fract_f32 v17, v17
v_cos_f32 v9, v17
v_sin_f32 v17, v17
v_fmamk_f32 v18, v2, 0x41900000, v3
v_fract_f32 v18, v18
v_cos_f32 v10, v18
v_sin_f32 v18, v18
v_fmamk_f32 v19, v2, 0x41980000, v3
v_fract_f32 v19, v19
v_cos_f32 v11, v19
v_sin_f32 v19, v19
v_fmamk_f32 v20, v2, 0x41c00000, v3
v_fract_f32 v20, v20
v_cos_f32 v12, v20
v_sin_f32 v20, v20
v_fmamk_f32 v21, v2, 0x41c80000, v3
v_fract_f32 v21, v21
v_cos_f32 v13, v21
v_sin_f32 v21, v21
v_fmamk_f32 v22, v2, 0x41d00000, v3
v_fract_f32 v22, v22
v_cos_f32 v14, v22
v_sin_f32 v22, v22
v_fmamk_f32 v23, v2, 0x41d80000, v3
v_fract_f32 v23, v23
v_cos_f32 v15, v23
v_sin_f32 v23, v23
v_cvt_pk_bf16_f32 v180, v8, v9
v_cvt_pk_bf16_f32 v188, v16, v17
v_xor_b32 v196, 0x80008000, v188
v_cvt_pk_bf16_f32 v181, v10, v11
v_cvt_pk_bf16_f32 v189, v18, v19
v_xor_b32 v197, 0x80008000, v189
v_cvt_pk_bf16_f32 v182, v12, v13
v_cvt_pk_bf16_f32 v190, v20, v21
v_xor_b32 v198, 0x80008000, v190
v_cvt_pk_bf16_f32 v183, v14, v15
v_cvt_pk_bf16_f32 v191, v22, v23
v_xor_b32 v199, 0x80008000, v191
v_and_b32 v2, 31, v1
s_lshl_b32 s16, s45, 5
v_add_u32 v2, s16, v2
v_cvt_f32_u32 v2, v2
v_mul_f32 v2, 0x3a000000, v2
v_lshrrev_b32 v3, 5, v1
v_lshlrev_b32 v3, 2, v3
v_cvt_f32_u32 v3, v3
v_mul_f32 v3, v3, v2
v_fmamk_f32 v80, v2, 0x0, v3
v_cos_f32 v64, v80
v_sin_f32 v80, v80
v_fmamk_f32 v81, v2, 0x3f800000, v3
v_cos_f32 v65, v81
v_sin_f32 v81, v81
v_fmamk_f32 v82, v2, 0x40000000, v3
v_cos_f32 v66, v82
v_sin_f32 v82, v82
v_fmamk_f32 v83, v2, 0x40400000, v3
v_cos_f32 v67, v83
v_sin_f32 v83, v83
v_fmamk_f32 v84, v2, 0x41000000, v3
v_cos_f32 v68, v84
v_sin_f32 v84, v84
v_fmamk_f32 v85, v2, 0x41100000, v3
v_cos_f32 v69, v85
v_sin_f32 v85, v85
v_fmamk_f32 v86, v2, 0x41200000, v3
v_cos_f32 v70, v86
v_sin_f32 v86, v86
v_fmamk_f32 v87, v2, 0x41300000, v3
v_cos_f32 v71, v87
v_sin_f32 v87, v87
v_fmamk_f32 v88, v2, 0x41800000, v3
v_cos_f32 v72, v88
v_sin_f32 v88, v88
v_fmamk_f32 v89, v2, 0x41880000, v3
v_cos_f32 v73, v89
v_sin_f32 v89, v89
v_fmamk_f32 v90, v2, 0x41900000, v3
v_cos_f32 v74, v90
v_sin_f32 v90, v90
v_fmamk_f32 v91, v2, 0x41980000, v3
v_cos_f32 v75, v91
v_sin_f32 v91, v91
v_fmamk_f32 v92, v2, 0x41c00000, v3
v_cos_f32 v76, v92
v_sin_f32 v92, v92
v_fmamk_f32 v93, v2, 0x41c80000, v3
v_cos_f32 v77, v93
v_sin_f32 v93, v93
v_fmamk_f32 v94, v2, 0x41d00000, v3
v_cos_f32 v78, v94
v_sin_f32 v94, v94
v_fmamk_f32 v95, v2, 0x41d80000, v3
v_cos_f32 v79, v95
v_sin_f32 v95, v95
v_and_b32 v2, 31, v1
v_cvt_f32_u32 v2, v2
v_mul_f32 v2, 0x3a000000, v2
v_lshrrev_b32 v3, 5, v1
v_lshlrev_b32 v3, 2, v3
v_add_u32 v3, s16, v3
v_cvt_f32_u32 v3, v3
v_mul_f32 v3, v3, v2
v_fmamk_f32 v112, v2, 0x0, v3
v_cos_f32 v96, v112
v_sin_f32 v112, v112
v_fmamk_f32 v113, v2, 0x3f800000, v3
v_cos_f32 v97, v113
v_sin_f32 v113, v113
v_fmamk_f32 v114, v2, 0x40000000, v3
v_cos_f32 v98, v114
v_sin_f32 v114, v114
v_fmamk_f32 v115, v2, 0x40400000, v3
v_cos_f32 v99, v115
v_sin_f32 v115, v115
v_fmamk_f32 v116, v2, 0x41000000, v3
v_cos_f32 v100, v116
v_sin_f32 v116, v116
v_fmamk_f32 v117, v2, 0x41100000, v3
v_cos_f32 v101, v117
v_sin_f32 v117, v117
v_fmamk_f32 v118, v2, 0x41200000, v3
v_cos_f32 v102, v118
v_sin_f32 v118, v118
v_fmamk_f32 v119, v2, 0x41300000, v3
v_cos_f32 v103, v119
v_sin_f32 v119, v119
v_fmamk_f32 v120, v2, 0x41800000, v3
v_cos_f32 v104, v120
v_sin_f32 v120, v120
v_fmamk_f32 v121, v2, 0x41880000, v3
v_cos_f32 v105, v121
v_sin_f32 v121, v121
v_fmamk_f32 v122, v2, 0x41900000, v3
v_cos_f32 v106, v122
v_sin_f32 v122, v122
v_fmamk_f32 v123, v2, 0x41980000, v3
v_cos_f32 v107, v123
v_sin_f32 v123, v123
v_fmamk_f32 v124, v2, 0x41c00000, v3
v_cos_f32 v108, v124
v_sin_f32 v124, v124
v_fmamk_f32 v125, v2, 0x41c80000, v3
v_cos_f32 v109, v125
v_sin_f32 v125, v125
v_fmamk_f32 v126, v2, 0x41d00000, v3
v_cos_f32 v110, v126
v_sin_f32 v126, v126
v_fmamk_f32 v127, v2, 0x41d80000, v3
v_cos_f32 v111, v127
v_sin_f32 v127, v127
s_waitcnt vmcnt(0)
s_cmp_eq_u32 s11, 0
s_cbranch_scc0 L_w2
v_lshlrev_b32 v200, 16, v200
v_mul_f32 v200, s43, v200
v_lshlrev_b32 v201, 16, v201
v_mul_f32 v201, s43, v201
v_lshlrev_b32 v202, 16, v202
v_mul_f32 v202, s43, v202
v_lshlrev_b32 v203, 16, v203
v_mul_f32 v203, s43, v203
v_lshlrev_b32 v204, 16, v204
v_mul_f32 v204, s43, v204
v_lshlrev_b32 v205, 16, v205
v_mul_f32 v205, s43, v205
v_lshlrev_b32 v206, 16, v206
v_mul_f32 v206, s43, v206
v_lshlrev_b32 v207, 16, v207
v_mul_f32 v207, s43, v207
v_lshlrev_b32 v208, 16, v208
v_mul_f32 v208, s43, v208
v_lshlrev_b32 v209, 16, v209
v_mul_f32 v209, s43, v209
v_lshlrev_b32 v210, 16, v210
v_mul_f32 v210, s43, v210
v_lshlrev_b32 v211, 16, v211
v_mul_f32 v211, s43, v211
v_lshlrev_b32 v212, 16, v212
v_mul_f32 v212, s43, v212
v_lshlrev_b32 v213, 16, v213
v_mul_f32 v213, s43, v213
v_lshlrev_b32 v214, 16, v214
v_mul_f32 v214, s43, v214
v_lshlrev_b32 v215, 16, v215
v_mul_f32 v215, s43, v215
v_lshlrev_b32 v216, 16, v216
v_mul_f32 v216, s43, v216
v_lshlrev_b32 v217, 16, v217
v_mul_f32 v217, s43, v217
v_lshlrev_b32 v218, 16, v218
v_mul_f32 v218, s43, v218
v_lshlrev_b32 v219, 16, v219
v_mul_f32 v219, s43, v219
v_lshlrev_b32 v220, 16, v220
v_mul_f32 v220, s43, v220
v_lshlrev_b32 v221, 16, v221
v_mul_f32 v221, s43, v221
v_lshlrev_b32 v222, 16, v222
v_mul_f32 v222, s43, v222
v_lshlrev_b32 v223, 16, v223
v_mul_f32 v223, s43, v223
v_lshlrev_b32 v224, 16, v224
v_mul_f32 v224, s43, v224
v_lshlrev_b32 v225, 16, v225
v_mul_f32 v225, s43, v225
v_lshlrev_b32 v226, 16, v226
v_mul_f32 v226, s43, v226
v_lshlrev_b32 v227, 16, v227
v_mul_f32 v227, s43, v227
v_lshlrev_b32 v228, 16, v228
v_mul_f32 v228, s43, v228
v_lshlrev_b32 v229, 16, v229
v_mul_f32 v229, s43, v229
v_lshlrev_b32 v230, 16, v230
v_mul_f32 v230, s43, v230
v_lshlrev_b32 v231, 16, v231
v_mul_f32 v231, s43, v231
s_lshl_b32 s16, s9, 13
s_add_u32 s16, s16, 131072
v_add_u32 v2, s16, v0
ds_write_b128 v2, v[200:203] offset:0
ds_write_b128 v2, v[204:207] offset:1024
ds_write_b128 v2, v[208:211] offset:2048
ds_write_b128 v2, v[212:215] offset:3072
ds_write_b128 v2, v[216:219] offset:4096
ds_write_b128 v2, v[220:223] offset:5120
ds_write_b128 v2, v[224:227] offset:6144
ds_write_b128 v2, v[228:231] offset:7168
s_waitcnt lgkmcnt(0)
L_w2:
s_lshl_b32 s16, s9, 13
s_add_u32 s16, s16, 131072
v_add_u32 v2, s16, v0
ds_read_b128 v[200:203], v2 offset:0
ds_read_b128 v[204:207], v2 offset:1024
ds_read_b128 v[208:211], v2 offset:2048
ds_read_b128 v[212:215], v2 offset:3072
ds_read_b128 v[216:219], v2 offset:4096
ds_read_b128 v[220:223], v2 offset:5120
ds_read_b128 v[224:227], v2 offset:6144
ds_read_b128 v[228:231], v2 offset:7168
s_waitcnt lgkmcnt(0)
v_lshrrev_b32 v4, 5, v1
v_lshlrev_b32 v4, 3, v4
v_bfe_u32 v5, v1, 2, 2
v_add_u32 v4, v4, v5
v_lshlrev_b32 v4, 7, v4
v_bfe_u32 v5, v1, 4, 1
v_lshl_add_u32 v4, v5, 5, v4
v_and_b32 v5, 3, v1
v_lshl_add_u32 v4, v5, 3, v4
v_add_u32 v4, 65536, v4
s_barrier
ds_read_b64_tr_b16 a[0:1], v4 offset:0
ds_read_b64_tr_b16 a[2:3], v4 offset:512
ds_read_b64_tr_b16 a[128:129], v4 offset:64
ds_read_b64_tr_b16 a[130:131], v4 offset:576
ds_read_b64_tr_b16 a[4:5], v4 offset:2048
ds_read_b64_tr_b16 a[6:7], v4 offset:2560
ds_read_b64_tr_b16 a[132:133], v4 offset:2112
ds_read_b64_tr_b16 a[134:135], v4 offset:2624
ds_read_b64_tr_b16 a[8:9], v4 offset:4096
ds_read_b64_tr_b16 a[10:11], v4 offset:4608
ds_read_b64_tr_b16 a[136:137], v4 offset:4160
ds_read_b64_tr_b16 a[138:139], v4 offset:4672
s_waitcnt lgkmcnt(2)
ds_read_b64_tr_b16 a[12:13], v4 offset:6144
ds_read_b64_tr_b16 a[14:15], v4 offset:6656
ds_read_b64_tr_b16 a[140:141], v4 offset:6208
ds_read_b64_tr_b16 a[142:143], v4 offset:6720
ds_read_b64_tr_b16 a[16:17], v4 offset:8192
ds_read_b64_tr_b16 a[18:19], v4 offset:8704
ds_read_b64_tr_b16 a[144:145], v4 offset:8256
ds_read_b64_tr_b16 a[146:147], v4 offset:8768
ds_read_b64_tr_b16 a[20:21], v4 offset:10240
ds_read_b64_tr_b16 a[22:23], v4 offset:10752
ds_read_b64_tr_b16 a[148:149], v4 offset:10304
ds_read_b64_tr_b16 a[150:151], v4 offset:10816
s_waitcnt lgkmcnt(2)
ds_read_b64_tr_b16 a[24:25], v4 offset:12288
ds_read_b64_tr_b16 a[26:27], v4 offset:12800
ds_read_b64_tr_b16 a[152:153], v4 offset:12352
ds_read_b64_tr_b16 a[154:155], v4 offset:12864
ds_read_b64_tr_b16 a[28:29], v4 offset:14336
ds_read_b64_tr_b16 a[30:31], v4 offset:14848
ds_read_b64_tr_b16 a[156:157], v4 offset:14400
ds_read_b64_tr_b16 a[158:159], v4 offset:14912
ds_read_b64_tr_b16 a[32:33], v4 offset:16384
ds_read_b64_tr_b16 a[34:35], v4 offset:16896
ds_read_b64_tr_b16 a[160:161], v4 offset:16448
ds_read_b64_tr_b16 a[162:163], v4 offset:16960
s_waitcnt lgkmcnt(2)
ds_read_b64_tr_b16 a[36:37], v4 offset:18432
ds_read_b64_tr_b16 a[38:39], v4 offset:18944
ds_read_b64_tr_b16 a[164:165], v4 offset:18496
ds_read_b64_tr_b16 a[166:167], v4 offset:19008
ds_read_b64_tr_b16 a[40:41], v4 offset:20480
ds_read_b64_tr_b16 a[42:43], v4 offset:20992
ds_read_b64_tr_b16 a[168:169], v4 offset:20544
ds_read_b64_tr_b16 a[170:171], v4 offset:21056
ds_read_b64_tr_b16 a[44:45], v4 offset:22528
ds_read_b64_tr_b16 a[46:47], v4 offset:23040
ds_read_b64_tr_b16 a[172:173], v4 offset:22592
ds_read_b64_tr_b16 a[174:175], v4 offset:23104
s_waitcnt lgkmcnt(2)
ds_read_b64_tr_b16 a[48:49], v4 offset:24576
ds_read_b64_tr_b16 a[50:51], v4 offset:25088
ds_read_b64_tr_b16 a[176:177], v4 offset:24640
ds_read_b64_tr_b16 a[178:179], v4 offset:25152
ds_read_b64_tr_b16 a[52:53], v4 offset:26624
ds_read_b64_tr_b16 a[54:55], v4 offset:27136
ds_read_b64_tr_b16 a[180:181], v4 offset:26688
ds_read_b64_tr_b16 a[182:183], v4 offset:27200
ds_read_b64_tr_b16 a[56:57], v4 offset:28672
ds_read_b64_tr_b16 a[58:59], v4 offset:29184
ds_read_b64_tr_b16 a[184:185], v4 offset:28736
ds_read_b64_tr_b16 a[186:187], v4 offset:29248
s_waitcnt lgkmcnt(2)
ds_read_b64_tr_b16 a[60:61], v4 offset:30720
ds_read_b64_tr_b16 a[62:63], v4 offset:31232
ds_read_b64_tr_b16 a[188:189], v4 offset:30784
ds_read_b64_tr_b16 a[190:191], v4 offset:31296
ds_read_b64_tr_b16 a[64:65], v4 offset:32768
ds_read_b64_tr_b16 a[66:67], v4 offset:33280
ds_read_b64_tr_b16 a[192:193], v4 offset:32832
ds_read_b64_tr_b16 a[194:195], v4 offset:33344
ds_read_b64_tr_b16 a[68:69], v4 offset:34816
ds_read_b64_tr_b16 a[70:71], v4 offset:35328
ds_read_b64_tr_b16 a[196:197], v4 offset:34880
ds_read_b64_tr_b16 a[198:199], v4 offset:35392
s_waitcnt lgkmcnt(2)
ds_read_b64_tr_b16 a[72:73], v4 offset:36864
ds_read_b64_tr_b16 a[74:75], v4 offset:37376
ds_read_b64_tr_b16 a[200:201], v4 offset:36928
ds_read_b64_tr_b16 a[202:203], v4 offset:37440
ds_read_b64_tr_b16 a[76:77], v4 offset:38912
ds_read_b64_tr_b16 a[78:79], v4 offset:39424
ds_read_b64_tr_b16 a[204:205], v4 offset:38976
ds_read_b64_tr_b16 a[206:207], v4 offset:39488
ds_read_b64_tr_b16 a[80:81], v4 offset:40960
ds_read_b64_tr_b16 a[82:83], v4 offset:41472
ds_read_b64_tr_b16 a[208:209], v4 offset:41024
ds_read_b64_tr_b16 a[210:211], v4 offset:41536
s_waitcnt lgkmcnt(2)
ds_read_b64_tr_b16 a[84:85], v4 offset:43008
ds_read_b64_tr_b16 a[86:87], v4 offset:43520
ds_read_b64_tr_b16 a[212:213], v4 offset:43072
ds_read_b64_tr_b16 a[214:215], v4 offset:43584
ds_read_b64_tr_b16 a[88:89], v4 offset:45056
ds_read_b64_tr_b16 a[90:91], v4 offset:45568
ds_read_b64_tr_b16 a[216:217], v4 offset:45120
ds_read_b64_tr_b16 a[218:219], v4 offset:45632
ds_read_b64_tr_b16 a[92:93], v4 offset:47104
ds_read_b64_tr_b16 a[94:95], v4 offset:47616
ds_read_b64_tr_b16 a[220:221], v4 offset:47168
ds_read_b64_tr_b16 a[222:223], v4 offset:47680
s_waitcnt lgkmcnt(2)
ds_read_b64_tr_b16 a[96:97], v4 offset:49152
ds_read_b64_tr_b16 a[98:99], v4 offset:49664
ds_read_b64_tr_b16 a[224:225], v4 offset:49216
ds_read_b64_tr_b16 a[226:227], v4 offset:49728
ds_read_b64_tr_b16 a[100:101], v4 offset:51200
ds_read_b64_tr_b16 a[102:103], v4 offset:51712
ds_read_b64_tr_b16 a[228:229], v4 offset:51264
ds_read_b64_tr_b16 a[230:231], v4 offset:51776
ds_read_b64_tr_b16 a[104:105], v4 offset:53248
ds_read_b64_tr_b16 a[106:107], v4 offset:53760
ds_read_b64_tr_b16 a[232:233], v4 offset:53312
ds_read_b64_tr_b16 a[234:235], v4 offset:53824
s_waitcnt lgkmcnt(2)
ds_read_b64_tr_b16 a[108:109], v4 offset:55296
ds_read_b64_tr_b16 a[110:111], v4 offset:55808
ds_read_b64_tr_b16 a[236:237], v4 offset:55360
ds_read_b64_tr_b16 a[238:239], v4 offset:55872
ds_read_b64_tr_b16 a[112:113], v4 offset:57344
ds_read_b64_tr_b16 a[114:115], v4 offset:57856
ds_read_b64_tr_b16 a[240:241], v4 offset:57408
ds_read_b64_tr_b16 a[242:243], v4 offset:57920
ds_read_b64_tr_b16 a[116:117], v4 offset:59392
ds_read_b64_tr_b16 a[118:119], v4 offset:59904
ds_read_b64_tr_b16 a[244:245], v4 offset:59456
ds_read_b64_tr_b16 a[246:247], v4 offset:59968
s_waitcnt lgkmcnt(2)
ds_read_b64_tr_b16 a[120:121], v4 offset:61440
ds_read_b64_tr_b16 a[122:123], v4 offset:61952
ds_read_b64_tr_b16 a[248:249], v4 offset:61504
ds_read_b64_tr_b16 a[250:251], v4 offset:62016
ds_read_b64_tr_b16 a[124:125], v4 offset:63488
ds_read_b64_tr_b16 a[126:127], v4 offset:64000
ds_read_b64_tr_b16 a[252:253], v4 offset:63552
ds_read_b64_tr_b16 a[254:255], v4 offset:64064
s_waitcnt lgkmcnt(0)
s_barrier
v_mov_b32 v8, 0x3f803f80
v_mov_b32 v9, 0x3f803f80
v_mov_b32 v10, 0x3f803f80
v_mov_b32 v11, 0x3f803f80
s_nop 1
v_mfma_f32_32x32x16_bf16 v[16:31], v[8:11], a[0:3], 0
v_mfma_f32_32x32x16_bf16 v[16:31], v[8:11], a[4:7], v[16:31]
v_mfma_f32_32x32x16_bf16 v[16:31], v[8:11], a[8:11], v[16:31]
v_mfma_f32_32x32x16_bf16 v[16:31], v[8:11], a[12:15], v[16:31]
v_mfma_f32_32x32x16_bf16 v[16:31], v[8:11], a[16:19], v[16:31]
v_mfma_f32_32x32x16_bf16 v[16:31], v[8:11], a[20:23], v[16:31]
v_mfma_f32_32x32x16_bf16 v[16:31], v[8:11], a[24:27], v[16:31]
v_mfma_f32_32x32x16_bf16 v[16:31], v[8:11], a[28:31], v[16:31]
v_mfma_f32_32x32x16_bf16 v[16:31], v[8:11], a[32:35], v[16:31]
v_mfma_f32_32x32x16_bf16 v[16:31], v[8:11], a[36:39], v[16:31]
v_mfma_f32_32x32x16_bf16 v[16:31], v[8:11], a[40:43], v[16:31]
v_mfma_f32_32x32x16_bf16 v[16:31], v[8:11], a[44:47], v[16:31]
v_mfma_f32_32x32x16_bf16 v[16:31], v[8:11], a[48:51], v[16:31]
v_mfma_f32_32x32x16_bf16 v[16:31], v[8:11], a[52:55], v[16:31]
v_mfma_f32_32x32x16_bf16 v[16:31], v[8:11], a[56:59], v[16:31]
v_mfma_f32_32x32x16_bf16 v[16:31], v[8:11], a[60:63], v[16:31]
v_mfma_f32_32x32x16_bf16 v[16:31], v[8:11], a[64:67], v[16:31]
v_mfma_f32_32x32x16_bf16 v[16:31], v[8:11], a[68:71], v[16:31]
v_mfma_f32_32x32x16_bf16 v[16:31], v[8:11], a[72:75], v[16:31]
v_mfma_f32_32x32x16_bf16 v[16:31], v[8:11], a[76:79], v[16:31]
v_mfma_f32_32x32x16_bf16 v[16:31], v[8:11], a[80:83], v[16:31]
v_mfma_f32_32x32x16_bf16 v[16:31], v[8:11], a[84:87], v[16:31]
v_mfma_f32_32x32x16_bf16 v[16:31], v[8:11], a[88:91], v[16:31]
v_mfma_f32_32x32x16_bf16 v[16:31], v[8:11], a[92:95], v[16:31]
v_mfma_f32_32x32x16_bf16 v[16:31], v[8:11], a[96:99], v[16:31]
v_mfma_f32_32x32x16_bf16 v[16:31], v[8:11], a[100:103], v[16:31]
v_mfma_f32_32x32x16_bf16 v[16:31], v[8:11], a[104:107], v[16:31]
v_mfma_f32_32x32x16_bf16 v[16:31], v[8:11], a[108:111], v[16:31]
v_mfma_f32_32x32x16_bf16 v[16:31], v[8:11], a[112:115], v[16:31]
v_mfma_f32_32x32x16_bf16 v[16:31], v[8:11], a[116:119], v[16:31]
v_mfma_f32_32x32x16_bf16 v[16:31], v[8:11], a[120:123], v[16:31]
v_mfma_f32_32x32x16_bf16 v[16:31], v[8:11], a[124:127], v[16:31]
v_mfma_f32_32x32x16_bf16 v[32:47], v[8:11], a[128:131], 0
v_mfma_f32_32x32x16_bf16 v[32:47], v[8:11], a[132:135], v[32:47]
v_mfma_f32_32x32x16_bf16 v[32:47], v[8:11], a[136:139], v[32:47]
v_mfma_f32_32x32x16_bf16 v[32:47], v[8:11], a[140:143], v[32:47]
v_mfma_f32_32x32x16_bf16 v[32:47], v[8:11], a[144:147], v[32:47]
v_mfma_f32_32x32x16_bf16 v[32:47], v[8:11], a[148:151], v[32:47]
v_mfma_f32_32x32x16_bf16 v[32:47], v[8:11], a[152:155], v[32:47]
v_mfma_f32_32x32x16_bf16 v[32:47], v[8:11], a[156:159], v[32:47]
v_mfma_f32_32x32x16_bf16 v[32:47], v[8:11], a[160:163], v[32:47]
v_mfma_f32_32x32x16_bf16 v[32:47], v[8:11], a[164:167], v[32:47]
v_mfma_f32_32x32x16_bf16 v[32:47], v[8:11], a[168:171], v[32:47]
v_mfma_f32_32x32x16_bf16 v[32:47], v[8:11], a[172:175], v[32:47]
v_mfma_f32_32x32x16_bf16 v[32:47], v[8:11], a[176:179], v[32:47]
v_mfma_f32_32x32x16_bf16 v[32:47], v[8:11], a[180:183], v[32:47]
v_mfma_f32_32x32x16_bf16 v[32:47], v[8:11], a[184:187], v[32:47]
v_mfma_f32_32x32x16_bf16 v[32:47], v[8:11], a[188:191], v[32:47]
v_mfma_f32_32x32x16_bf16 v[32:47], v[8:11], a[192:195], v[32:47]
v_mfma_f32_32x32x16_bf16 v[32:47], v[8:11], a[196:199], v[32:47]
v_mfma_f32_32x32x16_bf16 v[32:47], v[8:11], a[200:203], v[32:47]
v_mfma_f32_32x32x16_bf16 v[32:47], v[8:11], a[204:207], v[32:47]
v_mfma_f32_32x32x16_bf16 v[32:47], v[8:11], a[208:211], v[32:47]
v_mfma_f32_32x32x16_bf16 v[32:47], v[8:11], a[212:215], v[32:47]
v_mfma_f32_32x32x16_bf16 v[32:47], v[8:11], a[216:219], v[32:47]
v_mfma_f32_32x32x16_bf16 v[32:47], v[8:11], a[220:223], v[32:47]
v_mfma_f32_32x32x16_bf16 v[32:47], v[8:11], a[224:227], v[32:47]
v_mfma_f32_32x32x16_bf16 v[32:47], v[8:11], a[228:231], v[32:47]
v_mfma_f32_32x32x16_bf16 v[32:47], v[8:11], a[232:235], v[32:47]
v_mfma_f32_32x32x16_bf16 v[32:47], v[8:11], a[236:239], v[32:47]
v_mfma_f32_32x32x16_bf16 v[32:47], v[8:11], a[240:243], v[32:47]
v_mfma_f32_32x32x16_bf16 v[32:47], v[8:11], a[244:247], v[32:47]
v_mfma_f32_32x32x16_bf16 v[32:47], v[8:11], a[248:251], v[32:47]
v_mfma_f32_32x32x16_bf16 v[32:47], v[8:11], a[252:255], v[32:47]
v_cmp_gt_u32 vcc, 32, v1
v_cvt_pk_bf16_f32 v8, v16, v16
v_lshlrev_b32 v9, 16, v8
v_sub_f32 v10, v16, v9
v_cvt_pk_bf16_f32 v11, v9, v10
v_and_b32 v12, 0xffff0000, v11
v_sub_f32 v10, v10, v12
v_cvt_pk_bf16_f32 v12, v10, 0
v_cndmask_b32 v248, 0, v11, vcc
v_cndmask_b32 v249, 0, v12, vcc
v_mov_b64 v[250:251], 0
s_nop 0
v_cvt_pk_bf16_f32 v8, v32, v32
v_lshlrev_b32 v9, 16, v8
v_sub_f32 v10, v32, v9
v_cvt_pk_bf16_f32 v11, v9, v10
v_and_b32 v12, 0xffff0000, v11
v_sub_f32 v10, v10, v12
v_cvt_pk_bf16_f32 v12, v10, 0
v_cndmask_b32 v252, 0, v11, vcc
v_cndmask_b32 v253, 0, v12, vcc
v_mov_b64 v[254:255], 0
s_cmp_lg_u32 s9, 0
s_cbranch_scc1 L_wg_13
s_cmp_eq_u32 s15, 1
s_cbranch_scc1 L_sbd_15
s_mov_b32 s10, 0
v_mov_b32 v8, 0
L_sb_14:
global_load_dword v9, v8, s[6:7] offset:128 sc1
s_add_u32 s10, s10, 1
s_cmp_gt_u32 s10, 400000
s_cbranch_scc1 L_fail
s_waitcnt vmcnt(0)
v_cmp_ne_u32 vcc, 0x100, v9
s_cbranch_vccnz L_sb_14
s_mov_b32 s15, 1
L_sbd_15:
v_lshlrev_b32 v2, 7, v1
v_add_u32 v2, 1048576, v2
s_mov_b32 s10, 0
L_wt_16:
global_load_dwordx4 v[8:11], v2, s[4:5] offset:0 sc1
s_add_u32 s10, s10, 1
s_cmp_gt_u32 s10, 400000
s_cbranch_scc1 L_fail
s_waitcnt vmcnt(0)
v_min3_u32 v8, v8, v9, v10
v_min_u32 v8, v8, v11
v_cmp_gt_u32 vcc, 1, v8
s_cbranch_vccz L_wd_17
s_sleep 1
s_branch L_wt_16
L_wd_17:
L_wg_13:
s_barrier
v_lshrrev_b32 v2, 3, v1
s_lshl_b32 s16, s45, 5
v_add_u32 v2, s16, v2
v_lshlrev_b32 v2, 15, v2
v_and_b32 v3, 7, v1
v_lshl_add_u32 v2, v3, 4, v2
s_lshl_b32 s16, s40, 7
v_add_u32 v2, s16, v2
s_add_u32 s32, s4, 6291456
s_addc_u32 s33, s5, 0
s_add_u32 s34, s4, 8388608
s_addc_u32 s35, s5, 0
s_lshl_b32 s17, s9, 12
v_mov_b32 v3, v2
s_add_u32 m0, s17, 0
s_nop 0
global_load_lds_dwordx4 v3, s[32:33] sc1
s_add_u32 m0, s17, 1024
v_add_u32 v3, 0x40000, v3
global_load_lds_dwordx4 v3, s[32:33] sc1
s_add_u32 m0, s17, 2048
v_add_u32 v3, 0x40000, v3
global_load_lds_dwordx4 v3, s[32:33] sc1
s_add_u32 m0, s17, 3072
v_add_u32 v3, 0x40000, v3
global_load_lds_dwordx4 v3, s[32:33] sc1
s_lshr_b32 s16, s9, 1
s_lshl_b32 s16, s16, 13
v_lshrrev_b32 v4, 5, v1
v_lshlrev_b32 v4, 2, v4
v_bfe_u32 v5, v1, 2, 2
v_add_u32 v4, v4, v5
v_lshlrev_b32 v4, 7, v4
v_bfe_u32 v5, v1, 4, 1
v_lshl_add_u32 v4, v5, 5, v4
v_and_b32 v5, 3, v1
v_lshl_add_u32 v4, v5, 3, v4
v_add_u32 v4, s16, v4
v_add_u32 v5, s44, v4
v_add_u32 v6, s16, v0
s_lshl_b32 s18, s45, 11
v_add_u32 v7, s18, v6
s_waitcnt vmcnt(0)
s_barrier
ds_read_b64_tr_b16 v[232:233], v5 offset:0
ds_read_b64_tr_b16 v[234:235], v5 offset:1024
ds_read_b64_tr_b16 v[236:237], v5 offset:2048
ds_read_b64_tr_b16 v[238:239], v5 offset:3072
ds_read_b64_tr_b16 v[240:241], v5 offset:4096
ds_read_b64_tr_b16 v[242:243], v5 offset:5120
ds_read_b64_tr_b16 v[244:245], v5 offset:6144
ds_read_b64_tr_b16 v[246:247], v5 offset:7168
s_waitcnt lgkmcnt(4)
ds_read_b64_tr_b16 v[48:49], v4 offset:64
ds_read_b64_tr_b16 v[50:51], v4 offset:1088
ds_read_b64_tr_b16 v[52:53], v4 offset:2112
ds_read_b64_tr_b16 v[54:55], v4 offset:3136
ds_read_b64_tr_b16 v[56:57], v4 offset:4160
ds_read_b64_tr_b16 v[58:59], v4 offset:5184
ds_read_b64_tr_b16 v[60:61], v4 offset:6208
ds_read_b64_tr_b16 v[62:63], v4 offset:7232
s_waitcnt lgkmcnt(8)
v_mfma_f32_32x32x16_bf16 v[16:31], v[232:235], v[128:131], 0
v_mfma_f32_32x32x16_bf16 v[32:47], v[232:235], v[160:163], 0
v_mfma_f32_32x32x16_bf16 v[16:31], v[236:239], v[132:135], v[16:31]
v_mfma_f32_32x32x16_bf16 v[32:47], v[236:239], v[164:167], v[32:47]
v_mfma_f32_32x32x16_bf16 v[16:31], v[240:243], v[136:139], v[16:31]
v_mfma_f32_32x32x16_bf16 v[32:47], v[240:243], v[168:171], v[32:47]
v_mfma_f32_32x32x16_bf16 v[16:31], v[244:247], v[140:143], v[16:31]
v_mfma_f32_32x32x16_bf16 v[32:47], v[244:247], v[172:175], v[32:47]
s_waitcnt lgkmcnt(0)
v_and_b32 v48, s42, v48
v_and_b32 v49, s42, v49
v_and_b32 v50, s42, v50
v_and_b32 v51, s42, v51
v_and_b32 v52, s42, v52
v_and_b32 v53, s42, v53
v_and_b32 v54, s42, v54
v_and_b32 v55, s42, v55
v_and_b32 v56, s42, v56
v_and_b32 v57, s42, v57
v_and_b32 v58, s42, v58
v_and_b32 v59, s42, v59
v_and_b32 v60, s42, v60
v_and_b32 v61, s42, v61
v_and_b32 v62, s42, v62
v_and_b32 v63, s42, v63
v_mfma_f32_32x32x16_bf16 v[16:31], v[48:51], v[144:147], v[16:31]
v_mfma_f32_32x32x16_bf16 v[32:47], v[48:51], v[128:131], v[32:47]
v_mfma_f32_32x32x16_bf16 v[16:31], v[52:55], v[148:151], v[16:31]
v_mfma_f32_32x32x16_bf16 v[32:47], v[52:55], v[132:135], v[32:47]
v_mfma_f32_32x32x16_bf16 v[16:31], v[56:59], v[152:155], v[16:31]
v_mfma_f32_32x32x16_bf16 v[32:47], v[56:59], v[136:139], v[32:47]
v_mfma_f32_32x32x16_bf16 v[16:31], v[60:63], v[156:159], v[16:31]
v_mfma_f32_32x32x16_bf16 v[32:47], v[60:63], v[140:143], v[32:47]
s_nop 11
v_mul_f32 v8, v32, v80
v_mul_f32 v32, v32, v64
v_fma_f32 v32, -v16, v80, v32
v_fma_f32 v16, v16, v64, v8
v_mul_f32 v9, v33, v81
v_mul_f32 v33, v33, v65
v_fma_f32 v33, -v17, v81, v33
v_fma_f32 v17, v17, v65, v9
v_mul_f32 v10, v34, v82
v_mul_f32 v34, v34, v66
v_fma_f32 v34, -v18, v82, v34
v_fma_f32 v18, v18, v66, v10
v_mul_f32 v11, v35, v83
v_mul_f32 v35, v35, v67
v_fma_f32 v35, -v19, v83, v35
v_fma_f32 v19, v19, v67, v11
v_mul_f32 v12, v36, v84
v_mul_f32 v36, v36, v68
v_fma_f32 v36, -v20, v84, v36
v_fma_f32 v20, v20, v68, v12
v_mul_f32 v13, v37, v85
v_mul_f32 v37, v37, v69
v_fma_f32 v37, -v21, v85, v37
v_fma_f32 v21, v21, v69, v13
v_mul_f32 v14, v38, v86
v_mul_f32 v38, v38, v70
v_fma_f32 v38, -v22, v86, v38
v_fma_f32 v22, v22, v70, v14
v_mul_f32 v15, v39, v87
v_mul_f32 v39, v39, v71
v_fma_f32 v39, -v23, v87, v39
v_fma_f32 v23, v23, v71, v15
v_mul_f32 v8, v40, v88
v_mul_f32 v40, v40, v72
v_fma_f32 v40, -v24, v88, v40
v_fma_f32 v24, v24, v72, v8
v_mul_f32 v9, v41, v89
v_mul_f32 v41, v41, v73
v_fma_f32 v41, -v25, v89, v41
v_fma_f32 v25, v25, v73, v9
v_mul_f32 v10, v42, v90
v_mul_f32 v42, v42, v74
v_fma_f32 v42, -v26, v90, v42
v_fma_f32 v26, v26, v74, v10
v_mul_f32 v11, v43, v91
v_mul_f32 v43, v43, v75
v_fma_f32 v43, -v27, v91, v43
v_fma_f32 v27, v27, v75, v11
v_mul_f32 v12, v44, v92
v_mul_f32 v44, v44, v76
v_fma_f32 v44, -v28, v92, v44
v_fma_f32 v28, v28, v76, v12
v_mul_f32 v13, v45, v93
v_mul_f32 v45, v45, v77
v_fma_f32 v45, -v29, v93, v45
v_fma_f32 v29, v29, v77, v13
v_mul_f32 v14, v46, v94
v_mul_f32 v46, v46, v78
v_fma_f32 v46, -v30, v94, v46
v_fma_f32 v30, v30, v78, v14
v_mul_f32 v15, v47, v95
v_mul_f32 v47, v47, v79
v_fma_f32 v47, -v31, v95, v47
v_fma_f32 v31, v31, v79, v15
v_cvt_pk_bf16_f32 v232, v16, v17
v_cvt_pk_bf16_f32 v48, v32, v33
v_cvt_pk_bf16_f32 v233, v18, v19
v_cvt_pk_bf16_f32 v49, v34, v35
v_cvt_pk_bf16_f32 v234, v20, v21
v_cvt_pk_bf16_f32 v50, v36, v37
v_cvt_pk_bf16_f32 v235, v22, v23
v_cvt_pk_bf16_f32 v51, v38, v39
v_cvt_pk_bf16_f32 v236, v24, v25
v_cvt_pk_bf16_f32 v52, v40, v41
v_cvt_pk_bf16_f32 v237, v26, v27
v_cvt_pk_bf16_f32 v53, v42, v43
v_cvt_pk_bf16_f32 v238, v28, v29
v_cvt_pk_bf16_f32 v54, v44, v45
v_cvt_pk_bf16_f32 v239, v30, v31
v_cvt_pk_bf16_f32 v55, v46, v47
v_mfma_f32_32x32x16_bf16 v[16:31], v[176:179], v[232:235], 0
v_mfma_f32_32x32x16_bf16 v[32:47], v[192:195], v[232:235], 0
v_mfma_f32_32x32x16_bf16 v[16:31], v[180:183], v[236:239], v[16:31]
v_mfma_f32_32x32x16_bf16 v[32:47], v[196:199], v[236:239], v[32:47]
v_mfma_f32_32x32x16_bf16 v[16:31], v[184:187], v[48:51], v[16:31]
v_mfma_f32_32x32x16_bf16 v[32:47], v[176:179], v[48:51], v[32:47]
v_mfma_f32_32x32x16_bf16 v[16:31], v[188:191], v[52:55], v[16:31]
v_mfma_f32_32x32x16_bf16 v[32:47], v[180:183], v[52:55], v[32:47]
s_nop 11
v_mul_f32 v8, v32, v216
v_mul_f32 v32, v32, v200
v_fma_f32 v32, v16, v216, v32
v_fma_f32 v16, v16, v200, -v8
v_mul_f32 v9, v33, v217
v_mul_f32 v33, v33, v201
v_fma_f32 v33, v17, v217, v33
v_fma_f32 v17, v17, v201, -v9
v_mul_f32 v10, v34, v218
v_mul_f32 v34, v34, v202
v_fma_f32 v34, v18, v218, v34
v_fma_f32 v18, v18, v202, -v10
v_mul_f32 v11, v35, v219
v_mul_f32 v35, v35, v203
v_fma_f32 v35, v19, v219, v35
v_fma_f32 v19, v19, v203, -v11
v_mul_f32 v12, v36, v220
v_mul_f32 v36, v36, v204
v_fma_f32 v36, v20, v220, v36
v_fma_f32 v20, v20, v204, -v12
v_mul_f32 v13, v37, v221
v_mul_f32 v37, v37, v205
v_fma_f32 v37, v21, v221, v37
v_fma_f32 v21, v21, v205, -v13
v_mul_f32 v14, v38, v222
v_mul_f32 v38, v38, v206
v_fma_f32 v38, v22, v222, v38
v_fma_f32 v22, v22, v206, -v14
v_mul_f32 v15, v39, v223
v_mul_f32 v39, v39, v207
v_fma_f32 v39, v23, v223, v39
v_fma_f32 v23, v23, v207, -v15
v_mul_f32 v8, v40, v224
v_mul_f32 v40, v40, v208
v_fma_f32 v40, v24, v224, v40
v_fma_f32 v24, v24, v208, -v8
v_mul_f32 v9, v41, v225
v_mul_f32 v41, v41, v209
v_fma_f32 v41, v25, v225, v41
v_fma_f32 v25, v25, v209, -v9
v_mul_f32 v10, v42, v226
v_mul_f32 v42, v42, v210
v_fma_f32 v42, v26, v226, v42
v_fma_f32 v26, v26, v210, -v10
v_mul_f32 v11, v43, v227
v_mul_f32 v43, v43, v211
v_fma_f32 v43, v27, v227, v43
v_fma_f32 v27, v27, v211, -v11
v_mul_f32 v12, v44, v228
v_mul_f32 v44, v44, v212
v_fma_f32 v44, v28, v228, v44
v_fma_f32 v28, v28, v212, -v12
v_mul_f32 v13, v45, v229
v_mul_f32 v45, v45, v213
v_fma_f32 v45, v29, v229, v45
v_fma_f32 v29, v29, v213, -v13
v_mul_f32 v14, v46, v230
v_mul_f32 v46, v46, v214
v_fma_f32 v46, v30, v230, v46
v_fma_f32 v30, v30, v214, -v14
v_mul_f32 v15, v47, v231
v_mul_f32 v47, v47, v215
v_fma_f32 v47, v31, v231, v47
v_fma_f32 v31, v31, v215, -v15
v_cvt_pk_bf16_f32 v232, v16, v17
v_cvt_pk_bf16_f32 v48, v32, v33
v_cvt_pk_bf16_f32 v233, v18, v19
v_cvt_pk_bf16_f32 v49, v34, v35
v_cvt_pk_bf16_f32 v234, v20, v21
v_cvt_pk_bf16_f32 v50, v36, v37
v_cvt_pk_bf16_f32 v235, v22, v23
v_cvt_pk_bf16_f32 v51, v38, v39
v_cvt_pk_bf16_f32 v236, v24, v25
v_cvt_pk_bf16_f32 v52, v40, v41
v_cvt_pk_bf16_f32 v237, v26, v27
v_cvt_pk_bf16_f32 v53, v42, v43
v_cvt_pk_bf16_f32 v238, v28, v29
v_cvt_pk_bf16_f32 v54, v44, v45
v_cvt_pk_bf16_f32 v239, v30, v31
v_cvt_pk_bf16_f32 v55, v46, v47
v_mfma_f32_32x32x16_bf16 v[16:31], v[232:235], v[176:179], 0
v_mfma_f32_32x32x16_bf16 v[32:47], v[232:235], v[184:187], 0
v_mfma_f32_32x32x16_bf16 v[16:31], v[236:239], v[180:183], v[16:31]
v_mfma_f32_32x32x16_bf16 v[32:47], v[236:239], v[188:191], v[32:47]
v_mfma_f32_32x32x16_bf16 v[16:31], v[48:51], v[192:195], v[16:31]
v_mfma_f32_32x32x16_bf16 v[32:47], v[48:51], v[176:179], v[32:47]
v_mfma_f32_32x32x16_bf16 v[16:31], v[52:55], v[196:199], v[16:31]
v_mfma_f32_32x32x16_bf16 v[32:47], v[52:55], v[180:183], v[32:47]
s_nop 11
v_mul_f32 v8, v32, v112
v_mul_f32 v32, v32, v96
v_fma_f32 v32, v16, v112, v32
v_fma_f32 v16, v16, v96, -v8
v_mul_f32 v9, v33, v113
v_mul_f32 v33, v33, v97
v_fma_f32 v33, v17, v113, v33
v_fma_f32 v17, v17, v97, -v9
v_mul_f32 v10, v34, v114
v_mul_f32 v34, v34, v98
v_fma_f32 v34, v18, v114, v34
v_fma_f32 v18, v18, v98, -v10
v_mul_f32 v11, v35, v115
v_mul_f32 v35, v35, v99
v_fma_f32 v35, v19, v115, v35
v_fma_f32 v19, v19, v99, -v11
v_mul_f32 v12, v36, v116
v_mul_f32 v36, v36, v100
v_fma_f32 v36, v20, v116, v36
v_fma_f32 v20, v20, v100, -v12
v_mul_f32 v13, v37, v117
v_mul_f32 v37, v37, v101
v_fma_f32 v37, v21, v117, v37
v_fma_f32 v21, v21, v101, -v13
v_mul_f32 v14, v38, v118
v_mul_f32 v38, v38, v102
v_fma_f32 v38, v22, v118, v38
v_fma_f32 v22, v22, v102, -v14
v_mul_f32 v15, v39, v119
v_mul_f32 v39, v39, v103
v_fma_f32 v39, v23, v119, v39
v_fma_f32 v23, v23, v103, -v15
v_mul_f32 v8, v40, v120
v_mul_f32 v40, v40, v104
v_fma_f32 v40, v24, v120, v40
v_fma_f32 v24, v24, v104, -v8
v_mul_f32 v9, v41, v121
v_mul_f32 v41, v41, v105
v_fma_f32 v41, v25, v121, v41
v_fma_f32 v25, v25, v105, -v9
v_mul_f32 v10, v42, v122
v_mul_f32 v42, v42, v106
v_fma_f32 v42, v26, v122, v42
v_fma_f32 v26, v26, v106, -v10
v_mul_f32 v11, v43, v123
v_mul_f32 v43, v43, v107
v_fma_f32 v43, v27, v123, v43
v_fma_f32 v27, v27, v107, -v11
v_mul_f32 v12, v44, v124
v_mul_f32 v44, v44, v108
v_fma_f32 v44, v28, v124, v44
v_fma_f32 v28, v28, v108, -v12
v_mul_f32 v13, v45, v125
v_mul_f32 v45, v45, v109
v_fma_f32 v45, v29, v125, v45
v_fma_f32 v29, v29, v109, -v13
v_mul_f32 v14, v46, v126
v_mul_f32 v46, v46, v110
v_fma_f32 v46, v30, v126, v46
v_fma_f32 v30, v30, v110, -v14
v_mul_f32 v15, v47, v127
v_mul_f32 v47, v47, v111
v_fma_f32 v47, v31, v127, v47
v_fma_f32 v31, v31, v111, -v15
v_cvt_pk_bf16_f32 v232, v16, v17
v_cvt_pk_bf16_f32 v48, v32, v33
v_cvt_pk_bf16_f32 v233, v18, v19
v_cvt_pk_bf16_f32 v49, v34, v35
v_cvt_pk_bf16_f32 v234, v20, v21
v_cvt_pk_bf16_f32 v50, v36, v37
v_cvt_pk_bf16_f32 v235, v22, v23
v_cvt_pk_bf16_f32 v51, v38, v39
v_cvt_pk_bf16_f32 v236, v24, v25
v_cvt_pk_bf16_f32 v52, v40, v41
v_cvt_pk_bf16_f32 v237, v26, v27
v_cvt_pk_bf16_f32 v53, v42, v43
v_cvt_pk_bf16_f32 v238, v28, v29
v_cvt_pk_bf16_f32 v54, v44, v45
v_cvt_pk_bf16_f32 v239, v30, v31
v_cvt_pk_bf16_f32 v55, v46, v47
ds_write_b128 v7, v[232:235] offset:16384
ds_write_b128 v7, v[48:51] offset:20480
ds_write_b128 v7, v[236:239] offset:17408
ds_write_b128 v7, v[52:55] offset:21504
s_waitcnt lgkmcnt(0)
s_barrier
ds_read_b128 v[232:235], v6 offset:16384
ds_read_b128 v[236:239], v6 offset:17408
ds_read_b128 v[240:243], v6 offset:18432
ds_read_b128 v[244:247], v6 offset:19456
ds_read_b128 v[48:51], v6 offset:20480
ds_read_b128 v[52:55], v6 offset:21504
ds_read_b128 v[56:59], v6 offset:22528
ds_read_b128 v[60:63], v6 offset:23552
v_and_b32 v4, 31, v1
v_lshlrev_b32 v4, 7, v4
v_lshrrev_b32 v5, 5, v1
v_lshl_add_u32 v4, v5, 3, v4
v_add_u32 v4, s17, v4
v_add_u32 v5, s17, v0
s_waitcnt lgkmcnt(4)
v_mfma_f32_32x32x16_bf16 v[16:31], v[232:235], v[128:131], 0
v_mfma_f32_32x32x16_bf16 v[32:47], v[232:235], v[144:147], 0
v_mfma_f32_32x32x16_bf16 v[16:31], v[236:239], v[132:135], v[16:31]
v_mfma_f32_32x32x16_bf16 v[32:47], v[236:239], v[148:151], v[32:47]
v_mfma_f32_32x32x16_bf16 v[16:31], v[240:243], v[136:139], v[16:31]
v_mfma_f32_32x32x16_bf16 v[32:47], v[240:243], v[152:155], v[32:47]
v_mfma_f32_32x32x16_bf16 v[16:31], v[244:247], v[140:143], v[16:31]
v_mfma_f32_32x32x16_bf16 v[32:47], v[244:247], v[156:159], v[32:47]
s_waitcnt lgkmcnt(0)
v_mfma_f32_32x32x16_bf16 v[16:31], v[48:51], v[160:163], v[16:31]
v_mfma_f32_32x32x16_bf16 v[32:47], v[48:51], v[128:131], v[32:47]
v_mfma_f32_32x32x16_bf16 v[16:31], v[52:55], v[164:167], v[16:31]
v_mfma_f32_32x32x16_bf16 v[32:47], v[52:55], v[132:135], v[32:47]
v_mfma_f32_32x32x16_bf16 v[16:31], v[56:59], v[168:171], v[16:31]
v_mfma_f32_32x32x16_bf16 v[32:47], v[56:59], v[136:139], v[32:47]
v_mfma_f32_32x32x16_bf16 v[16:31], v[60:63], v[172:175], v[16:31]
v_mfma_f32_32x32x16_bf16 v[32:47], v[60:63], v[140:143], v[32:47]
s_nop 3
v_cvt_pk_bf16_f32 v64, v16, v17
v_cvt_pk_bf16_f32 v65, v18, v19
v_cvt_pk_bf16_f32 v66, v20, v21
v_cvt_pk_bf16_f32 v67, v22, v23
v_cvt_pk_bf16_f32 v68, v24, v25
v_cvt_pk_bf16_f32 v69, v26, v27
v_cvt_pk_bf16_f32 v70, v28, v29
v_cvt_pk_bf16_f32 v71, v30, v31
v_cvt_pk_bf16_f32 v72, v32, v33
v_cvt_pk_bf16_f32 v73, v34, v35
v_cvt_pk_bf16_f32 v74, v36, v37
v_cvt_pk_bf16_f32 v75, v38, v39
v_cvt_pk_bf16_f32 v76, v40, v41
v_cvt_pk_bf16_f32 v77, v42, v43
v_cvt_pk_bf16_f32 v78, v44, v45
v_cvt_pk_bf16_f32 v79, v46, v47
ds_write_b64 v4, v[64:65] offset:0
ds_write_b64 v4, v[72:73] offset:64
ds_write_b64 v4, v[66:67] offset:16
ds_write_b64 v4, v[74:75] offset:80
ds_write_b64 v4, v[68:69] offset:32
ds_write_b64 v4, v[76:77] offset:96
ds_write_b64 v4, v[70:71] offset:48
ds_write_b64 v4, v[78:79] offset:112
s_or_b32 s20, s42, 0x0f0f0f0f
s_mov_b32 s21, s20
v_add_u32 v2, s44, v2
s_waitcnt lgkmcnt(0)
ds_read_b128 v[16:19], v5 offset:0
ds_read_b128 v[20:23], v5 offset:1024
ds_read_b128 v[24:27], v5 offset:2048
ds_read_b128 v[28:31], v5 offset:3072
s_mov_b64 exec, s[20:21]
s_waitcnt lgkmcnt(3)
global_store_dwordx4 v2, v[16:19], s[34:35] sc1
v_add_u32 v2, 0x40000, v2
s_waitcnt lgkmcnt(2)
global_store_dwordx4 v2, v[20:23], s[34:35] sc1
v_add_u32 v2, 0x40000, v2
s_waitcnt lgkmcnt(1)
global_store_dwordx4 v2, v[24:27], s[34:35] sc1
v_add_u32 v2, 0x40000, v2
s_waitcnt lgkmcnt(0)
global_store_dwordx4 v2, v[28:31], s[34:35] sc1
s_mov_b64 exec, -1
s_waitcnt vmcnt(0)
s_barrier
s_cmp_lg_u32 s9, 0
s_cbranch_scc1 L_t2f_18
s_and_b32 s17, s8, 3
s_lshl_b32 s17, s17, 2
s_lshr_b32 s16, s8, 2
s_lshl_b32 s16, s16, 7
s_add_u32 s16, s16, s17
s_add_u32 s16, s16, 1056768
v_lshl_add_u32 v2, v1, 2, s16
v_mov_b32 v3, 1
s_cmp_eq_u32 s8, 128
s_cselect_b64 exec, 15, 1
global_store_dword v2, v3, s[4:5] sc1
s_mov_b64 exec, -1
L_t2f_18:
s_branch L_t4
L_row:
s_lshl_b32 s16, s60, 7
s_lshl_b32 s17, s9, 5
s_add_u32 s16, s16, s17
v_and_b32 v4, 0x13, v1
v_bfe_u32 v5, v1, 2, 1
v_lshl_add_u32 v4, v5, 3, v4
v_bfe_u32 v5, v1, 3, 1
v_lshl_add_u32 v4, v5, 2, v4
v_add_u32 v4, s16, v4
v_cvt_f32_u32 v2, v4
v_mul_f32 v2, 0x3b000000, v2
v_lshrrev_b32 v3, 5, v1
v_lshlrev_b32 v3, 2, v3
v_cvt_f32_u32 v3, v3
v_mul_f32 v3, v3, v2
v_fract_f32 v3, v3
v_lshlrev_b32 v4, 31, v4
v_or_b32 v4, 0x3f803f80, v4
v_cos_f32 v8, v3
v_sin_f32 v9, -v3
v_fmamk_f32 v11, v2, 0x3f800000, v3
v_cos_f32 v10, v11
v_sin_f32 v11, -v11
v_fmamk_f32 v13, v2, 0x40000000, v3
v_cos_f32 v12, v13
v_sin_f32 v13, -v13
v_fmamk_f32 v15, v2, 0x40400000, v3
v_cos_f32 v14, v15
v_sin_f32 v15, -v15
v_fmamk_f32 v3, v2, 0x41000000, v3
v_fract_f32 v3, v3
v_cvt_pk_bf16_f32 v128, v8, v9
v_cvt_pk_bf16_f32 v129, v10, v11
v_cvt_pk_bf16_f32 v130, v12, v13
v_cvt_pk_bf16_f32 v131, v14, v15
v_cos_f32 v8, v3
v_sin_f32 v9, -v3
v_fmamk_f32 v11, v2, 0x3f800000, v3
v_cos_f32 v10, v11
v_sin_f32 v11, -v11
v_fmamk_f32 v13, v2, 0x40000000, v3
v_cos_f32 v12, v13
v_sin_f32 v13, -v13
v_fmamk_f32 v15, v2, 0x40400000, v3
v_cos_f32 v14, v15
v_sin_f32 v15, -v15
v_fmamk_f32 v3, v2, 0x41000000, v3
v_fract_f32 v3, v3
v_cvt_pk_bf16_f32 v132, v8, v9
v_cvt_pk_bf16_f32 v133, v10, v11
v_cvt_pk_bf16_f32 v134, v12, v13
v_cvt_pk_bf16_f32 v135, v14, v15
v_cos_f32 v8, v3
v_sin_f32 v9, -v3
v_fmamk_f32 v11, v2, 0x3f800000, v3
v_cos_f32 v10, v11
v_sin_f32 v11, -v11
v_fmamk_f32 v13, v2, 0x40000000, v3
v_cos_f32 v12, v13
v_sin_f32 v13, -v13
v_fmamk_f32 v15, v2, 0x40400000, v3
v_cos_f32 v14, v15
v_sin_f32 v15, -v15
v_fmamk_f32 v3, v2, 0x41000000, v3
v_fract_f32 v3, v3
v_cvt_pk_bf16_f32 v136, v8, v9
v_cvt_pk_bf16_f32 v137, v10, v11
v_cvt_pk_bf16_f32 v138, v12, v13
v_cvt_pk_bf16_f32 v139, v14, v15
v_cos_f32 v8, v3
v_sin_f32 v9, -v3
v_fmamk_f32 v11, v2, 0x3f800000, v3
v_cos_f32 v10, v11
v_sin_f32 v11, -v11
v_fmamk_f32 v13, v2, 0x40000000, v3
v_cos_f32 v12, v13
v_sin_f32 v13, -v13
v_fmamk_f32 v15, v2, 0x40400000, v3
v_cos_f32 v14, v15
v_sin_f32 v15, -v15
v_fmamk_f32 v3, v2, 0x41000000, v3
v_fract_f32 v3, v3
v_cvt_pk_bf16_f32 v140, v8, v9
v_cvt_pk_bf16_f32 v141, v10, v11
v_cvt_pk_bf16_f32 v142, v12, v13
v_cvt_pk_bf16_f32 v143, v14, v15
v_cos_f32 v8, v3
v_sin_f32 v9, -v3
v_fmamk_f32 v11, v2, 0x3f800000, v3
v_cos_f32 v10, v11
v_sin_f32 v11, -v11
v_fmamk_f32 v13, v2, 0x40000000, v3
v_cos_f32 v12, v13
v_sin_f32 v13, -v13
v_fmamk_f32 v15, v2, 0x40400000, v3
v_cos_f32 v14, v15
v_sin_f32 v15, -v15
v_fmamk_f32 v3, v2, 0x41000000, v3
v_fract_f32 v3, v3
v_cvt_pk_bf16_f32 v144, v8, v9
v_cvt_pk_bf16_f32 v145, v10, v11
v_cvt_pk_bf16_f32 v146, v12, v13
v_cvt_pk_bf16_f32 v147, v14, v15
v_cos_f32 v8, v3
v_sin_f32 v9, -v3
v_fmamk_f32 v11, v2, 0x3f800000, v3
v_cos_f32 v10, v11
v_sin_f32 v11, -v11
v_fmamk_f32 v13, v2, 0x40000000, v3
v_cos_f32 v12, v13
v_sin_f32 v13, -v13
v_fmamk_f32 v15, v2, 0x40400000, v3
v_cos_f32 v14, v15
v_sin_f32 v15, -v15
v_fmamk_f32 v3, v2, 0x41000000, v3
v_fract_f32 v3, v3
v_cvt_pk_bf16_f32 v148, v8, v9
v_cvt_pk_bf16_f32 v149, v10, v11
v_cvt_pk_bf16_f32 v150, v12, v13
v_cvt_pk_bf16_f32 v151, v14, v15
v_cos_f32 v8, v3
v_sin_f32 v9, -v3
v_fmamk_f32 v11, v2, 0x3f800000, v3
v_cos_f32 v10, v11
v_sin_f32 v11, -v11
v_fmamk_f32 v13, v2, 0x40000000, v3
v_cos_f32 v12, v13
v_sin_f32 v13, -v13
v_fmamk_f32 v15, v2, 0x40400000, v3
v_cos_f32 v14, v15
v_sin_f32 v15, -v15
v_fmamk_f32 v3, v2, 0x41000000, v3
v_fract_f32 v3, v3
v_cvt_pk_bf16_f32 v152, v8, v9
v_cvt_pk_bf16_f32 v153, v10, v11
v_cvt_pk_bf16_f32 v154, v12, v13
v_cvt_pk_bf16_f32 v155, v14, v15
v_cos_f32 v8, v3
v_sin_f32 v9, -v3
v_fmamk_f32 v11, v2, 0x3f800000, v3
v_cos_f32 v10, v11
v_sin_f32 v11, -v11
v_fmamk_f32 v13, v2, 0x40000000, v3
v_cos_f32 v12, v13
v_sin_f32 v13, -v13
v_fmamk_f32 v15, v2, 0x40400000, v3
v_cos_f32 v14, v15
v_sin_f32 v15, -v15
v_fmamk_f32 v3, v2, 0x41000000, v3
v_fract_f32 v3, v3
v_cvt_pk_bf16_f32 v156, v8, v9
v_cvt_pk_bf16_f32 v157, v10, v11
v_cvt_pk_bf16_f32 v158, v12, v13
v_cvt_pk_bf16_f32 v159, v14, v15
v_cos_f32 v8, v3
v_sin_f32 v9, -v3
v_fmamk_f32 v11, v2, 0x3f800000, v3
v_cos_f32 v10, v11
v_sin_f32 v11, -v11
v_fmamk_f32 v13, v2, 0x40000000, v3
v_cos_f32 v12, v13
v_sin_f32 v13, -v13
v_fmamk_f32 v15, v2, 0x40400000, v3
v_cos_f32 v14, v15
v_sin_f32 v15, -v15
v_fmamk_f32 v3, v2, 0x41000000, v3
v_fract_f32 v3, v3
v_cvt_pk_bf16_f32 v160, v8, v9
v_cvt_pk_bf16_f32 v161, v10, v11
v_cvt_pk_bf16_f32 v162, v12, v13
v_cvt_pk_bf16_f32 v163, v14, v15
v_cos_f32 v8, v3
v_sin_f32 v9, -v3
v_fmamk_f32 v11, v2, 0x3f800000, v3
v_cos_f32 v10, v11
v_sin_f32 v11, -v11
v_fmamk_f32 v13, v2, 0x40000000, v3
v_cos_f32 v12, v13
v_sin_f32 v13, -v13
v_fmamk_f32 v15, v2, 0x40400000, v3
v_cos_f32 v14, v15
v_sin_f32 v15, -v15
v_fmamk_f32 v3, v2, 0x41000000, v3
v_fract_f32 v3, v3
v_cvt_pk_bf16_f32 v164, v8, v9
v_cvt_pk_bf16_f32 v165, v10, v11
v_cvt_pk_bf16_f32 v166, v12, v13
v_cvt_pk_bf16_f32 v167, v14, v15
v_cos_f32 v8, v3
v_sin_f32 v9, -v3
v_fmamk_f32 v11, v2, 0x3f800000, v3
v_cos_f32 v10, v11
v_sin_f32 v11, -v11
v_fmamk_f32 v13, v2, 0x40000000, v3
v_cos_f32 v12, v13
v_sin_f32 v13, -v13
v_fmamk_f32 v15, v2, 0x40400000, v3
v_cos_f32 v14, v15
v_sin_f32 v15, -v15
v_fmamk_f32 v3, v2, 0x41000000, v3
v_fract_f32 v3, v3
v_cvt_pk_bf16_f32 v168, v8, v9
v_cvt_pk_bf16_f32 v169, v10, v11
v_cvt_pk_bf16_f32 v170, v12, v13
v_cvt_pk_bf16_f32 v171, v14, v15
v_cos_f32 v8, v3
v_sin_f32 v9, -v3
v_fmamk_f32 v11, v2, 0x3f800000, v3
v_cos_f32 v10, v11
v_sin_f32 v11, -v11
v_fmamk_f32 v13, v2, 0x40000000, v3
v_cos_f32 v12, v13
v_sin_f32 v13, -v13
v_fmamk_f32 v15, v2, 0x40400000, v3
v_cos_f32 v14, v15
v_sin_f32 v15, -v15
v_fmamk_f32 v3, v2, 0x41000000, v3
v_fract_f32 v3, v3
v_cvt_pk_bf16_f32 v172, v8, v9
v_cvt_pk_bf16_f32 v173, v10, v11
v_cvt_pk_bf16_f32 v174, v12, v13
v_cvt_pk_bf16_f32 v175, v14, v15
v_cos_f32 v8, v3
v_sin_f32 v9, -v3
v_fmamk_f32 v11, v2, 0x3f800000, v3
v_cos_f32 v10, v11
v_sin_f32 v11, -v11
v_fmamk_f32 v13, v2, 0x40000000, v3
v_cos_f32 v12, v13
v_sin_f32 v13, -v13
v_fmamk_f32 v15, v2, 0x40400000, v3
v_cos_f32 v14, v15
v_sin_f32 v15, -v15
v_fmamk_f32 v3, v2, 0x41000000, v3
v_fract_f32 v3, v3
v_cvt_pk_bf16_f32 v176, v8, v9
v_cvt_pk_bf16_f32 v177, v10, v11
v_cvt_pk_bf16_f32 v178, v12, v13
v_cvt_pk_bf16_f32 v179, v14, v15
v_cos_f32 v8, v3
v_sin_f32 v9, -v3
v_fmamk_f32 v11, v2, 0x3f800000, v3
v_cos_f32 v10, v11
v_sin_f32 v11, -v11
v_fmamk_f32 v13, v2, 0x40000000, v3
v_cos_f32 v12, v13
v_sin_f32 v13, -v13
v_fmamk_f32 v15, v2, 0x40400000, v3
v_cos_f32 v14, v15
v_sin_f32 v15, -v15
v_fmamk_f32 v3, v2, 0x41000000, v3
v_fract_f32 v3, v3
v_cvt_pk_bf16_f32 v180, v8, v9
v_cvt_pk_bf16_f32 v181, v10, v11
v_cvt_pk_bf16_f32 v182, v12, v13
v_cvt_pk_bf16_f32 v183, v14, v15
v_cos_f32 v8, v3
v_sin_f32 v9, -v3
v_fmamk_f32 v11, v2, 0x3f800000, v3
v_cos_f32 v10, v11
v_sin_f32 v11, -v11
v_fmamk_f32 v13, v2, 0x40000000, v3
v_cos_f32 v12, v13
v_sin_f32 v13, -v13
v_fmamk_f32 v15, v2, 0x40400000, v3
v_cos_f32 v14, v15
v_sin_f32 v15, -v15
v_fmamk_f32 v3, v2, 0x41000000, v3
v_fract_f32 v3, v3
v_cvt_pk_bf16_f32 v184, v8, v9
v_cvt_pk_bf16_f32 v185, v10, v11
v_cvt_pk_bf16_f32 v186, v12, v13
v_cvt_pk_bf16_f32 v187, v14, v15
v_cos_f32 v8, v3
v_sin_f32 v9, -v3
v_fmamk_f32 v11, v2, 0x3f800000, v3
v_cos_f32 v10, v11
v_sin_f32 v11, -v11
v_fmamk_f32 v13, v2, 0x40000000, v3
v_cos_f32 v12, v13
v_sin_f32 v13, -v13
v_fmamk_f32 v15, v2, 0x40400000, v3
v_cos_f32 v14, v15
v_sin_f32 v15, -v15
v_fmamk_f32 v3, v2, 0x41000000, v3
v_fract_f32 v3, v3
v_cvt_pk_bf16_f32 v188, v8, v9
v_cvt_pk_bf16_f32 v189, v10, v11
v_cvt_pk_bf16_f32 v190, v12, v13
v_cvt_pk_bf16_f32 v191, v14, v15
v_cos_f32 v8, v3
v_sin_f32 v9, -v3
v_fmamk_f32 v11, v2, 0x3f800000, v3
v_cos_f32 v10, v11
v_sin_f32 v11, -v11
v_fmamk_f32 v13, v2, 0x40000000, v3
v_cos_f32 v12, v13
v_sin_f32 v13, -v13
v_fmamk_f32 v15, v2, 0x40400000, v3
v_cos_f32 v14, v15
v_sin_f32 v15, -v15
v_fmamk_f32 v3, v2, 0x41000000, v3
v_fract_f32 v3, v3
v_cvt_pk_bf16_f32 v192, v8, v9
v_cvt_pk_bf16_f32 v193, v10, v11
v_cvt_pk_bf16_f32 v194, v12, v13
v_cvt_pk_bf16_f32 v195, v14, v15
v_cos_f32 v8, v3
v_sin_f32 v9, -v3
v_fmamk_f32 v11, v2, 0x3f800000, v3
v_cos_f32 v10, v11
v_sin_f32 v11, -v11
v_fmamk_f32 v13, v2, 0x40000000, v3
v_cos_f32 v12, v13
v_sin_f32 v13, -v13
v_fmamk_f32 v15, v2, 0x40400000, v3
v_cos_f32 v14, v15
v_sin_f32 v15, -v15
v_fmamk_f32 v3, v2, 0x41000000, v3
v_fract_f32 v3, v3
v_cvt_pk_bf16_f32 v196, v8, v9
v_cvt_pk_bf16_f32 v197, v10, v11
v_cvt_pk_bf16_f32 v198, v12, v13
v_cvt_pk_bf16_f32 v199, v14, v15
v_cos_f32 v8, v3
v_sin_f32 v9, -v3
v_fmamk_f32 v11, v2, 0x3f800000, v3
v_cos_f32 v10, v11
v_sin_f32 v11, -v11
v_fmamk_f32 v13, v2, 0x40000000, v3
v_cos_f32 v12, v13
v_sin_f32 v13, -v13
v_fmamk_f32 v15, v2, 0x40400000, v3
v_cos_f32 v14, v15
v_sin_f32 v15, -v15
v_fmamk_f32 v3, v2, 0x41000000, v3
v_fract_f32 v3, v3
v_cvt_pk_bf16_f32 v200, v8, v9
v_cvt_pk_bf16_f32 v201, v10, v11
v_cvt_pk_bf16_f32 v202, v12, v13
v_cvt_pk_bf16_f32 v203, v14, v15
v_cos_f32 v8, v3
v_sin_f32 v9, -v3
v_fmamk_f32 v11, v2, 0x3f800000, v3
v_cos_f32 v10, v11
v_sin_f32 v11, -v11
v_fmamk_f32 v13, v2, 0x40000000, v3
v_cos_f32 v12, v13
v_sin_f32 v13, -v13
v_fmamk_f32 v15, v2, 0x40400000, v3
v_cos_f32 v14, v15
v_sin_f32 v15, -v15
v_fmamk_f32 v3, v2, 0x41000000, v3
v_fract_f32 v3, v3
v_cvt_pk_bf16_f32 v204, v8, v9
v_cvt_pk_bf16_f32 v205, v10, v11
v_cvt_pk_bf16_f32 v206, v12, v13
v_cvt_pk_bf16_f32 v207, v14, v15
v_cos_f32 v8, v3
v_sin_f32 v9, -v3
v_fmamk_f32 v11, v2, 0x3f800000, v3
v_cos_f32 v10, v11
v_sin_f32 v11, -v11
v_fmamk_f32 v13, v2, 0x40000000, v3
v_cos_f32 v12, v13
v_sin_f32 v13, -v13
v_fmamk_f32 v15, v2, 0x40400000, v3
v_cos_f32 v14, v15
v_sin_f32 v15, -v15
v_fmamk_f32 v3, v2, 0x41000000, v3
v_fract_f32 v3, v3
v_cvt_pk_bf16_f32 v208, v8, v9
v_cvt_pk_bf16_f32 v209, v10, v11
v_cvt_pk_bf16_f32 v210, v12, v13
v_cvt_pk_bf16_f32 v211, v14, v15
v_cos_f32 v8, v3
v_sin_f32 v9, -v3
v_fmamk_f32 v11, v2, 0x3f800000, v3
v_cos_f32 v10, v11
v_sin_f32 v11, -v11
v_fmamk_f32 v13, v2, 0x40000000, v3
v_cos_f32 v12, v13
v_sin_f32 v13, -v13
v_fmamk_f32 v15, v2, 0x40400000, v3
v_cos_f32 v14, v15
v_sin_f32 v15, -v15
v_fmamk_f32 v3, v2, 0x41000000, v3
v_fract_f32 v3, v3
v_cvt_pk_bf16_f32 v212, v8, v9
v_cvt_pk_bf16_f32 v213, v10, v11
v_cvt_pk_bf16_f32 v214, v12, v13
v_cvt_pk_bf16_f32 v215, v14, v15
v_cos_f32 v8, v3
v_sin_f32 v9, -v3
v_fmamk_f32 v11, v2, 0x3f800000, v3
v_cos_f32 v10, v11
v_sin_f32 v11, -v11
v_fmamk_f32 v13, v2, 0x40000000, v3
v_cos_f32 v12, v13
v_sin_f32 v13, -v13
v_fmamk_f32 v15, v2, 0x40400000, v3
v_cos_f32 v14, v15
v_sin_f32 v15, -v15
v_fmamk_f32 v3, v2, 0x41000000, v3
v_fract_f32 v3, v3
v_cvt_pk_bf16_f32 v216, v8, v9
v_cvt_pk_bf16_f32 v217, v10, v11
v_cvt_pk_bf16_f32 v218, v12, v13
v_cvt_pk_bf16_f32 v219, v14, v15
v_cos_f32 v8, v3
v_sin_f32 v9, -v3
v_fmamk_f32 v11, v2, 0x3f800000, v3
v_cos_f32 v10, v11
v_sin_f32 v11, -v11
v_fmamk_f32 v13, v2, 0x40000000, v3
v_cos_f32 v12, v13
v_sin_f32 v13, -v13
v_fmamk_f32 v15, v2, 0x40400000, v3
v_cos_f32 v14, v15
v_sin_f32 v15, -v15
v_fmamk_f32 v3, v2, 0x41000000, v3
v_fract_f32 v3, v3
v_cvt_pk_bf16_f32 v220, v8, v9
v_cvt_pk_bf16_f32 v221, v10, v11
v_cvt_pk_bf16_f32 v222, v12, v13
v_cvt_pk_bf16_f32 v223, v14, v15
v_cos_f32 v8, v3
v_sin_f32 v9, -v3
v_fmamk_f32 v11, v2, 0x3f800000, v3
v_cos_f32 v10, v11
v_sin_f32 v11, -v11
v_fmamk_f32 v13, v2, 0x40000000, v3
v_cos_f32 v12, v13
v_sin_f32 v13, -v13
v_fmamk_f32 v15, v2, 0x40400000, v3
v_cos_f32 v14, v15
v_sin_f32 v15, -v15
v_fmamk_f32 v3, v2, 0x41000000, v3
v_fract_f32 v3, v3
v_cvt_pk_bf16_f32 v224, v8, v9
v_cvt_pk_bf16_f32 v225, v10, v11
v_cvt_pk_bf16_f32 v226, v12, v13
v_cvt_pk_bf16_f32 v227, v14, v15
v_cos_f32 v8, v3
v_sin_f32 v9, -v3
v_fmamk_f32 v11, v2, 0x3f800000, v3
v_cos_f32 v10, v11
v_sin_f32 v11, -v11
v_fmamk_f32 v13, v2, 0x40000000, v3
v_cos_f32 v12, v13
v_sin_f32 v13, -v13
v_fmamk_f32 v15, v2, 0x40400000, v3
v_cos_f32 v14, v15
v_sin_f32 v15, -v15
v_fmamk_f32 v3, v2, 0x41000000, v3
v_fract_f32 v3, v3
v_cvt_pk_bf16_f32 v228, v8, v9
v_cvt_pk_bf16_f32 v229, v10, v11
v_cvt_pk_bf16_f32 v230, v12, v13
v_cvt_pk_bf16_f32 v231, v14, v15
v_cos_f32 v8, v3
v_sin_f32 v9, -v3
v_fmamk_f32 v11, v2, 0x3f800000, v3
v_cos_f32 v10, v11
v_sin_f32 v11, -v11
v_fmamk_f32 v13, v2, 0x40000000, v3
v_cos_f32 v12, v13
v_sin_f32 v13, -v13
v_fmamk_f32 v15, v2, 0x40400000, v3
v_cos_f32 v14, v15
v_sin_f32 v15, -v15
v_fmamk_f32 v3, v2, 0x41000000, v3
v_fract_f32 v3, v3
v_cvt_pk_bf16_f32 v232, v8, v9
v_cvt_pk_bf16_f32 v233, v10, v11
v_cvt_pk_bf16_f32 v234, v12, v13
v_cvt_pk_bf16_f32 v235, v14, v15
v_cos_f32 v8, v3
v_sin_f32 v9, -v3
v_fmamk_f32 v11, v2, 0x3f800000, v3
v_cos_f32 v10, v11
v_sin_f32 v11, -v11
v_fmamk_f32 v13, v2, 0x40000000, v3
v_cos_f32 v12, v13
v_sin_f32 v13, -v13
v_fmamk_f32 v15, v2, 0x40400000, v3
v_cos_f32 v14, v15
v_sin_f32 v15, -v15
v_fmamk_f32 v3, v2, 0x41000000, v3
v_fract_f32 v3, v3
v_cvt_pk_bf16_f32 v236, v8, v9
v_cvt_pk_bf16_f32 v237, v10, v11
v_cvt_pk_bf16_f32 v238, v12, v13
v_cvt_pk_bf16_f32 v239, v14, v15
v_cos_f32 v8, v3
v_sin_f32 v9, -v3
v_fmamk_f32 v11, v2, 0x3f800000, v3
v_cos_f32 v10, v11
v_sin_f32 v11, -v11
v_fmamk_f32 v13, v2, 0x40000000, v3
v_cos_f32 v12, v13
v_sin_f32 v13, -v13
v_fmamk_f32 v15, v2, 0x40400000, v3
v_cos_f32 v14, v15
v_sin_f32 v15, -v15
v_fmamk_f32 v3, v2, 0x41000000, v3
v_fract_f32 v3, v3
v_cvt_pk_bf16_f32 v240, v8, v9
v_cvt_pk_bf16_f32 v241, v10, v11
v_cvt_pk_bf16_f32 v242, v12, v13
v_cvt_pk_bf16_f32 v243, v14, v15
v_cos_f32 v8, v3
v_sin_f32 v9, -v3
v_fmamk_f32 v11, v2, 0x3f800000, v3
v_cos_f32 v10, v11
v_sin_f32 v11, -v11
v_fmamk_f32 v13, v2, 0x40000000, v3
v_cos_f32 v12, v13
v_sin_f32 v13, -v13
v_fmamk_f32 v15, v2, 0x40400000, v3
v_cos_f32 v14, v15
v_sin_f32 v15, -v15
v_fmamk_f32 v3, v2, 0x41000000, v3
v_fract_f32 v3, v3
v_cvt_pk_bf16_f32 v244, v8, v9
v_cvt_pk_bf16_f32 v245, v10, v11
v_cvt_pk_bf16_f32 v246, v12, v13
v_cvt_pk_bf16_f32 v247, v14, v15
v_cos_f32 v8, v3
v_sin_f32 v9, -v3
v_fmamk_f32 v11, v2, 0x3f800000, v3
v_cos_f32 v10, v11
v_sin_f32 v11, -v11
v_fmamk_f32 v13, v2, 0x40000000, v3
v_cos_f32 v12, v13
v_sin_f32 v13, -v13
v_fmamk_f32 v15, v2, 0x40400000, v3
v_cos_f32 v14, v15
v_sin_f32 v15, -v15
v_fmamk_f32 v3, v2, 0x41000000, v3
v_fract_f32 v3, v3
v_cvt_pk_bf16_f32 v248, v8, v9
v_cvt_pk_bf16_f32 v249, v10, v11
v_cvt_pk_bf16_f32 v250, v12, v13
v_cvt_pk_bf16_f32 v251, v14, v15
v_cos_f32 v8, v3
v_sin_f32 v9, -v3
v_fmamk_f32 v11, v2, 0x3f800000, v3
v_cos_f32 v10, v11
v_sin_f32 v11, -v11
v_fmamk_f32 v13, v2, 0x40000000, v3
v_cos_f32 v12, v13
v_sin_f32 v13, -v13
v_fmamk_f32 v15, v2, 0x40400000, v3
v_cos_f32 v14, v15
v_sin_f32 v15, -v15
v_cvt_pk_bf16_f32 v252, v8, v9
v_cvt_pk_bf16_f32 v253, v10, v11
v_cvt_pk_bf16_f32 v254, v12, v13
v_cvt_pk_bf16_f32 v255, v14, v15
v_cmp_gt_u32 vcc, 32, v1
s_nop 1
v_cndmask_b32 v128, v128, v4, vcc
s_cmp_lg_u32 s9, 0
s_cbranch_scc1 L_wg_19
s_cmp_eq_u32 s15, 1
s_cbranch_scc1 L_sbd_21
s_mov_b32 s10, 0
v_mov_b32 v8, 0
L_sb_20:
global_load_dword v9, v8, s[6:7] offset:128 sc1
s_add_u32 s10, s10, 1
s_cmp_gt_u32 s10, 400000
s_cbranch_scc1 L_fail
s_waitcnt vmcnt(0)
v_cmp_ne_u32 vcc, 0x100, v9
s_cbranch_vccnz L_sb_20
s_mov_b32 s15, 1
L_sbd_21:
s_mov_b32 s22, -1
s_mov_b32 s23, 1
v_lshlrev_b32 v2, 7, v1
v_add_u32 v2, 1056768, v2
s_mov_b32 s10, 0
s_mov_b64 exec, s[22:23]
L_wt_22:
global_load_dwordx4 v[8:11], v2, s[4:5] offset:0 sc1
s_add_u32 s10, s10, 1
s_cmp_gt_u32 s10, 400000
s_cbranch_scc1 L_fail
s_waitcnt vmcnt(0)
v_min3_u32 v8, v8, v9, v10
v_min_u32 v8, v8, v11
v_cmp_gt_u32 vcc, 1, v8
s_cbranch_vccz L_wd_23
s_sleep 1
s_branch L_wt_22
L_wd_23:
s_mov_b64 exec, -1
L_wg_19:
s_barrier
s_mov_b32 s14, s61
L_t3l:
s_lshl_b32 s18, s14, 15
s_add_u32 s18, s18, 8388608
s_add_u32 s34, s4, s18
s_addc_u32 s35, s5, 0
s_lshl_b32 s16, s9, 13
v_add_u32 v2, s16, v0
s_lshl_b32 s16, s9, 13
s_add_u32 m0, s16, 0
s_nop 0
global_load_lds_dwordx4 v2, s[34:35] sc1
s_add_u32 m0, s16, 1024
v_add_u32 v2, 0x400, v2
global_load_lds_dwordx4 v2, s[34:35] sc1
s_add_u32 m0, s16, 2048
v_add_u32 v2, 0x400, v2
global_load_lds_dwordx4 v2, s[34:35] sc1
s_add_u32 m0, s16, 3072
v_add_u32 v2, 0x400, v2
global_load_lds_dwordx4 v2, s[34:35] sc1
s_add_u32 m0, s16, 4096
v_add_u32 v2, 0x400, v2
global_load_lds_dwordx4 v2, s[34:35] sc1
s_add_u32 m0, s16, 5120
v_add_u32 v2, 0x400, v2
global_load_lds_dwordx4 v2, s[34:35] sc1
s_add_u32 m0, s16, 6144
v_add_u32 v2, 0x400, v2
global_load_lds_dwordx4 v2, s[34:35] sc1
s_add_u32 m0, s16, 7168
v_add_u32 v2, 0x400, v2
global_load_lds_dwordx4 v2, s[34:35] sc1
s_lshl_b32 s17, s60, 2
s_add_u32 s17, s17, s9
s_lshl_b32 s17, s17, 1
s_load_dwordx2 s[32:33], s[0:1], 0
s_add_u32 s20, s4, 2097152
s_addc_u32 s21, s5, 0
v_and_b32 v2, 31, v1
v_lshlrev_b32 v2, 10, v2
v_lshrrev_b32 v3, 5, v1
v_lshl_add_u32 v2, v3, 4, v2
s_lshl_b32 s18, s14, 15
s_cmp_eq_u32 s11, 0
s_cselect_b64 vcc, -1, 0
s_cselect_b32 s19, 32, 0x400
s_waitcnt lgkmcnt(0)
s_cselect_b64 s[32:33], s[32:33], s[20:21]
s_mul_i32 s20, s17, s19
s_add_u32 s18, s18, s20
s_add_u32 s32, s32, s18
s_addc_u32 s33, s33, 0
v_cndmask_b32 v2, v0, v2, vcc
global_load_dwordx4 v[8:11], v2, s[32:33] sc1
v_add_u32 v2, s19, v2
global_load_dwordx4 v[12:15], v2, s[32:33] sc1
v_lshrrev_b32 v4, 5, v1
v_lshlrev_b32 v4, 3, v4
v_bfe_u32 v5, v1, 2, 2
v_add_u32 v4, v4, v5
v_lshlrev_b32 v4, 6, v4
v_bfe_u32 v5, v1, 4, 1
v_lshl_add_u32 v4, v5, 5, v4
v_and_b32 v5, 3, v1
v_lshl_add_u32 v4, v5, 3, v4
s_waitcnt vmcnt(2)
s_barrier
ds_read_b64_tr_b16 v[32:33], v4 offset:0
ds_read_b64_tr_b16 v[34:35], v4 offset:256
ds_read_b64_tr_b16 v[36:37], v4 offset:1024
ds_read_b64_tr_b16 v[38:39], v4 offset:1280
ds_read_b64_tr_b16 v[40:41], v4 offset:2048
ds_read_b64_tr_b16 v[42:43], v4 offset:2304
ds_read_b64_tr_b16 v[44:45], v4 offset:3072
ds_read_b64_tr_b16 v[46:47], v4 offset:3328
ds_read_b64_tr_b16 v[48:49], v4 offset:4096
ds_read_b64_tr_b16 v[50:51], v4 offset:4352
ds_read_b64_tr_b16 v[52:53], v4 offset:5120
ds_read_b64_tr_b16 v[54:55], v4 offset:5376
ds_read_b64_tr_b16 v[56:57], v4 offset:6144
ds_read_b64_tr_b16 v[58:59], v4 offset:6400
s_waitcnt lgkmcnt(12)
v_mfma_f32_32x32x16_bf16 v[16:31], v[128:131], v[32:35], 0
ds_read_b64_tr_b16 v[60:61], v4 offset:7168
ds_read_b64_tr_b16 v[62:63], v4 offset:7424
s_waitcnt lgkmcnt(12)
v_mfma_f32_32x32x16_bf16 v[16:31], v[132:135], v[36:39], v[16:31]
ds_read_b64_tr_b16 v[32:33], v4 offset:8192
ds_read_b64_tr_b16 v[34:35], v4 offset:8448
s_waitcnt lgkmcnt(12)
v_mfma_f32_32x32x16_bf16 v[16:31], v[136:139], v[40:43], v[16:31]
ds_read_b64_tr_b16 v[36:37], v4 offset:9216
ds_read_b64_tr_b16 v[38:39], v4 offset:9472
s_waitcnt lgkmcnt(12)
v_mfma_f32_32x32x16_bf16 v[16:31], v[140:143], v[44:47], v[16:31]
ds_read_b64_tr_b16 v[40:41], v4 offset:10240
ds_read_b64_tr_b16 v[42:43], v4 offset:10496
s_waitcnt lgkmcnt(12)
v_mfma_f32_32x32x16_bf16 v[16:31], v[144:147], v[48:51], v[16:31]
ds_read_b64_tr_b16 v[44:45], v4 offset:11264
ds_read_b64_tr_b16 v[46:47], v4 offset:11520
s_waitcnt lgkmcnt(12)
v_mfma_f32_32x32x16_bf16 v[16:31], v[148:151], v[52:55], v[16:31]
ds_read_b64_tr_b16 v[48:49], v4 offset:12288
ds_read_b64_tr_b16 v[50:51], v4 offset:12544
s_waitcnt lgkmcnt(12)
v_mfma_f32_32x32x16_bf16 v[16:31], v[152:155], v[56:59], v[16:31]
ds_read_b64_tr_b16 v[52:53], v4 offset:13312
ds_read_b64_tr_b16 v[54:55], v4 offset:13568
s_waitcnt lgkmcnt(12)
v_mfma_f32_32x32x16_bf16 v[16:31], v[156:159], v[60:63], v[16:31]
ds_read_b64_tr_b16 v[56:57], v4 offset:14336
ds_read_b64_tr_b16 v[58:59], v4 offset:14592
s_waitcnt lgkmcnt(12)
v_mfma_f32_32x32x16_bf16 v[16:31], v[160:163], v[32:35], v[16:31]
ds_read_b64_tr_b16 v[60:61], v4 offset:15360
ds_read_b64_tr_b16 v[62:63], v4 offset:15616
s_waitcnt lgkmcnt(12)
v_mfma_f32_32x32x16_bf16 v[16:31], v[164:167], v[36:39], v[16:31]
ds_read_b64_tr_b16 v[32:33], v4 offset:16384
ds_read_b64_tr_b16 v[34:35], v4 offset:16640
s_waitcnt lgkmcnt(12)
v_mfma_f32_32x32x16_bf16 v[16:31], v[168:171], v[40:43], v[16:31]
ds_read_b64_tr_b16 v[36:37], v4 offset:17408
ds_read_b64_tr_b16 v[38:39], v4 offset:17664
s_waitcnt lgkmcnt(12)
v_mfma_f32_32x32x16_bf16 v[16:31], v[172:175], v[44:47], v[16:31]
ds_read_b64_tr_b16 v[40:41], v4 offset:18432
ds_read_b64_tr_b16 v[42:43], v4 offset:18688
s_waitcnt lgkmcnt(12)
v_mfma_f32_32x32x16_bf16 v[16:31], v[176:179], v[48:51], v[16:31]
ds_read_b64_tr_b16 v[44:45], v4 offset:19456
ds_read_b64_tr_b16 v[46:47], v4 offset:19712
s_waitcnt lgkmcnt(12)
v_mfma_f32_32x32x16_bf16 v[16:31], v[180:183], v[52:55], v[16:31]
ds_read_b64_tr_b16 v[48:49], v4 offset:20480
ds_read_b64_tr_b16 v[50:51], v4 offset:20736
s_waitcnt lgkmcnt(12)
v_mfma_f32_32x32x16_bf16 v[16:31], v[184:187], v[56:59], v[16:31]
ds_read_b64_tr_b16 v[52:53], v4 offset:21504
ds_read_b64_tr_b16 v[54:55], v4 offset:21760
s_waitcnt lgkmcnt(12)
v_mfma_f32_32x32x16_bf16 v[16:31], v[188:191], v[60:63], v[16:31]
ds_read_b64_tr_b16 v[56:57], v4 offset:22528
ds_read_b64_tr_b16 v[58:59], v4 offset:22784
s_waitcnt lgkmcnt(12)
v_mfma_f32_32x32x16_bf16 v[16:31], v[192:195], v[32:35], v[16:31]
ds_read_b64_tr_b16 v[60:61], v4 offset:23552
ds_read_b64_tr_b16 v[62:63], v4 offset:23808
s_waitcnt lgkmcnt(12)
v_mfma_f32_32x32x16_bf16 v[16:31], v[196:199], v[36:39], v[16:31]
ds_read_b64_tr_b16 v[32:33], v4 offset:24576
ds_read_b64_tr_b16 v[34:35], v4 offset:24832
s_waitcnt lgkmcnt(12)
v_mfma_f32_32x32x16_bf16 v[16:31], v[200:203], v[40:43], v[16:31]
ds_read_b64_tr_b16 v[36:37], v4 offset:25600
ds_read_b64_tr_b16 v[38:39], v4 offset:25856
s_waitcnt lgkmcnt(12)
v_mfma_f32_32x32x16_bf16 v[16:31], v[204:207], v[44:47], v[16:31]
ds_read_b64_tr_b16 v[40:41], v4 offset:26624
ds_read_b64_tr_b16 v[42:43], v4 offset:26880
s_waitcnt lgkmcnt(12)
v_mfma_f32_32x32x16_bf16 v[16:31], v[208:211], v[48:51], v[16:31]
ds_read_b64_tr_b16 v[44:45], v4 offset:27648
ds_read_b64_tr_b16 v[46:47], v4 offset:27904
s_waitcnt lgkmcnt(12)
v_mfma_f32_32x32x16_bf16 v[16:31], v[212:215], v[52:55], v[16:31]
ds_read_b64_tr_b16 v[48:49], v4 offset:28672
ds_read_b64_tr_b16 v[50:51], v4 offset:28928
s_waitcnt lgkmcnt(12)
v_mfma_f32_32x32x16_bf16 v[16:31], v[216:219], v[56:59], v[16:31]
ds_read_b64_tr_b16 v[52:53], v4 offset:29696
ds_read_b64_tr_b16 v[54:55], v4 offset:29952
s_waitcnt lgkmcnt(12)
v_mfma_f32_32x32x16_bf16 v[16:31], v[220:223], v[60:63], v[16:31]
ds_read_b64_tr_b16 v[56:57], v4 offset:30720
ds_read_b64_tr_b16 v[58:59], v4 offset:30976
s_waitcnt lgkmcnt(12)
v_mfma_f32_32x32x16_bf16 v[16:31], v[224:227], v[32:35], v[16:31]
ds_read_b64_tr_b16 v[60:61], v4 offset:31744
ds_read_b64_tr_b16 v[62:63], v4 offset:32000
s_waitcnt lgkmcnt(12)
v_mfma_f32_32x32x16_bf16 v[16:31], v[228:231], v[36:39], v[16:31]
s_waitcnt lgkmcnt(10)
v_mfma_f32_32x32x16_bf16 v[16:31], v[232:235], v[40:43], v[16:31]
s_waitcnt lgkmcnt(8)
v_mfma_f32_32x32x16_bf16 v[16:31], v[236:239], v[44:47], v[16:31]
s_waitcnt lgkmcnt(6)
v_mfma_f32_32x32x16_bf16 v[16:31], v[240:243], v[48:51], v[16:31]
s_waitcnt lgkmcnt(4)
v_mfma_f32_32x32x16_bf16 v[16:31], v[244:247], v[52:55], v[16:31]
s_waitcnt lgkmcnt(2)
v_mfma_f32_32x32x16_bf16 v[16:31], v[248:251], v[56:59], v[16:31]
s_waitcnt lgkmcnt(0)
v_mfma_f32_32x32x16_bf16 v[16:31], v[252:255], v[60:63], v[16:31]
s_lshl_b32 s17, s60, 2
s_add_u32 s17, s17, s9
s_lshl_b32 s17, s17, 11
s_lshl_b32 s18, s14, 15
s_add_u32 s18, s18, s17
s_add_u32 s18, s18, 4194304
s_add_u32 s34, s4, s18
s_addc_u32 s35, s5, 0
s_mov_b32 s17, 0x3f803f80
s_mov_b32 s19, 0xffff0000
v_mov_b64 v[4:5], 0
v_mov_b64 v[6:7], 0
s_waitcnt vmcnt(0)
v_lshlrev_b32 v32, 16, v8
v_and_b32 v33, s19, v8
v_lshlrev_b32 v34, 16, v9
v_and_b32 v35, s19, v9
v_lshlrev_b32 v36, 16, v10
v_and_b32 v37, s19, v10
v_lshlrev_b32 v38, 16, v11
v_and_b32 v39, s19, v11
v_lshlrev_b32 v40, 16, v12
v_and_b32 v41, s19, v12
v_lshlrev_b32 v42, 16, v13
v_and_b32 v43, s19, v13
v_lshlrev_b32 v44, 16, v14
v_and_b32 v45, s19, v14
v_lshlrev_b32 v46, 16, v15
v_and_b32 v47, s19, v15
v_cvt_pk_bf16_f32 v8, v16, v17
v_cvt_pk_bf16_f32 v9, v18, v19
v_cvt_pk_bf16_f32 v10, v20, v21
v_cvt_pk_bf16_f32 v11, v22, v23
v_cvt_pk_bf16_f32 v12, v24, v25
v_cvt_pk_bf16_f32 v13, v26, v27
v_cvt_pk_bf16_f32 v14, v28, v29
v_cvt_pk_bf16_f32 v15, v30, v31
v_lshlrev_b32 v16, 16, v8
v_and_b32 v17, s19, v8
v_lshlrev_b32 v18, 16, v9
v_and_b32 v19, s19, v9
v_lshlrev_b32 v20, 16, v10
v_and_b32 v21, s19, v10
v_lshlrev_b32 v22, 16, v11
v_and_b32 v23, s19, v11
v_lshlrev_b32 v24, 16, v12
v_and_b32 v25, s19, v12
v_lshlrev_b32 v26, 16, v13
v_and_b32 v27, s19, v13
v_lshlrev_b32 v28, 16, v14
v_and_b32 v29, s19, v14
v_lshlrev_b32 v30, 16, v15
v_and_b32 v31, s19, v15
v_pk_add_f32 v[16:17], v[16:17], v[32:33]
v_pk_add_f32 v[18:19], v[18:19], v[34:35]
v_pk_add_f32 v[20:21], v[20:21], v[36:37]
v_pk_add_f32 v[22:23], v[22:23], v[38:39]
v_pk_add_f32 v[24:25], v[24:25], v[40:41]
v_pk_add_f32 v[26:27], v[26:27], v[42:43]
v_pk_add_f32 v[28:29], v[28:29], v[44:45]
v_pk_add_f32 v[30:31], v[30:31], v[46:47]
v_cvt_pk_bf16_f32 v8, v16, v17
v_cvt_pk_bf16_f32 v9, v18, v19
v_cvt_pk_bf16_f32 v10, v20, v21
v_cvt_pk_bf16_f32 v11, v22, v23
v_cvt_pk_bf16_f32 v12, v24, v25
v_cvt_pk_bf16_f32 v13, v26, v27
v_cvt_pk_bf16_f32 v14, v28, v29
v_cvt_pk_bf16_f32 v15, v30, v31
global_store_dwordx4 v0, v[8:11], s[34:35] sc1
global_store_dwordx4 v0, v[12:15], s[34:35] offset:1024 sc1
v_dot2_f32_bf16 v4, v8, s17, v4
v_dot2_f32_bf16 v5, v8, v8, v5
v_dot2_f32_bf16 v6, v9, s17, v6
v_dot2_f32_bf16 v7, v9, v9, v7
v_dot2_f32_bf16 v4, v10, s17, v4
v_dot2_f32_bf16 v5, v10, v10, v5
v_dot2_f32_bf16 v6, v11, s17, v6
v_dot2_f32_bf16 v7, v11, v11, v7
v_dot2_f32_bf16 v4, v12, s17, v4
v_dot2_f32_bf16 v5, v12, v12, v5
v_dot2_f32_bf16 v6, v13, s17, v6
v_dot2_f32_bf16 v7, v13, v13, v7
v_dot2_f32_bf16 v4, v14, s17, v4
v_dot2_f32_bf16 v5, v14, v14, v5
v_dot2_f32_bf16 v6, v15, s17, v6
v_dot2_f32_bf16 v7, v15, v15, v7
s_nop 2
v_add_f32 v4, v4, v6
v_add_f32 v5, v5, v7
s_lshl_b32 s16, s9, 9
v_lshl_add_u32 v3, v1, 3, s16
ds_write_b64 v3, v[4:5] offset:32768
s_waitcnt lgkmcnt(0)
s_barrier
s_cmp_lg_u32 s9, 0
s_cbranch_scc1 L_t3f_24
v_and_b32 v3, 31, v1
v_lshlrev_b32 v3, 3, v3
ds_read_b64 v[32:33], v3 offset:32768
ds_read_b64 v[34:35], v3 offset:33024
ds_read_b64 v[36:37], v3 offset:33280
ds_read_b64 v[38:39], v3 offset:33536
ds_read_b64 v[40:41], v3 offset:33792
ds_read_b64 v[42:43], v3 offset:34048
ds_read_b64 v[44:45], v3 offset:34304
ds_read_b64 v[46:47], v3 offset:34560
s_lshl_b32 s16, s14, 2
s_add_u32 s16, s16, s60
s_lshl_b32 s17, s16, 8
s_add_u32 s17, s17, 524288
s_add_u32 s34, s4, s17
s_addc_u32 s35, s5, 0
s_waitcnt lgkmcnt(0)
v_pk_add_f32 v[32:33], v[32:33], v[40:41]
v_pk_add_f32 v[34:35], v[34:35], v[42:43]
v_pk_add_f32 v[36:37], v[36:37], v[44:45]
v_pk_add_f32 v[38:39], v[38:39], v[46:47]
v_pk_add_f32 v[32:33], v[32:33], v[36:37]
v_pk_add_f32 v[34:35], v[34:35], v[38:39]
v_pk_add_f32 v[32:33], v[32:33], v[34:35]
s_mov_b32 exec_hi, 0
global_store_dwordx2 v3, v[32:33], s[34:35] sc1
s_mov_b32 exec_hi, -1
L_t3f_24:
s_waitcnt vmcnt(0)
s_barrier
s_cmp_lg_u32 s9, 0
s_cbranch_scc1 L_t3g_25
s_and_b32 s17, s16, 3
s_lshl_b32 s17, s17, 2
s_lshr_b32 s16, s16, 2
s_lshl_b32 s16, s16, 7
s_add_u32 s16, s16, s17
s_add_u32 s16, s16, 1064960
v_mov_b32 v2, s16
v_mov_b32 v3, 1
s_mov_b64 exec, 1
global_store_dword v2, v3, s[4:5] sc1
s_mov_b64 exec, -1
L_t3g_25:
s_add_u32 s14, s14, 23
s_cmp_lt_u32 s14, 64
s_cbranch_scc1 L_t3l
s_cmp_ge_u32 s8, 192
s_cbranch_scc1 L_t5
L_q:
s_cmp_eq_u32 s46, 0
s_cselect_b32 s16, 48, 56
s_cmp_eq_u32 s46, 2
s_cselect_b32 s16, 40, s16
s_load_dwordx2 s[36:37], s[0:1], s16
v_lshrrev_b32 v2, 3, v1
s_lshl_b32 s16, s9, 7
v_add_u32 v2, s16, v2
v_lshlrev_b32 v2, 13, v2
v_and_b32 v3, 7, v1
v_lshl_add_u32 v2, v3, 4, v2
s_and_b32 s16, s8, 63
s_lshl_b32 s16, s16, 7
v_add_u32 v2, s16, v2
s_lshl_b32 s16, s9, 14
s_waitcnt lgkmcnt(0)
s_add_u32 m0, s16, 65536
s_nop 0
global_load_lds_dwordx4 v2, s[36:37]
s_add_u32 m0, s16, 66560
v_add_u32 v2, 0x10000, v2
global_load_lds_dwordx4 v2, s[36:37]
s_add_u32 m0, s16, 67584
v_add_u32 v2, 0x10000, v2
global_load_lds_dwordx4 v2, s[36:37]
s_add_u32 m0, s16, 68608
v_add_u32 v2, 0x10000, v2
global_load_lds_dwordx4 v2, s[36:37]
s_add_u32 m0, s16, 69632
v_add_u32 v2, 0x10000, v2
global_load_lds_dwordx4 v2, s[36:37]
s_add_u32 m0, s16, 70656
v_add_u32 v2, 0x10000, v2
global_load_lds_dwordx4 v2, s[36:37]
s_add_u32 m0, s16, 71680
v_add_u32 v2, 0x10000, v2
global_load_lds_dwordx4 v2, s[36:37]
s_add_u32 m0, s16, 72704
v_add_u32 v2, 0x10000, v2
global_load_lds_dwordx4 v2, s[36:37]
s_add_u32 m0, s16, 73728
v_add_u32 v2, 0x10000, v2
global_load_lds_dwordx4 v2, s[36:37]
s_add_u32 m0, s16, 74752
v_add_u32 v2, 0x10000, v2
global_load_lds_dwordx4 v2, s[36:37]
s_add_u32 m0, s16, 75776
v_add_u32 v2, 0x10000, v2
global_load_lds_dwordx4 v2, s[36:37]
s_add_u32 m0, s16, 76800
v_add_u32 v2, 0x10000, v2
global_load_lds_dwordx4 v2, s[36:37]
s_add_u32 m0, s16, 77824
v_add_u32 v2, 0x10000, v2
global_load_lds_dwordx4 v2, s[36:37]
s_add_u32 m0, s16, 78848
v_add_u32 v2, 0x10000, v2
global_load_lds_dwordx4 v2, s[36:37]
s_add_u32 m0, s16, 79872
v_add_u32 v2, 0x10000, v2
global_load_lds_dwordx4 v2, s[36:37]
s_add_u32 m0, s16, 80896
v_add_u32 v2, 0x10000, v2
global_load_lds_dwordx4 v2, s[36:37]
s_waitcnt vmcnt(0)
v_lshrrev_b32 v4, 5, v1
v_lshlrev_b32 v4, 3, v4
v_bfe_u32 v5, v1, 2, 2
v_add_u32 v4, v4, v5
v_lshlrev_b32 v4, 7, v4
v_bfe_u32 v5, v1, 4, 1
v_lshl_add_u32 v4, v5, 5, v4
v_and_b32 v5, 3, v1
v_lshl_add_u32 v4, v5, 3, v4
v_add_u32 v4, 65536, v4
s_barrier
ds_read_b64_tr_b16 a[0:1], v4 offset:0
ds_read_b64_tr_b16 a[2:3], v4 offset:512
ds_read_b64_tr_b16 a[128:129], v4 offset:64
ds_read_b64_tr_b16 a[130:131], v4 offset:576
ds_read_b64_tr_b16 a[4:5], v4 offset:2048
ds_read_b64_tr_b16 a[6:7], v4 offset:2560
ds_read_b64_tr_b16 a[132:133], v4 offset:2112
ds_read_b64_tr_b16 a[134:135], v4 offset:2624
ds_read_b64_tr_b16 a[8:9], v4 offset:4096
ds_read_b64_tr_b16 a[10:11], v4 offset:4608
ds_read_b64_tr_b16 a[136:137], v4 offset:4160
ds_read_b64_tr_b16 a[138:139], v4 offset:4672
s_waitcnt lgkmcnt(2)
ds_read_b64_tr_b16 a[12:13], v4 offset:6144
ds_read_b64_tr_b16 a[14:15], v4 offset:6656
ds_read_b64_tr_b16 a[140:141], v4 offset:6208
ds_read_b64_tr_b16 a[142:143], v4 offset:6720
ds_read_b64_tr_b16 a[16:17], v4 offset:8192
ds_read_b64_tr_b16 a[18:19], v4 offset:8704
ds_read_b64_tr_b16 a[144:145], v4 offset:8256
ds_read_b64_tr_b16 a[146:147], v4 offset:8768
ds_read_b64_tr_b16 a[20:21], v4 offset:10240
ds_read_b64_tr_b16 a[22:23], v4 offset:10752
ds_read_b64_tr_b16 a[148:149], v4 offset:10304
ds_read_b64_tr_b16 a[150:151], v4 offset:10816
s_waitcnt lgkmcnt(2)
ds_read_b64_tr_b16 a[24:25], v4 offset:12288
ds_read_b64_tr_b16 a[26:27], v4 offset:12800
ds_read_b64_tr_b16 a[152:153], v4 offset:12352
ds_read_b64_tr_b16 a[154:155], v4 offset:12864
ds_read_b64_tr_b16 a[28:29], v4 offset:14336
ds_read_b64_tr_b16 a[30:31], v4 offset:14848
ds_read_b64_tr_b16 a[156:157], v4 offset:14400
ds_read_b64_tr_b16 a[158:159], v4 offset:14912
ds_read_b64_tr_b16 a[32:33], v4 offset:16384
ds_read_b64_tr_b16 a[34:35], v4 offset:16896
ds_read_b64_tr_b16 a[160:161], v4 offset:16448
ds_read_b64_tr_b16 a[162:163], v4 offset:16960
s_waitcnt lgkmcnt(2)
ds_read_b64_tr_b16 a[36:37], v4 offset:18432
ds_read_b64_tr_b16 a[38:39], v4 offset:18944
ds_read_b64_tr_b16 a[164:165], v4 offset:18496
ds_read_b64_tr_b16 a[166:167], v4 offset:19008
ds_read_b64_tr_b16 a[40:41], v4 offset:20480
ds_read_b64_tr_b16 a[42:43], v4 offset:20992
ds_read_b64_tr_b16 a[168:169], v4 offset:20544
ds_read_b64_tr_b16 a[170:171], v4 offset:21056
ds_read_b64_tr_b16 a[44:45], v4 offset:22528
ds_read_b64_tr_b16 a[46:47], v4 offset:23040
ds_read_b64_tr_b16 a[172:173], v4 offset:22592
ds_read_b64_tr_b16 a[174:175], v4 offset:23104
s_waitcnt lgkmcnt(2)
ds_read_b64_tr_b16 a[48:49], v4 offset:24576
ds_read_b64_tr_b16 a[50:51], v4 offset:25088
ds_read_b64_tr_b16 a[176:177], v4 offset:24640
ds_read_b64_tr_b16 a[178:179], v4 offset:25152
ds_read_b64_tr_b16 a[52:53], v4 offset:26624
ds_read_b64_tr_b16 a[54:55], v4 offset:27136
ds_read_b64_tr_b16 a[180:181], v4 offset:26688
ds_read_b64_tr_b16 a[182:183], v4 offset:27200
ds_read_b64_tr_b16 a[56:57], v4 offset:28672
ds_read_b64_tr_b16 a[58:59], v4 offset:29184
ds_read_b64_tr_b16 a[184:185], v4 offset:28736
ds_read_b64_tr_b16 a[186:187], v4 offset:29248
s_waitcnt lgkmcnt(2)
ds_read_b64_tr_b16 a[60:61], v4 offset:30720
ds_read_b64_tr_b16 a[62:63], v4 offset:31232
ds_read_b64_tr_b16 a[188:189], v4 offset:30784
ds_read_b64_tr_b16 a[190:191], v4 offset:31296
ds_read_b64_tr_b16 a[64:65], v4 offset:32768
ds_read_b64_tr_b16 a[66:67], v4 offset:33280
ds_read_b64_tr_b16 a[192:193], v4 offset:32832
ds_read_b64_tr_b16 a[194:195], v4 offset:33344
ds_read_b64_tr_b16 a[68:69], v4 offset:34816
ds_read_b64_tr_b16 a[70:71], v4 offset:35328
ds_read_b64_tr_b16 a[196:197], v4 offset:34880
ds_read_b64_tr_b16 a[198:199], v4 offset:35392
s_waitcnt lgkmcnt(2)
ds_read_b64_tr_b16 a[72:73], v4 offset:36864
ds_read_b64_tr_b16 a[74:75], v4 offset:37376
ds_read_b64_tr_b16 a[200:201], v4 offset:36928
ds_read_b64_tr_b16 a[202:203], v4 offset:37440
ds_read_b64_tr_b16 a[76:77], v4 offset:38912
ds_read_b64_tr_b16 a[78:79], v4 offset:39424
ds_read_b64_tr_b16 a[204:205], v4 offset:38976
ds_read_b64_tr_b16 a[206:207], v4 offset:39488
ds_read_b64_tr_b16 a[80:81], v4 offset:40960
ds_read_b64_tr_b16 a[82:83], v4 offset:41472
ds_read_b64_tr_b16 a[208:209], v4 offset:41024
ds_read_b64_tr_b16 a[210:211], v4 offset:41536
s_waitcnt lgkmcnt(2)
ds_read_b64_tr_b16 a[84:85], v4 offset:43008
ds_read_b64_tr_b16 a[86:87], v4 offset:43520
ds_read_b64_tr_b16 a[212:213], v4 offset:43072
ds_read_b64_tr_b16 a[214:215], v4 offset:43584
ds_read_b64_tr_b16 a[88:89], v4 offset:45056
ds_read_b64_tr_b16 a[90:91], v4 offset:45568
ds_read_b64_tr_b16 a[216:217], v4 offset:45120
ds_read_b64_tr_b16 a[218:219], v4 offset:45632
ds_read_b64_tr_b16 a[92:93], v4 offset:47104
ds_read_b64_tr_b16 a[94:95], v4 offset:47616
ds_read_b64_tr_b16 a[220:221], v4 offset:47168
ds_read_b64_tr_b16 a[222:223], v4 offset:47680
s_waitcnt lgkmcnt(2)
ds_read_b64_tr_b16 a[96:97], v4 offset:49152
ds_read_b64_tr_b16 a[98:99], v4 offset:49664
ds_read_b64_tr_b16 a[224:225], v4 offset:49216
ds_read_b64_tr_b16 a[226:227], v4 offset:49728
ds_read_b64_tr_b16 a[100:101], v4 offset:51200
ds_read_b64_tr_b16 a[102:103], v4 offset:51712
ds_read_b64_tr_b16 a[228:229], v4 offset:51264
ds_read_b64_tr_b16 a[230:231], v4 offset:51776
ds_read_b64_tr_b16 a[104:105], v4 offset:53248
ds_read_b64_tr_b16 a[106:107], v4 offset:53760
ds_read_b64_tr_b16 a[232:233], v4 offset:53312
ds_read_b64_tr_b16 a[234:235], v4 offset:53824
s_waitcnt lgkmcnt(2)
ds_read_b64_tr_b16 a[108:109], v4 offset:55296
ds_read_b64_tr_b16 a[110:111], v4 offset:55808
ds_read_b64_tr_b16 a[236:237], v4 offset:55360
ds_read_b64_tr_b16 a[238:239], v4 offset:55872
ds_read_b64_tr_b16 a[112:113], v4 offset:57344
ds_read_b64_tr_b16 a[114:115], v4 offset:57856
ds_read_b64_tr_b16 a[240:241], v4 offset:57408
ds_read_b64_tr_b16 a[242:243], v4 offset:57920
ds_read_b64_tr_b16 a[116:117], v4 offset:59392
ds_read_b64_tr_b16 a[118:119], v4 offset:59904
ds_read_b64_tr_b16 a[244:245], v4 offset:59456
ds_read_b64_tr_b16 a[246:247], v4 offset:59968
s_waitcnt lgkmcnt(2)
ds_read_b64_tr_b16 a[120:121], v4 offset:61440
ds_read_b64_tr_b16 a[122:123], v4 offset:61952
ds_read_b64_tr_b16 a[248:249], v4 offset:61504
ds_read_b64_tr_b16 a[250:251], v4 offset:62016
ds_read_b64_tr_b16 a[124:125], v4 offset:63488
ds_read_b64_tr_b16 a[126:127], v4 offset:64000
ds_read_b64_tr_b16 a[252:253], v4 offset:63552
ds_read_b64_tr_b16 a[254:255], v4 offset:64064
s_waitcnt lgkmcnt(0)
s_barrier
v_mov_b32 v8, 0x3f803f80
v_mov_b32 v9, 0x3f803f80
v_mov_b32 v10, 0x3f803f80
v_mov_b32 v11, 0x3f803f80
s_nop 1
v_mfma_f32_32x32x16_bf16 v[16:31], v[8:11], a[0:3], 0
v_mfma_f32_32x32x16_bf16 v[16:31], v[8:11], a[4:7], v[16:31]
v_mfma_f32_32x32x16_bf16 v[16:31], v[8:11], a[8:11], v[16:31]
v_mfma_f32_32x32x16_bf16 v[16:31], v[8:11], a[12:15], v[16:31]
v_mfma_f32_32x32x16_bf16 v[16:31], v[8:11], a[16:19], v[16:31]
v_mfma_f32_32x32x16_bf16 v[16:31], v[8:11], a[20:23], v[16:31]
v_mfma_f32_32x32x16_bf16 v[16:31], v[8:11], a[24:27], v[16:31]
v_mfma_f32_32x32x16_bf16 v[16:31], v[8:11], a[28:31], v[16:31]
v_mfma_f32_32x32x16_bf16 v[16:31], v[8:11], a[32:35], v[16:31]
v_mfma_f32_32x32x16_bf16 v[16:31], v[8:11], a[36:39], v[16:31]
v_mfma_f32_32x32x16_bf16 v[16:31], v[8:11], a[40:43], v[16:31]
v_mfma_f32_32x32x16_bf16 v[16:31], v[8:11], a[44:47], v[16:31]
v_mfma_f32_32x32x16_bf16 v[16:31], v[8:11], a[48:51], v[16:31]
v_mfma_f32_32x32x16_bf16 v[16:31], v[8:11], a[52:55], v[16:31]
v_mfma_f32_32x32x16_bf16 v[16:31], v[8:11], a[56:59], v[16:31]
v_mfma_f32_32x32x16_bf16 v[16:31], v[8:11], a[60:63], v[16:31]
v_mfma_f32_32x32x16_bf16 v[16:31], v[8:11], a[64:67], v[16:31]
v_mfma_f32_32x32x16_bf16 v[16:31], v[8:11], a[68:71], v[16:31]
v_mfma_f32_32x32x16_bf16 v[16:31], v[8:11], a[72:75], v[16:31]
v_mfma_f32_32x32x16_bf16 v[16:31], v[8:11], a[76:79], v[16:31]
v_mfma_f32_32x32x16_bf16 v[16:31], v[8:11], a[80:83], v[16:31]
v_mfma_f32_32x32x16_bf16 v[16:31], v[8:11], a[84:87], v[16:31]
v_mfma_f32_32x32x16_bf16 v[16:31], v[8:11], a[88:91], v[16:31]
v_mfma_f32_32x32x16_bf16 v[16:31], v[8:11], a[92:95], v[16:31]
v_mfma_f32_32x32x16_bf16 v[16:31], v[8:11], a[96:99], v[16:31]
v_mfma_f32_32x32x16_bf16 v[16:31], v[8:11], a[100:103], v[16:31]
v_mfma_f32_32x32x16_bf16 v[16:31], v[8:11], a[104:107], v[16:31]
v_mfma_f32_32x32x16_bf16 v[16:31], v[8:11], a[108:111], v[16:31]
v_mfma_f32_32x32x16_bf16 v[16:31], v[8:11], a[112:115], v[16:31]
v_mfma_f32_32x32x16_bf16 v[16:31], v[8:11], a[116:119], v[16:31]
v_mfma_f32_32x32x16_bf16 v[16:31], v[8:11], a[120:123], v[16:31]
v_mfma_f32_32x32x16_bf16 v[16:31], v[8:11], a[124:127], v[16:31]
v_mfma_f32_32x32x16_bf16 v[32:47], v[8:11], a[128:131], 0
v_mfma_f32_32x32x16_bf16 v[32:47], v[8:11], a[132:135], v[32:47]
v_mfma_f32_32x32x16_bf16 v[32:47], v[8:11], a[136:139], v[32:47]
v_mfma_f32_32x32x16_bf16 v[32:47], v[8:11], a[140:143], v[32:47]
v_mfma_f32_32x32x16_bf16 v[32:47], v[8:11], a[144:147], v[32:47]
v_mfma_f32_32x32x16_bf16 v[32:47], v[8:11], a[148:151], v[32:47]
v_mfma_f32_32x32x16_bf16 v[32:47], v[8:11], a[152:155], v[32:47]
v_mfma_f32_32x32x16_bf16 v[32:47], v[8:11], a[156:159], v[32:47]
v_mfma_f32_32x32x16_bf16 v[32:47], v[8:11], a[160:163], v[32:47]
v_mfma_f32_32x32x16_bf16 v[32:47], v[8:11], a[164:167], v[32:47]
v_mfma_f32_32x32x16_bf16 v[32:47], v[8:11], a[168:171], v[32:47]
v_mfma_f32_32x32x16_bf16 v[32:47], v[8:11], a[172:175], v[32:47]
v_mfma_f32_32x32x16_bf16 v[32:47], v[8:11], a[176:179], v[32:47]
v_mfma_f32_32x32x16_bf16 v[32:47], v[8:11], a[180:183], v[32:47]
v_mfma_f32_32x32x16_bf16 v[32:47], v[8:11], a[184:187], v[32:47]
v_mfma_f32_32x32x16_bf16 v[32:47], v[8:11], a[188:191], v[32:47]
v_mfma_f32_32x32x16_bf16 v[32:47], v[8:11], a[192:195], v[32:47]
v_mfma_f32_32x32x16_bf16 v[32:47], v[8:11], a[196:199], v[32:47]
v_mfma_f32_32x32x16_bf16 v[32:47], v[8:11], a[200:203], v[32:47]
v_mfma_f32_32x32x16_bf16 v[32:47], v[8:11], a[204:207], v[32:47]
v_mfma_f32_32x32x16_bf16 v[32:47], v[8:11], a[208:211], v[32:47]
v_mfma_f32_32x32x16_bf16 v[32:47], v[8:11], a[212:215], v[32:47]
v_mfma_f32_32x32x16_bf16 v[32:47], v[8:11], a[216:219], v[32:47]
v_mfma_f32_32x32x16_bf16 v[32:47], v[8:11], a[220:223], v[32:47]
v_mfma_f32_32x32x16_bf16 v[32:47], v[8:11], a[224:227], v[32:47]
v_mfma_f32_32x32x16_bf16 v[32:47], v[8:11], a[228:231], v[32:47]
v_mfma_f32_32x32x16_bf16 v[32:47], v[8:11], a[232:235], v[32:47]
v_mfma_f32_32x32x16_bf16 v[32:47], v[8:11], a[236:239], v[32:47]
v_mfma_f32_32x32x16_bf16 v[32:47], v[8:11], a[240:243], v[32:47]
v_mfma_f32_32x32x16_bf16 v[32:47], v[8:11], a[244:247], v[32:47]
v_mfma_f32_32x32x16_bf16 v[32:47], v[8:11], a[248:251], v[32:47]
v_mfma_f32_32x32x16_bf16 v[32:47], v[8:11], a[252:255], v[32:47]
v_cmp_gt_u32 vcc, 32, v1
v_cvt_pk_bf16_f32 v8, v16, v16
v_lshlrev_b32 v9, 16, v8
v_sub_f32 v10, v16, v9
v_cvt_pk_bf16_f32 v11, v9, v10
v_and_b32 v12, 0xffff0000, v11
v_sub_f32 v10, v10, v12
v_cvt_pk_bf16_f32 v12, v10, 0
v_cndmask_b32 v248, 0, v11, vcc
v_cndmask_b32 v249, 0, v12, vcc
v_mov_b64 v[250:251], 0
s_nop 0
v_cvt_pk_bf16_f32 v8, v32, v32
v_lshlrev_b32 v9, 16, v8
v_sub_f32 v10, v32, v9
v_cvt_pk_bf16_f32 v11, v9, v10
v_and_b32 v12, 0xffff0000, v11
v_sub_f32 v10, v10, v12
v_cvt_pk_bf16_f32 v12, v10, 0
v_cndmask_b32 v252, 0, v11, vcc
v_cndmask_b32 v253, 0, v12, vcc
v_mov_b64 v[254:255], 0
L_t4:
s_cmp_eq_u32 s15, 1
s_cbranch_scc1 L_sbd_27
s_mov_b32 s10, 0
v_mov_b32 v2, 0
L_sb_26:
global_load_dword v3, v2, s[6:7] offset:128 sc1
s_add_u32 s10, s10, 1
s_cmp_gt_u32 s10, 400000
s_cbranch_scc1 L_fail
s_waitcnt vmcnt(0)
v_cmp_ne_u32 vcc, 0x100, v3
s_cbranch_vccnz L_sb_26
s_mov_b32 s15, 1
L_sbd_27:
s_cmp_eq_u32 s46, 1
s_cbranch_scc1 L_t4v
v_bfe_u32 v2, v1, 4, 1
v_lshlrev_b32 v2, 13, v2
v_bfe_u32 v5, v1, 2, 1
v_lshl_add_u32 v2, v5, 12, v2
v_lshrrev_b32 v5, 5, v1
v_lshl_add_u32 v2, v5, 8, v2
v_bfe_u32 v5, v1, 3, 1
v_lshl_add_u32 v2, v5, 6, v2
v_and_b32 v5, 3, v1
v_lshl_add_u32 v2, v5, 4, v2
s_lshl_b32 s16, s47, 14
s_lshl_b32 s17, s48, 10
s_add_u32 s16, s16, s17
s_add_u32 s16, s16, 25165824
s_lshl_b32 s18, s47, 13
s_lshl_b32 s17, s48, 12
s_add_u32 s18, s18, s17
s_add_u32 s18, s18, 58720256
s_cmp_eq_u32 s46, 2
s_cselect_b32 s16, s18, s16
s_cselect_b32 s19, 18, 19
s_cselect_b32 s20, 3, 0
s_cselect_b32 s21, 2, 0
s_cselect_b64 vcc, -1, 0
s_lshl_b32 s42, 4, s19
s_lshl_b32 s17, s9, s19
v_cndmask_b32 v2, v2, v0, vcc
s_lshl_b32 s20, 128, s20
s_lshl_b32 s21, 512, s21
v_add_u32 v5, s20, v2
v_add_u32 v6, s21, v2
v_add_u32 v7, s21, v5
s_add_u32 s16, s16, s17
s_add_u32 s34, s4, s16
s_addc_u32 s35, s5, 0
s_lshl_b32 s16, s9, 15
s_add_u32 s16, s16, 4198400
s_add_u32 s32, s4, s16
s_addc_u32 s33, s5, 0
s_lshl_b32 s16, s9, 10
s_add_u32 s16, s16, 524288
s_add_u32 s38, s4, s16
s_addc_u32 s39, s5, 0
s_lshl_b32 s40, s47, 10
s_lshl_b32 s16, s46, 8
s_add_u32 s40, s40, s16
s_lshl_b32 s16, s48, 7
s_add_u32 s40, s40, s16
s_lshl_b32 s16, s9, 2
s_add_u32 s40, s40, s16
s_add_u32 s40, s40, 1081344
s_lshl_b32 s16, s9, 7
s_add_u32 s16, s16, 1064960
v_mov_b32 v3, s16
v_and_b32 v4, 31, v1
v_lshlrev_b32 v4, 3, v4
v_add_u32 v8, 0x2000, v0
v_add_u32 v9, 0x4000, v0
v_add_u32 v10, 0x6000, v0
s_lshl_b32 s16, s9, 7
s_add_u32 s16, s16, 32768
v_lshrrev_b32 v11, 1, v4
v_add_u32 v11, s16, v11
v_lshrrev_b32 v12, 5, v1
v_lshl_add_u32 v12, v12, 4, s16
v_mov_b64 v[58:59], 0
s_mov_b32 s41, 0
L_t4_28:
s_mov_b32 s10, 0
s_mov_b64 exec, 1
L_wt_30:
global_load_dwordx4 v[48:51], v3, s[4:5] offset:0 sc1
s_add_u32 s10, s10, 1
s_cmp_gt_u32 s10, 400000
s_cbranch_scc1 L_fail
s_waitcnt vmcnt(0)
v_min3_u32 v48, v48, v49, v50
v_min_u32 v48, v48, v51
v_cmp_gt_u32 vcc, 1, v48
s_cbranch_vccz L_wd_31
s_sleep 1
s_branch L_wt_30
L_wd_31:
s_mov_b64 exec, -1
global_load_dwordx2 v[48:49], v4, s[38:39] offset:0 sc1
global_load_dwordx2 v[50:51], v4, s[38:39] offset:256 sc1
global_load_dwordx2 v[52:53], v4, s[38:39] offset:512 sc1
global_load_dwordx2 v[54:55], v4, s[38:39] offset:768 sc1
global_load_dwordx4 v[64:67], v0, s[32:33] offset:-4096 sc1
global_load_dwordx4 v[68:71], v0, s[32:33] offset:-3072 sc1
global_load_dwordx4 v[72:75], v0, s[32:33] offset:-2048 sc1
global_load_dwordx4 v[76:79], v0, s[32:33] offset:-1024 sc1
global_load_dwordx4 v[80:83], v0, s[32:33] offset:0 sc1
global_load_dwordx4 v[84:87], v0, s[32:33] offset:1024 sc1
global_load_dwordx4 v[88:91], v0, s[32:33] offset:2048 sc1
global_load_dwordx4 v[92:95], v0, s[32:33] offset:3072 sc1
global_load_dwordx4 v[96:99], v8, s[32:33] offset:-4096 sc1
global_load_dwordx4 v[100:103], v8, s[32:33] offset:-3072 sc1
global_load_dwordx4 v[104:107], v8, s[32:33] offset:-2048 sc1
global_load_dwordx4 v[108:111], v8, s[32:33] offset:-1024 sc1
global_load_dwordx4 v[112:115], v8, s[32:33] offset:0 sc1
global_load_dwordx4 v[116:119], v8, s[32:33] offset:1024 sc1
global_load_dwordx4 v[120:123], v8, s[32:33] offset:2048 sc1
global_load_dwordx4 v[124:127], v8, s[32:33] offset:3072 sc1
global_load_dwordx4 v[128:131], v9, s[32:33] offset:-4096 sc1
global_load_dwordx4 v[132:135], v9, s[32:33] offset:-3072 sc1
global_load_dwordx4 v[136:139], v9, s[32:33] offset:-2048 sc1
global_load_dwordx4 v[140:143], v9, s[32:33] offset:-1024 sc1
global_load_dwordx4 v[144:147], v9, s[32:33] offset:0 sc1
global_load_dwordx4 v[148:151], v9, s[32:33] offset:1024 sc1
global_load_dwordx4 v[152:155], v9, s[32:33] offset:2048 sc1
global_load_dwordx4 v[156:159], v9, s[32:33] offset:3072 sc1
global_load_dwordx4 v[160:163], v10, s[32:33] offset:-4096 sc1
global_load_dwordx4 v[164:167], v10, s[32:33] offset:-3072 sc1
global_load_dwordx4 v[168:171], v10, s[32:33] offset:-2048 sc1
global_load_dwordx4 v[172:175], v10, s[32:33] offset:-1024 sc1
global_load_dwordx4 v[176:179], v10, s[32:33] offset:0 sc1
global_load_dwordx4 v[180:183], v10, s[32:33] offset:1024 sc1
global_load_dwordx4 v[184:187], v10, s[32:33] offset:2048 sc1
global_load_dwordx4 v[188:191], v10, s[32:33] offset:3072 sc1
s_waitcnt vmcnt(32)
v_pk_add_f32 v[48:49], v[48:49], v[50:51]
v_pk_add_f32 v[52:53], v[52:53], v[54:55]
v_pk_add_f32 v[48:49], v[48:49], v[52:53]
v_mul_f32 v50, 0x3b000000, v48
v_mul_f32 v52, 0x3b000000, v49
v_fma_f32 v52, -v50, v50, v52
v_max_f32 v52, 0, v52
v_cvt_pk_bf16_f32 v52, v52, v52
v_lshlrev_b32 v52, 16, v52
v_add_f32 v52, 0x3727c5ac, v52
v_cvt_pk_bf16_f32 v52, v52, v52
v_lshlrev_b32 v52, 16, v52
v_sqrt_f32 v52, v52
s_nop 0
v_cvt_pk_bf16_f32 v52, v52, v52
v_lshlrev_b32 v52, 16, v52
v_rcp_f32 v51, v52
v_cvt_pk_bf16_f32 v50, v50, v50
v_lshlrev_b32 v50, 16, v50
v_xor_b32 v50, 0x80000000, v50
v_lshrrev_b32 v57, 16, v50
v_or_b32 v56, v57, v50
s_nop 1
v_mfma_f32_32x32x16_bf16 v[16:31], v[248:251], v[56:59], 0
v_mfma_f32_32x32x16_bf16 v[32:47], v[252:255], v[56:59], 0
s_waitcnt vmcnt(31)
v_mfma_f32_32x32x16_bf16 v[16:31], a[0:3], v[64:67], v[16:31]
v_mfma_f32_32x32x16_bf16 v[32:47], a[128:131], v[64:67], v[32:47]
s_waitcnt vmcnt(30)
v_mfma_f32_32x32x16_bf16 v[16:31], a[4:7], v[68:71], v[16:31]
v_mfma_f32_32x32x16_bf16 v[32:47], a[132:135], v[68:71], v[32:47]
s_waitcnt vmcnt(29)
v_mfma_f32_32x32x16_bf16 v[16:31], a[8:11], v[72:75], v[16:31]
v_mfma_f32_32x32x16_bf16 v[32:47], a[136:139], v[72:75], v[32:47]
s_waitcnt vmcnt(28)
v_mfma_f32_32x32x16_bf16 v[16:31], a[12:15], v[76:79], v[16:31]
v_mfma_f32_32x32x16_bf16 v[32:47], a[140:143], v[76:79], v[32:47]
s_waitcnt vmcnt(27)
v_mfma_f32_32x32x16_bf16 v[16:31], a[16:19], v[80:83], v[16:31]
v_mfma_f32_32x32x16_bf16 v[32:47], a[144:147], v[80:83], v[32:47]
s_waitcnt vmcnt(26)
v_mfma_f32_32x32x16_bf16 v[16:31], a[20:23], v[84:87], v[16:31]
v_mfma_f32_32x32x16_bf16 v[32:47], a[148:151], v[84:87], v[32:47]
s_waitcnt vmcnt(25)
v_mfma_f32_32x32x16_bf16 v[16:31], a[24:27], v[88:91], v[16:31]
v_mfma_f32_32x32x16_bf16 v[32:47], a[152:155], v[88:91], v[32:47]
s_waitcnt vmcnt(24)
v_mfma_f32_32x32x16_bf16 v[16:31], a[28:31], v[92:95], v[16:31]
v_mfma_f32_32x32x16_bf16 v[32:47], a[156:159], v[92:95], v[32:47]
s_waitcnt vmcnt(23)
v_mfma_f32_32x32x16_bf16 v[16:31], a[32:35], v[96:99], v[16:31]
v_mfma_f32_32x32x16_bf16 v[32:47], a[160:163], v[96:99], v[32:47]
s_waitcnt vmcnt(22)
v_mfma_f32_32x32x16_bf16 v[16:31], a[36:39], v[100:103], v[16:31]
v_mfma_f32_32x32x16_bf16 v[32:47], a[164:167], v[100:103], v[32:47]
s_waitcnt vmcnt(21)
v_mfma_f32_32x32x16_bf16 v[16:31], a[40:43], v[104:107], v[16:31]
v_mfma_f32_32x32x16_bf16 v[32:47], a[168:171], v[104:107], v[32:47]
s_waitcnt vmcnt(20)
v_mfma_f32_32x32x16_bf16 v[16:31], a[44:47], v[108:111], v[16:31]
v_mfma_f32_32x32x16_bf16 v[32:47], a[172:175], v[108:111], v[32:47]
s_waitcnt vmcnt(19)
v_mfma_f32_32x32x16_bf16 v[16:31], a[48:51], v[112:115], v[16:31]
v_mfma_f32_32x32x16_bf16 v[32:47], a[176:179], v[112:115], v[32:47]
s_waitcnt vmcnt(18)
v_mfma_f32_32x32x16_bf16 v[16:31], a[52:55], v[116:119], v[16:31]
v_mfma_f32_32x32x16_bf16 v[32:47], a[180:183], v[116:119], v[32:47]
s_waitcnt vmcnt(17)
v_mfma_f32_32x32x16_bf16 v[16:31], a[56:59], v[120:123], v[16:31]
v_mfma_f32_32x32x16_bf16 v[32:47], a[184:187], v[120:123], v[32:47]
s_waitcnt vmcnt(16)
v_mfma_f32_32x32x16_bf16 v[16:31], a[60:63], v[124:127], v[16:31]
v_mfma_f32_32x32x16_bf16 v[32:47], a[188:191], v[124:127], v[32:47]
s_waitcnt vmcnt(15)
v_mfma_f32_32x32x16_bf16 v[16:31], a[64:67], v[128:131], v[16:31]
v_mfma_f32_32x32x16_bf16 v[32:47], a[192:195], v[128:131], v[32:47]
s_waitcnt vmcnt(14)
v_mfma_f32_32x32x16_bf16 v[16:31], a[68:71], v[132:135], v[16:31]
v_mfma_f32_32x32x16_bf16 v[32:47], a[196:199], v[132:135], v[32:47]
s_waitcnt vmcnt(13)
v_mfma_f32_32x32x16_bf16 v[16:31], a[72:75], v[136:139], v[16:31]
v_mfma_f32_32x32x16_bf16 v[32:47], a[200:203], v[136:139], v[32:47]
s_waitcnt vmcnt(12)
v_mfma_f32_32x32x16_bf16 v[16:31], a[76:79], v[140:143], v[16:31]
v_mfma_f32_32x32x16_bf16 v[32:47], a[204:207], v[140:143], v[32:47]
s_waitcnt vmcnt(11)
v_mfma_f32_32x32x16_bf16 v[16:31], a[80:83], v[144:147], v[16:31]
v_mfma_f32_32x32x16_bf16 v[32:47], a[208:211], v[144:147], v[32:47]
s_waitcnt vmcnt(10)
v_mfma_f32_32x32x16_bf16 v[16:31], a[84:87], v[148:151], v[16:31]
v_mfma_f32_32x32x16_bf16 v[32:47], a[212:215], v[148:151], v[32:47]
s_waitcnt vmcnt(9)
v_mfma_f32_32x32x16_bf16 v[16:31], a[88:91], v[152:155], v[16:31]
v_mfma_f32_32x32x16_bf16 v[32:47], a[216:219], v[152:155], v[32:47]
s_waitcnt vmcnt(8)
v_mfma_f32_32x32x16_bf16 v[16:31], a[92:95], v[156:159], v[16:31]
v_mfma_f32_32x32x16_bf16 v[32:47], a[220:223], v[156:159], v[32:47]
s_waitcnt vmcnt(7)
v_mfma_f32_32x32x16_bf16 v[16:31], a[96:99], v[160:163], v[16:31]
v_mfma_f32_32x32x16_bf16 v[32:47], a[224:227], v[160:163], v[32:47]
s_waitcnt vmcnt(6)
v_mfma_f32_32x32x16_bf16 v[16:31], a[100:103], v[164:167], v[16:31]
v_mfma_f32_32x32x16_bf16 v[32:47], a[228:231], v[164:167], v[32:47]
s_waitcnt vmcnt(5)
v_mfma_f32_32x32x16_bf16 v[16:31], a[104:107], v[168:171], v[16:31]
v_mfma_f32_32x32x16_bf16 v[32:47], a[232:235], v[168:171], v[32:47]
s_waitcnt vmcnt(4)
v_mfma_f32_32x32x16_bf16 v[16:31], a[108:111], v[172:175], v[16:31]
v_mfma_f32_32x32x16_bf16 v[32:47], a[236:239], v[172:175], v[32:47]
s_waitcnt vmcnt(3)
v_mfma_f32_32x32x16_bf16 v[16:31], a[112:115], v[176:179], v[16:31]
v_mfma_f32_32x32x16_bf16 v[32:47], a[240:243], v[176:179], v[32:47]
s_waitcnt vmcnt(2)
v_mfma_f32_32x32x16_bf16 v[16:31], a[116:119], v[180:183], v[16:31]
v_mfma_f32_32x32x16_bf16 v[32:47], a[244:247], v[180:183], v[32:47]
s_waitcnt vmcnt(1)
v_mfma_f32_32x32x16_bf16 v[16:31], a[120:123], v[184:187], v[16:31]
v_mfma_f32_32x32x16_bf16 v[32:47], a[248:251], v[184:187], v[32:47]
s_waitcnt vmcnt(0)
v_mfma_f32_32x32x16_bf16 v[16:31], a[124:127], v[188:191], v[16:31]
v_mfma_f32_32x32x16_bf16 v[32:47], a[252:255], v[188:191], v[32:47]
s_add_u32 s32, s32, 0x20000
s_addc_u32 s33, s33, 0
s_add_u32 s38, s38, 0x1000
s_addc_u32 s39, s39, 0
v_add_u32 v3, 0x200, v3
s_add_u32 s41, s41, 1
s_waitcnt lgkmcnt(0)
v_mul_f32 v16, v16, v51
v_mul_f32 v17, v17, v51
v_mul_f32 v18, v18, v51
v_mul_f32 v19, v19, v51
v_mul_f32 v20, v20, v51
v_mul_f32 v21, v21, v51
v_mul_f32 v22, v22, v51
v_mul_f32 v23, v23, v51
v_mul_f32 v24, v24, v51
v_mul_f32 v25, v25, v51
v_mul_f32 v26, v26, v51
v_mul_f32 v27, v27, v51
v_mul_f32 v28, v28, v51
v_mul_f32 v29, v29, v51
v_mul_f32 v30, v30, v51
v_mul_f32 v31, v31, v51
v_cvt_pk_bf16_f32 v208, v16, v17
v_cvt_pk_bf16_f32 v209, v18, v19
v_cvt_pk_bf16_f32 v210, v20, v21
v_cvt_pk_bf16_f32 v211, v22, v23
v_cvt_pk_bf16_f32 v212, v24, v25
v_cvt_pk_bf16_f32 v213, v26, v27
v_cvt_pk_bf16_f32 v214, v28, v29
v_cvt_pk_bf16_f32 v215, v30, v31
global_store_dwordx4 v2, v[208:211], s[34:35] sc1
global_store_dwordx4 v5, v[212:215], s[34:35] sc1
v_mul_f32 v32, v32, v51
v_mul_f32 v33, v33, v51
v_mul_f32 v34, v34, v51
v_mul_f32 v35, v35, v51
v_mul_f32 v36, v36, v51
v_mul_f32 v37, v37, v51
v_mul_f32 v38, v38, v51
v_mul_f32 v39, v39, v51
v_mul_f32 v40, v40, v51
v_mul_f32 v41, v41, v51
v_mul_f32 v42, v42, v51
v_mul_f32 v43, v43, v51
v_mul_f32 v44, v44, v51
v_mul_f32 v45, v45, v51
v_mul_f32 v46, v46, v51
v_mul_f32 v47, v47, v51
v_cvt_pk_bf16_f32 v216, v32, v33
v_cvt_pk_bf16_f32 v217, v34, v35
v_cvt_pk_bf16_f32 v218, v36, v37
v_cvt_pk_bf16_f32 v219, v38, v39
v_cvt_pk_bf16_f32 v220, v40, v41
v_cvt_pk_bf16_f32 v221, v42, v43
v_cvt_pk_bf16_f32 v222, v44, v45
v_cvt_pk_bf16_f32 v223, v46, v47
global_store_dwordx4 v6, v[216:219], s[34:35] sc1
global_store_dwordx4 v7, v[220:223], s[34:35] sc1
s_add_u32 s34, s34, s42
s_addc_u32 s35, s35, 0
s_waitcnt vmcnt(0)
v_mov_b32 v48, s40
v_mov_b32 v49, s41
s_mov_b64 exec, 1
global_store_dword v48, v49, s[4:5] sc1
s_mov_b64 exec, -1
s_cmp_lt_u32 s41, 16
s_cbranch_scc1 L_t4_28
s_branch L_t5
L_t4v:
v_bfe_u32 v2, v1, 4, 1
v_lshlrev_b32 v2, 10, v2
v_lshrrev_b32 v5, 5, v1
v_lshl_add_u32 v2, v5, 8, v2
v_and_b32 v5, 15, v1
v_lshl_add_u32 v2, v5, 4, v2
s_lshl_b32 s16, s47, 14
s_lshl_b32 s17, s48, 13
s_add_u32 s16, s16, s17
s_add_u32 s16, s16, 25169920
s_mov_b32 s42, 0x200000
s_lshl_b32 s17, s9, 19
s_add_u32 s16, s16, s17
s_add_u32 s34, s4, s16
s_addc_u32 s35, s5, 0
s_lshl_b32 s16, s9, 15
s_add_u32 s16, s16, 4198400
s_add_u32 s32, s4, s16
s_addc_u32 s33, s5, 0
s_lshl_b32 s16, s9, 10
s_add_u32 s16, s16, 524288
s_add_u32 s38, s4, s16
s_addc_u32 s39, s5, 0
s_lshl_b32 s40, s47, 10
s_lshl_b32 s16, s46, 8
s_add_u32 s40, s40, s16
s_lshl_b32 s16, s48, 7
s_add_u32 s40, s40, s16
s_lshl_b32 s16, s9, 2
s_add_u32 s40, s40, s16
s_add_u32 s40, s40, 1081344
s_lshl_b32 s16, s9, 7
s_add_u32 s16, s16, 1064960
v_mov_b32 v3, s16
v_and_b32 v4, 31, v1
v_lshlrev_b32 v4, 3, v4
v_add_u32 v8, 0x2000, v0
v_add_u32 v9, 0x4000, v0
v_add_u32 v10, 0x6000, v0
s_lshl_b32 s16, s9, 7
s_add_u32 s16, s16, 32768
v_lshrrev_b32 v11, 1, v4
v_add_u32 v11, s16, v11
v_lshrrev_b32 v12, 5, v1
v_lshl_add_u32 v12, v12, 4, s16
v_mov_b64 v[58:59], 0
s_mov_b32 s41, 0
L_t4_32:
s_mov_b32 s10, 0
s_mov_b64 exec, 1
L_wt_34:
global_load_dwordx4 v[48:51], v3, s[4:5] offset:0 sc1
s_add_u32 s10, s10, 1
s_cmp_gt_u32 s10, 400000
s_cbranch_scc1 L_fail
s_waitcnt vmcnt(0)
v_min3_u32 v48, v48, v49, v50
v_min_u32 v48, v48, v51
v_cmp_gt_u32 vcc, 1, v48
s_cbranch_vccz L_wd_35
s_sleep 1
s_branch L_wt_34
L_wd_35:
s_mov_b64 exec, -1
global_load_dwordx2 v[48:49], v4, s[38:39] offset:0 sc1
global_load_dwordx2 v[50:51], v4, s[38:39] offset:256 sc1
global_load_dwordx2 v[52:53], v4, s[38:39] offset:512 sc1
global_load_dwordx2 v[54:55], v4, s[38:39] offset:768 sc1
global_load_dwordx4 v[64:67], v0, s[32:33] offset:-4096 sc1
global_load_dwordx4 v[68:71], v0, s[32:33] offset:-3072 sc1
global_load_dwordx4 v[72:75], v0, s[32:33] offset:-2048 sc1
global_load_dwordx4 v[76:79], v0, s[32:33] offset:-1024 sc1
global_load_dwordx4 v[80:83], v0, s[32:33] offset:0 sc1
global_load_dwordx4 v[84:87], v0, s[32:33] offset:1024 sc1
global_load_dwordx4 v[88:91], v0, s[32:33] offset:2048 sc1
global_load_dwordx4 v[92:95], v0, s[32:33] offset:3072 sc1
global_load_dwordx4 v[96:99], v8, s[32:33] offset:-4096 sc1
global_load_dwordx4 v[100:103], v8, s[32:33] offset:-3072 sc1
global_load_dwordx4 v[104:107], v8, s[32:33] offset:-2048 sc1
global_load_dwordx4 v[108:111], v8, s[32:33] offset:-1024 sc1
global_load_dwordx4 v[112:115], v8, s[32:33] offset:0 sc1
global_load_dwordx4 v[116:119], v8, s[32:33] offset:1024 sc1
global_load_dwordx4 v[120:123], v8, s[32:33] offset:2048 sc1
global_load_dwordx4 v[124:127], v8, s[32:33] offset:3072 sc1
global_load_dwordx4 v[128:131], v9, s[32:33] offset:-4096 sc1
global_load_dwordx4 v[132:135], v9, s[32:33] offset:-3072 sc1
global_load_dwordx4 v[136:139], v9, s[32:33] offset:-2048 sc1
global_load_dwordx4 v[140:143], v9, s[32:33] offset:-1024 sc1
global_load_dwordx4 v[144:147], v9, s[32:33] offset:0 sc1
global_load_dwordx4 v[148:151], v9, s[32:33] offset:1024 sc1
global_load_dwordx4 v[152:155], v9, s[32:33] offset:2048 sc1
global_load_dwordx4 v[156:159], v9, s[32:33] offset:3072 sc1
global_load_dwordx4 v[160:163], v10, s[32:33] offset:-4096 sc1
global_load_dwordx4 v[164:167], v10, s[32:33] offset:-3072 sc1
global_load_dwordx4 v[168:171], v10, s[32:33] offset:-2048 sc1
global_load_dwordx4 v[172:175], v10, s[32:33] offset:-1024 sc1
global_load_dwordx4 v[176:179], v10, s[32:33] offset:0 sc1
global_load_dwordx4 v[180:183], v10, s[32:33] offset:1024 sc1
global_load_dwordx4 v[184:187], v10, s[32:33] offset:2048 sc1
global_load_dwordx4 v[188:191], v10, s[32:33] offset:3072 sc1
s_waitcnt vmcnt(32)
v_pk_add_f32 v[48:49], v[48:49], v[50:51]
v_pk_add_f32 v[52:53], v[52:53], v[54:55]
v_pk_add_f32 v[48:49], v[48:49], v[52:53]
v_mul_f32 v50, 0x3b000000, v48
v_mul_f32 v52, 0x3b000000, v49
v_fma_f32 v52, -v50, v50, v52
v_max_f32 v52, 0, v52
v_cvt_pk_bf16_f32 v52, v52, v52
v_lshlrev_b32 v52, 16, v52
v_add_f32 v52, 0x3727c5ac, v52
v_cvt_pk_bf16_f32 v52, v52, v52
v_lshlrev_b32 v52, 16, v52
v_sqrt_f32 v52, v52
s_nop 0
v_cvt_pk_bf16_f32 v52, v52, v52
v_lshlrev_b32 v52, 16, v52
v_rcp_f32 v51, v52
v_cvt_pk_bf16_f32 v50, v50, v50
v_lshlrev_b32 v50, 16, v50
v_xor_b32 v50, 0x80000000, v50
v_lshrrev_b32 v57, 16, v50
v_or_b32 v56, v57, v50
ds_write_b32 v11, v51
ds_read_b128 v[192:195], v12 offset:0
ds_read_b128 v[196:199], v12 offset:32
ds_read_b128 v[200:203], v12 offset:64
ds_read_b128 v[204:207], v12 offset:96
v_mfma_f32_32x32x16_bf16 v[16:31], v[56:59], v[248:251], 0
v_mfma_f32_32x32x16_bf16 v[32:47], v[56:59], v[252:255], 0
s_waitcnt vmcnt(31)
v_mfma_f32_32x32x16_bf16 v[16:31], v[64:67], a[0:3], v[16:31]
v_mfma_f32_32x32x16_bf16 v[32:47], v[64:67], a[128:131], v[32:47]
s_waitcnt vmcnt(30)
v_mfma_f32_32x32x16_bf16 v[16:31], v[68:71], a[4:7], v[16:31]
v_mfma_f32_32x32x16_bf16 v[32:47], v[68:71], a[132:135], v[32:47]
s_waitcnt vmcnt(29)
v_mfma_f32_32x32x16_bf16 v[16:31], v[72:75], a[8:11], v[16:31]
v_mfma_f32_32x32x16_bf16 v[32:47], v[72:75], a[136:139], v[32:47]
s_waitcnt vmcnt(28)
v_mfma_f32_32x32x16_bf16 v[16:31], v[76:79], a[12:15], v[16:31]
v_mfma_f32_32x32x16_bf16 v[32:47], v[76:79], a[140:143], v[32:47]
s_waitcnt vmcnt(27)
v_mfma_f32_32x32x16_bf16 v[16:31], v[80:83], a[16:19], v[16:31]
v_mfma_f32_32x32x16_bf16 v[32:47], v[80:83], a[144:147], v[32:47]
s_waitcnt vmcnt(26)
v_mfma_f32_32x32x16_bf16 v[16:31], v[84:87], a[20:23], v[16:31]
v_mfma_f32_32x32x16_bf16 v[32:47], v[84:87], a[148:151], v[32:47]
s_waitcnt vmcnt(25)
v_mfma_f32_32x32x16_bf16 v[16:31], v[88:91], a[24:27], v[16:31]
v_mfma_f32_32x32x16_bf16 v[32:47], v[88:91], a[152:155], v[32:47]
s_waitcnt vmcnt(24)
v_mfma_f32_32x32x16_bf16 v[16:31], v[92:95], a[28:31], v[16:31]
v_mfma_f32_32x32x16_bf16 v[32:47], v[92:95], a[156:159], v[32:47]
s_waitcnt vmcnt(23)
v_mfma_f32_32x32x16_bf16 v[16:31], v[96:99], a[32:35], v[16:31]
v_mfma_f32_32x32x16_bf16 v[32:47], v[96:99], a[160:163], v[32:47]
s_waitcnt vmcnt(22)
v_mfma_f32_32x32x16_bf16 v[16:31], v[100:103], a[36:39], v[16:31]
v_mfma_f32_32x32x16_bf16 v[32:47], v[100:103], a[164:167], v[32:47]
s_waitcnt vmcnt(21)
v_mfma_f32_32x32x16_bf16 v[16:31], v[104:107], a[40:43], v[16:31]
v_mfma_f32_32x32x16_bf16 v[32:47], v[104:107], a[168:171], v[32:47]
s_waitcnt vmcnt(20)
v_mfma_f32_32x32x16_bf16 v[16:31], v[108:111], a[44:47], v[16:31]
v_mfma_f32_32x32x16_bf16 v[32:47], v[108:111], a[172:175], v[32:47]
s_waitcnt vmcnt(19)
v_mfma_f32_32x32x16_bf16 v[16:31], v[112:115], a[48:51], v[16:31]
v_mfma_f32_32x32x16_bf16 v[32:47], v[112:115], a[176:179], v[32:47]
s_waitcnt vmcnt(18)
v_mfma_f32_32x32x16_bf16 v[16:31], v[116:119], a[52:55], v[16:31]
v_mfma_f32_32x32x16_bf16 v[32:47], v[116:119], a[180:183], v[32:47]
s_waitcnt vmcnt(17)
v_mfma_f32_32x32x16_bf16 v[16:31], v[120:123], a[56:59], v[16:31]
v_mfma_f32_32x32x16_bf16 v[32:47], v[120:123], a[184:187], v[32:47]
s_waitcnt vmcnt(16)
v_mfma_f32_32x32x16_bf16 v[16:31], v[124:127], a[60:63], v[16:31]
v_mfma_f32_32x32x16_bf16 v[32:47], v[124:127], a[188:191], v[32:47]
s_waitcnt vmcnt(15)
v_mfma_f32_32x32x16_bf16 v[16:31], v[128:131], a[64:67], v[16:31]
v_mfma_f32_32x32x16_bf16 v[32:47], v[128:131], a[192:195], v[32:47]
s_waitcnt vmcnt(14)
v_mfma_f32_32x32x16_bf16 v[16:31], v[132:135], a[68:71], v[16:31]
v_mfma_f32_32x32x16_bf16 v[32:47], v[132:135], a[196:199], v[32:47]
s_waitcnt vmcnt(13)
v_mfma_f32_32x32x16_bf16 v[16:31], v[136:139], a[72:75], v[16:31]
v_mfma_f32_32x32x16_bf16 v[32:47], v[136:139], a[200:203], v[32:47]
s_waitcnt vmcnt(12)
v_mfma_f32_32x32x16_bf16 v[16:31], v[140:143], a[76:79], v[16:31]
v_mfma_f32_32x32x16_bf16 v[32:47], v[140:143], a[204:207], v[32:47]
s_waitcnt vmcnt(11)
v_mfma_f32_32x32x16_bf16 v[16:31], v[144:147], a[80:83], v[16:31]
v_mfma_f32_32x32x16_bf16 v[32:47], v[144:147], a[208:211], v[32:47]
s_waitcnt vmcnt(10)
v_mfma_f32_32x32x16_bf16 v[16:31], v[148:151], a[84:87], v[16:31]
v_mfma_f32_32x32x16_bf16 v[32:47], v[148:151], a[212:215], v[32:47]
s_waitcnt vmcnt(9)
v_mfma_f32_32x32x16_bf16 v[16:31], v[152:155], a[88:91], v[16:31]
v_mfma_f32_32x32x16_bf16 v[32:47], v[152:155], a[216:219], v[32:47]
s_waitcnt vmcnt(8)
v_mfma_f32_32x32x16_bf16 v[16:31], v[156:159], a[92:95], v[16:31]
v_mfma_f32_32x32x16_bf16 v[32:47], v[156:159], a[220:223], v[32:47]
s_waitcnt vmcnt(7)
v_mfma_f32_32x32x16_bf16 v[16:31], v[160:163], a[96:99], v[16:31]
v_mfma_f32_32x32x16_bf16 v[32:47], v[160:163], a[224:227], v[32:47]
s_waitcnt vmcnt(6)
v_mfma_f32_32x32x16_bf16 v[16:31], v[164:167], a[100:103], v[16:31]
v_mfma_f32_32x32x16_bf16 v[32:47], v[164:167], a[228:231], v[32:47]
s_waitcnt vmcnt(5)
v_mfma_f32_32x32x16_bf16 v[16:31], v[168:171], a[104:107], v[16:31]
v_mfma_f32_32x32x16_bf16 v[32:47], v[168:171], a[232:235], v[32:47]
s_waitcnt vmcnt(4)
v_mfma_f32_32x32x16_bf16 v[16:31], v[172:175], a[108:111], v[16:31]
v_mfma_f32_32x32x16_bf16 v[32:47], v[172:175], a[236:239], v[32:47]
s_waitcnt vmcnt(3)
v_mfma_f32_32x32x16_bf16 v[16:31], v[176:179], a[112:115], v[16:31]
v_mfma_f32_32x32x16_bf16 v[32:47], v[176:179], a[240:243], v[32:47]
s_waitcnt vmcnt(2)
v_mfma_f32_32x32x16_bf16 v[16:31], v[180:183], a[116:119], v[16:31]
v_mfma_f32_32x32x16_bf16 v[32:47], v[180:183], a[244:247], v[32:47]
s_waitcnt vmcnt(1)
v_mfma_f32_32x32x16_bf16 v[16:31], v[184:187], a[120:123], v[16:31]
v_mfma_f32_32x32x16_bf16 v[32:47], v[184:187], a[248:251], v[32:47]
s_waitcnt vmcnt(0)
v_mfma_f32_32x32x16_bf16 v[16:31], v[188:191], a[124:127], v[16:31]
v_mfma_f32_32x32x16_bf16 v[32:47], v[188:191], a[252:255], v[32:47]
s_add_u32 s32, s32, 0x20000
s_addc_u32 s33, s33, 0
s_add_u32 s38, s38, 0x1000
s_addc_u32 s39, s39, 0
v_add_u32 v3, 0x200, v3
s_add_u32 s41, s41, 1
s_waitcnt lgkmcnt(0)
v_mul_f32 v16, v16, v192
v_mul_f32 v17, v17, v193
v_mul_f32 v18, v18, v194
v_mul_f32 v19, v19, v195
v_mul_f32 v20, v20, v196
v_mul_f32 v21, v21, v197
v_mul_f32 v22, v22, v198
v_mul_f32 v23, v23, v199
v_mul_f32 v24, v24, v200
v_mul_f32 v25, v25, v201
v_mul_f32 v26, v26, v202
v_mul_f32 v27, v27, v203
v_mul_f32 v28, v28, v204
v_mul_f32 v29, v29, v205
v_mul_f32 v30, v30, v206
v_mul_f32 v31, v31, v207
v_cvt_pk_bf16_f32 v208, v16, v17
v_cvt_pk_bf16_f32 v209, v18, v19
v_cvt_pk_bf16_f32 v210, v20, v21
v_cvt_pk_bf16_f32 v211, v22, v23
v_cvt_pk_bf16_f32 v212, v24, v25
v_cvt_pk_bf16_f32 v213, v26, v27
v_cvt_pk_bf16_f32 v214, v28, v29
v_cvt_pk_bf16_f32 v215, v30, v31
global_store_dwordx4 v2, v[208:211], s[34:35] offset:-2048 sc1
global_store_dwordx4 v2, v[212:215], s[34:35] offset:-1536 sc1
v_mul_f32 v32, v32, v192
v_mul_f32 v33, v33, v193
v_mul_f32 v34, v34, v194
v_mul_f32 v35, v35, v195
v_mul_f32 v36, v36, v196
v_mul_f32 v37, v37, v197
v_mul_f32 v38, v38, v198
v_mul_f32 v39, v39, v199
v_mul_f32 v40, v40, v200
v_mul_f32 v41, v41, v201
v_mul_f32 v42, v42, v202
v_mul_f32 v43, v43, v203
v_mul_f32 v44, v44, v204
v_mul_f32 v45, v45, v205
v_mul_f32 v46, v46, v206
v_mul_f32 v47, v47, v207
v_cvt_pk_bf16_f32 v216, v32, v33
v_cvt_pk_bf16_f32 v217, v34, v35
v_cvt_pk_bf16_f32 v218, v36, v37
v_cvt_pk_bf16_f32 v219, v38, v39
v_cvt_pk_bf16_f32 v220, v40, v41
v_cvt_pk_bf16_f32 v221, v42, v43
v_cvt_pk_bf16_f32 v222, v44, v45
v_cvt_pk_bf16_f32 v223, v46, v47
global_store_dwordx4 v2, v[216:219], s[34:35] offset:2048 sc1
global_store_dwordx4 v2, v[220:223], s[34:35] offset:2560 sc1
s_add_u32 s34, s34, s42
s_addc_u32 s35, s35, 0
s_waitcnt vmcnt(0)
v_mov_b32 v48, s40
v_mov_b32 v49, s41
s_mov_b64 exec, 1
global_store_dword v48, v49, s[4:5] sc1
s_mov_b64 exec, -1
s_cmp_lt_u32 s41, 16
s_cbranch_scc1 L_t4_32
L_t5:
s_barrier
s_cmp_ge_u32 s8, 208
s_cbranch_scc1 L_nl
s_cmp_eq_u32 s15, 1
s_cbranch_scc1 L_sbd_37
s_mov_b32 s10, 0
v_mov_b32 v2, 0
L_sb_36:
global_load_dword v3, v2, s[6:7] offset:128 sc1
s_add_u32 s10, s10, 1
s_cmp_gt_u32 s10, 400000
s_cbranch_scc1 L_fail
s_waitcnt vmcnt(0)
v_cmp_ne_u32 vcc, 0x100, v3
s_cbranch_vccnz L_sb_36
s_mov_b32 s15, 1
L_sbd_37:
s_load_dwordx2 s[36:37], s[0:1], 64
v_lshrrev_b32 v2, 3, v1
s_lshl_b32 s16, s51, 9
v_add_u32 v2, s16, v2
v_lshlrev_b32 v2, 10, v2
v_and_b32 v3, 7, v1
v_lshl_add_u32 v2, v3, 4, v2
s_lshl_b32 s16, s52, 9
s_lshl_b32 s17, s9, 7
s_add_u32 s16, s16, s17
v_add_u32 v2, s16, v2
s_lshl_b32 s16, s9, 14
s_add_u32 s16, s16, 65536
v_lshrrev_b32 v4, 5, v1
v_lshlrev_b32 v4, 2, v4
v_bfe_u32 v5, v1, 2, 2
v_add_u32 v4, v4, v5
v_lshlrev_b32 v4, 7, v4
v_bfe_u32 v5, v1, 4, 1
v_lshl_add_u32 v4, v5, 5, v4
v_and_b32 v5, 1, v1
v_lshl_add_u32 v4, v5, 4, v4
v_bfe_u32 v5, v1, 1, 1
v_lshl_add_u32 v4, v5, 3, v4
v_add_u32 v4, s16, v4
s_waitcnt lgkmcnt(0)
s_add_u32 m0, s16, 0
s_nop 0
global_load_lds_dwordx4 v2, s[36:37]
s_add_u32 m0, s16, 1024
v_add_u32 v2, 0x2000, v2
global_load_lds_dwordx4 v2, s[36:37]
s_add_u32 m0, s16, 2048
v_add_u32 v2, 0x2000, v2
global_load_lds_dwordx4 v2, s[36:37]
s_add_u32 m0, s16, 3072
v_add_u32 v2, 0x2000, v2
global_load_lds_dwordx4 v2, s[36:37]
s_add_u32 m0, s16, 4096
v_add_u32 v2, 0x2000, v2
global_load_lds_dwordx4 v2, s[36:37]
s_add_u32 m0, s16, 5120
v_add_u32 v2, 0x2000, v2
global_load_lds_dwordx4 v2, s[36:37]
s_add_u32 m0, s16, 6144
v_add_u32 v2, 0x2000, v2
global_load_lds_dwordx4 v2, s[36:37]
s_add_u32 m0, s16, 7168
v_add_u32 v2, 0x2000, v2
global_load_lds_dwordx4 v2, s[36:37]
s_add_u32 m0, s16, 8192
v_add_u32 v2, 0x2000, v2
global_load_lds_dwordx4 v2, s[36:37]
s_add_u32 m0, s16, 9216
v_add_u32 v2, 0x2000, v2
global_load_lds_dwordx4 v2, s[36:37]
s_add_u32 m0, s16, 10240
v_add_u32 v2, 0x2000, v2
global_load_lds_dwordx4 v2, s[36:37]
s_add_u32 m0, s16, 11264
v_add_u32 v2, 0x2000, v2
global_load_lds_dwordx4 v2, s[36:37]
s_add_u32 m0, s16, 12288
v_add_u32 v2, 0x2000, v2
global_load_lds_dwordx4 v2, s[36:37]
s_add_u32 m0, s16, 13312
v_add_u32 v2, 0x2000, v2
global_load_lds_dwordx4 v2, s[36:37]
s_add_u32 m0, s16, 14336
v_add_u32 v2, 0x2000, v2
global_load_lds_dwordx4 v2, s[36:37]
s_add_u32 m0, s16, 15360
v_add_u32 v2, 0x2000, v2
global_load_lds_dwordx4 v2, s[36:37]
s_waitcnt vmcnt(12)
ds_read_b64_tr_b16 a[0:1], v4 offset:0
ds_read_b64_tr_b16 a[2:3], v4 offset:1024
ds_read_b64_tr_b16 a[128:129], v4 offset:64
ds_read_b64_tr_b16 a[130:131], v4 offset:1088
ds_read_b64_tr_b16 a[4:5], v4 offset:2048
ds_read_b64_tr_b16 a[6:7], v4 offset:3072
ds_read_b64_tr_b16 a[132:133], v4 offset:2112
ds_read_b64_tr_b16 a[134:135], v4 offset:3136
s_waitcnt lgkmcnt(0)
s_add_u32 m0, s16, 0
v_add_u32 v2, 0x2000, v2
global_load_lds_dwordx4 v2, s[36:37]
s_add_u32 m0, s16, 1024
v_add_u32 v2, 0x2000, v2
global_load_lds_dwordx4 v2, s[36:37]
s_add_u32 m0, s16, 2048
v_add_u32 v2, 0x2000, v2
global_load_lds_dwordx4 v2, s[36:37]
s_add_u32 m0, s16, 3072
v_add_u32 v2, 0x2000, v2
global_load_lds_dwordx4 v2, s[36:37]
s_waitcnt vmcnt(12)
ds_read_b64_tr_b16 a[8:9], v4 offset:4096
ds_read_b64_tr_b16 a[10:11], v4 offset:5120
ds_read_b64_tr_b16 a[136:137], v4 offset:4160
ds_read_b64_tr_b16 a[138:139], v4 offset:5184
ds_read_b64_tr_b16 a[12:13], v4 offset:6144
ds_read_b64_tr_b16 a[14:15], v4 offset:7168
ds_read_b64_tr_b16 a[140:141], v4 offset:6208
ds_read_b64_tr_b16 a[142:143], v4 offset:7232
s_waitcnt lgkmcnt(0)
s_add_u32 m0, s16, 4096
v_add_u32 v2, 0x2000, v2
global_load_lds_dwordx4 v2, s[36:37]
s_add_u32 m0, s16, 5120
v_add_u32 v2, 0x2000, v2
global_load_lds_dwordx4 v2, s[36:37]
s_add_u32 m0, s16, 6144
v_add_u32 v2, 0x2000, v2
global_load_lds_dwordx4 v2, s[36:37]
s_add_u32 m0, s16, 7168
v_add_u32 v2, 0x2000, v2
global_load_lds_dwordx4 v2, s[36:37]
s_waitcnt vmcnt(12)
ds_read_b64_tr_b16 a[16:17], v4 offset:8192
ds_read_b64_tr_b16 a[18:19], v4 offset:9216
ds_read_b64_tr_b16 a[144:145], v4 offset:8256
ds_read_b64_tr_b16 a[146:147], v4 offset:9280
ds_read_b64_tr_b16 a[20:21], v4 offset:10240
ds_read_b64_tr_b16 a[22:23], v4 offset:11264
ds_read_b64_tr_b16 a[148:149], v4 offset:10304
ds_read_b64_tr_b16 a[150:151], v4 offset:11328
s_waitcnt lgkmcnt(0)
s_add_u32 m0, s16, 8192
v_add_u32 v2, 0x2000, v2
global_load_lds_dwordx4 v2, s[36:37]
s_add_u32 m0, s16, 9216
v_add_u32 v2, 0x2000, v2
global_load_lds_dwordx4 v2, s[36:37]
s_add_u32 m0, s16, 10240
v_add_u32 v2, 0x2000, v2
global_load_lds_dwordx4 v2, s[36:37]
s_add_u32 m0, s16, 11264
v_add_u32 v2, 0x2000, v2
global_load_lds_dwordx4 v2, s[36:37]
s_waitcnt vmcnt(12)
ds_read_b64_tr_b16 a[24:25], v4 offset:12288
ds_read_b64_tr_b16 a[26:27], v4 offset:13312
ds_read_b64_tr_b16 a[152:153], v4 offset:12352
ds_read_b64_tr_b16 a[154:155], v4 offset:13376
ds_read_b64_tr_b16 a[28:29], v4 offset:14336
ds_read_b64_tr_b16 a[30:31], v4 offset:15360
ds_read_b64_tr_b16 a[156:157], v4 offset:14400
ds_read_b64_tr_b16 a[158:159], v4 offset:15424
s_waitcnt lgkmcnt(0)
s_add_u32 m0, s16, 12288
v_add_u32 v2, 0x2000, v2
global_load_lds_dwordx4 v2, s[36:37]
s_add_u32 m0, s16, 13312
v_add_u32 v2, 0x2000, v2
global_load_lds_dwordx4 v2, s[36:37]
s_add_u32 m0, s16, 14336
v_add_u32 v2, 0x2000, v2
global_load_lds_dwordx4 v2, s[36:37]
s_add_u32 m0, s16, 15360
v_add_u32 v2, 0x2000, v2
global_load_lds_dwordx4 v2, s[36:37]
s_waitcnt vmcnt(12)
ds_read_b64_tr_b16 a[32:33], v4 offset:0
ds_read_b64_tr_b16 a[34:35], v4 offset:1024
ds_read_b64_tr_b16 a[160:161], v4 offset:64
ds_read_b64_tr_b16 a[162:163], v4 offset:1088
ds_read_b64_tr_b16 a[36:37], v4 offset:2048
ds_read_b64_tr_b16 a[38:39], v4 offset:3072
ds_read_b64_tr_b16 a[164:165], v4 offset:2112
ds_read_b64_tr_b16 a[166:167], v4 offset:3136
s_waitcnt lgkmcnt(0)
s_add_u32 m0, s16, 0
v_add_u32 v2, 0x2000, v2
global_load_lds_dwordx4 v2, s[36:37]
s_add_u32 m0, s16, 1024
v_add_u32 v2, 0x2000, v2
global_load_lds_dwordx4 v2, s[36:37]
s_add_u32 m0, s16, 2048
v_add_u32 v2, 0x2000, v2
global_load_lds_dwordx4 v2, s[36:37]
s_add_u32 m0, s16, 3072
v_add_u32 v2, 0x2000, v2
global_load_lds_dwordx4 v2, s[36:37]
s_waitcnt vmcnt(12)
ds_read_b64_tr_b16 a[40:41], v4 offset:4096
ds_read_b64_tr_b16 a[42:43], v4 offset:5120
ds_read_b64_tr_b16 a[168:169], v4 offset:4160
ds_read_b64_tr_b16 a[170:171], v4 offset:5184
ds_read_b64_tr_b16 a[44:45], v4 offset:6144
ds_read_b64_tr_b16 a[46:47], v4 offset:7168
ds_read_b64_tr_b16 a[172:173], v4 offset:6208
ds_read_b64_tr_b16 a[174:175], v4 offset:7232
s_waitcnt lgkmcnt(0)
s_add_u32 m0, s16, 4096
v_add_u32 v2, 0x2000, v2
global_load_lds_dwordx4 v2, s[36:37]
s_add_u32 m0, s16, 5120
v_add_u32 v2, 0x2000, v2
global_load_lds_dwordx4 v2, s[36:37]
s_add_u32 m0, s16, 6144
v_add_u32 v2, 0x2000, v2
global_load_lds_dwordx4 v2, s[36:37]
s_add_u32 m0, s16, 7168
v_add_u32 v2, 0x2000, v2
global_load_lds_dwordx4 v2, s[36:37]
s_waitcnt vmcnt(12)
ds_read_b64_tr_b16 a[48:49], v4 offset:8192
ds_read_b64_tr_b16 a[50:51], v4 offset:9216
ds_read_b64_tr_b16 a[176:177], v4 offset:8256
ds_read_b64_tr_b16 a[178:179], v4 offset:9280
ds_read_b64_tr_b16 a[52:53], v4 offset:10240
ds_read_b64_tr_b16 a[54:55], v4 offset:11264
ds_read_b64_tr_b16 a[180:181], v4 offset:10304
ds_read_b64_tr_b16 a[182:183], v4 offset:11328
s_waitcnt lgkmcnt(0)
s_add_u32 m0, s16, 8192
v_add_u32 v2, 0x2000, v2
global_load_lds_dwordx4 v2, s[36:37]
s_add_u32 m0, s16, 9216
v_add_u32 v2, 0x2000, v2
global_load_lds_dwordx4 v2, s[36:37]
s_add_u32 m0, s16, 10240
v_add_u32 v2, 0x2000, v2
global_load_lds_dwordx4 v2, s[36:37]
s_add_u32 m0, s16, 11264
v_add_u32 v2, 0x2000, v2
global_load_lds_dwordx4 v2, s[36:37]
s_waitcnt vmcnt(12)
ds_read_b64_tr_b16 a[56:57], v4 offset:12288
ds_read_b64_tr_b16 a[58:59], v4 offset:13312
ds_read_b64_tr_b16 a[184:185], v4 offset:12352
ds_read_b64_tr_b16 a[186:187], v4 offset:13376
ds_read_b64_tr_b16 a[60:61], v4 offset:14336
ds_read_b64_tr_b16 a[62:63], v4 offset:15360
ds_read_b64_tr_b16 a[188:189], v4 offset:14400
ds_read_b64_tr_b16 a[190:191], v4 offset:15424
s_waitcnt lgkmcnt(0)
s_add_u32 m0, s16, 12288
v_add_u32 v2, 0x2000, v2
global_load_lds_dwordx4 v2, s[36:37]
s_add_u32 m0, s16, 13312
v_add_u32 v2, 0x2000, v2
global_load_lds_dwordx4 v2, s[36:37]
s_add_u32 m0, s16, 14336
v_add_u32 v2, 0x2000, v2
global_load_lds_dwordx4 v2, s[36:37]
s_add_u32 m0, s16, 15360
v_add_u32 v2, 0x2000, v2
global_load_lds_dwordx4 v2, s[36:37]
s_waitcnt vmcnt(12)
ds_read_b64_tr_b16 a[64:65], v4 offset:0
ds_read_b64_tr_b16 a[66:67], v4 offset:1024
ds_read_b64_tr_b16 a[192:193], v4 offset:64
ds_read_b64_tr_b16 a[194:195], v4 offset:1088
ds_read_b64_tr_b16 a[68:69], v4 offset:2048
ds_read_b64_tr_b16 a[70:71], v4 offset:3072
ds_read_b64_tr_b16 a[196:197], v4 offset:2112
ds_read_b64_tr_b16 a[198:199], v4 offset:3136
s_waitcnt lgkmcnt(0)
s_add_u32 m0, s16, 0
v_add_u32 v2, 0x2000, v2
global_load_lds_dwordx4 v2, s[36:37]
s_add_u32 m0, s16, 1024
v_add_u32 v2, 0x2000, v2
global_load_lds_dwordx4 v2, s[36:37]
s_add_u32 m0, s16, 2048
v_add_u32 v2, 0x2000, v2
global_load_lds_dwordx4 v2, s[36:37]
s_add_u32 m0, s16, 3072
v_add_u32 v2, 0x2000, v2
global_load_lds_dwordx4 v2, s[36:37]
s_waitcnt vmcnt(12)
ds_read_b64_tr_b16 a[72:73], v4 offset:4096
ds_read_b64_tr_b16 a[74:75], v4 offset:5120
ds_read_b64_tr_b16 a[200:201], v4 offset:4160
ds_read_b64_tr_b16 a[202:203], v4 offset:5184
ds_read_b64_tr_b16 a[76:77], v4 offset:6144
ds_read_b64_tr_b16 a[78:79], v4 offset:7168
ds_read_b64_tr_b16 a[204:205], v4 offset:6208
ds_read_b64_tr_b16 a[206:207], v4 offset:7232
s_waitcnt lgkmcnt(0)
s_add_u32 m0, s16, 4096
v_add_u32 v2, 0x2000, v2
global_load_lds_dwordx4 v2, s[36:37]
s_add_u32 m0, s16, 5120
v_add_u32 v2, 0x2000, v2
global_load_lds_dwordx4 v2, s[36:37]
s_add_u32 m0, s16, 6144
v_add_u32 v2, 0x2000, v2
global_load_lds_dwordx4 v2, s[36:37]
s_add_u32 m0, s16, 7168
v_add_u32 v2, 0x2000, v2
global_load_lds_dwordx4 v2, s[36:37]
s_waitcnt vmcnt(12)
ds_read_b64_tr_b16 a[80:81], v4 offset:8192
ds_read_b64_tr_b16 a[82:83], v4 offset:9216
ds_read_b64_tr_b16 a[208:209], v4 offset:8256
ds_read_b64_tr_b16 a[210:211], v4 offset:9280
ds_read_b64_tr_b16 a[84:85], v4 offset:10240
ds_read_b64_tr_b16 a[86:87], v4 offset:11264
ds_read_b64_tr_b16 a[212:213], v4 offset:10304
ds_read_b64_tr_b16 a[214:215], v4 offset:11328
s_waitcnt lgkmcnt(0)
s_add_u32 m0, s16, 8192
v_add_u32 v2, 0x2000, v2
global_load_lds_dwordx4 v2, s[36:37]
s_add_u32 m0, s16, 9216
v_add_u32 v2, 0x2000, v2
global_load_lds_dwordx4 v2, s[36:37]
s_add_u32 m0, s16, 10240
v_add_u32 v2, 0x2000, v2
global_load_lds_dwordx4 v2, s[36:37]
s_add_u32 m0, s16, 11264
v_add_u32 v2, 0x2000, v2
global_load_lds_dwordx4 v2, s[36:37]
s_waitcnt vmcnt(12)
ds_read_b64_tr_b16 a[88:89], v4 offset:12288
ds_read_b64_tr_b16 a[90:91], v4 offset:13312
ds_read_b64_tr_b16 a[216:217], v4 offset:12352
ds_read_b64_tr_b16 a[218:219], v4 offset:13376
ds_read_b64_tr_b16 a[92:93], v4 offset:14336
ds_read_b64_tr_b16 a[94:95], v4 offset:15360
ds_read_b64_tr_b16 a[220:221], v4 offset:14400
ds_read_b64_tr_b16 a[222:223], v4 offset:15424
s_waitcnt lgkmcnt(0)
s_add_u32 m0, s16, 12288
v_add_u32 v2, 0x2000, v2
global_load_lds_dwordx4 v2, s[36:37]
s_add_u32 m0, s16, 13312
v_add_u32 v2, 0x2000, v2
global_load_lds_dwordx4 v2, s[36:37]
s_add_u32 m0, s16, 14336
v_add_u32 v2, 0x2000, v2
global_load_lds_dwordx4 v2, s[36:37]
s_add_u32 m0, s16, 15360
v_add_u32 v2, 0x2000, v2
global_load_lds_dwordx4 v2, s[36:37]
s_waitcnt vmcnt(12)
ds_read_b64_tr_b16 a[96:97], v4 offset:0
ds_read_b64_tr_b16 a[98:99], v4 offset:1024
ds_read_b64_tr_b16 a[224:225], v4 offset:64
ds_read_b64_tr_b16 a[226:227], v4 offset:1088
ds_read_b64_tr_b16 a[100:101], v4 offset:2048
ds_read_b64_tr_b16 a[102:103], v4 offset:3072
ds_read_b64_tr_b16 a[228:229], v4 offset:2112
ds_read_b64_tr_b16 a[230:231], v4 offset:3136
s_waitcnt lgkmcnt(0)
s_waitcnt vmcnt(8)
ds_read_b64_tr_b16 a[104:105], v4 offset:4096
ds_read_b64_tr_b16 a[106:107], v4 offset:5120
ds_read_b64_tr_b16 a[232:233], v4 offset:4160
ds_read_b64_tr_b16 a[234:235], v4 offset:5184
ds_read_b64_tr_b16 a[108:109], v4 offset:6144
ds_read_b64_tr_b16 a[110:111], v4 offset:7168
ds_read_b64_tr_b16 a[236:237], v4 offset:6208
ds_read_b64_tr_b16 a[238:239], v4 offset:7232
s_waitcnt lgkmcnt(0)
s_waitcnt vmcnt(4)
ds_read_b64_tr_b16 a[112:113], v4 offset:8192
ds_read_b64_tr_b16 a[114:115], v4 offset:9216
ds_read_b64_tr_b16 a[240:241], v4 offset:8256
ds_read_b64_tr_b16 a[242:243], v4 offset:9280
ds_read_b64_tr_b16 a[116:117], v4 offset:10240
ds_read_b64_tr_b16 a[118:119], v4 offset:11264
ds_read_b64_tr_b16 a[244:245], v4 offset:10304
ds_read_b64_tr_b16 a[246:247], v4 offset:11328
s_waitcnt lgkmcnt(0)
s_waitcnt vmcnt(0)
ds_read_b64_tr_b16 a[120:121], v4 offset:12288
ds_read_b64_tr_b16 a[122:123], v4 offset:13312
ds_read_b64_tr_b16 a[248:249], v4 offset:12352
ds_read_b64_tr_b16 a[250:251], v4 offset:13376
ds_read_b64_tr_b16 a[124:125], v4 offset:14336
ds_read_b64_tr_b16 a[126:127], v4 offset:15360
ds_read_b64_tr_b16 a[252:253], v4 offset:14400
ds_read_b64_tr_b16 a[254:255], v4 offset:15424
s_waitcnt lgkmcnt(0)
v_and_b32 v2, 31, v1
v_lshrrev_b32 v3, 5, v1
v_lshlrev_b32 v3, 2, v3
v_sub_u32 v2, v2, v3
v_mov_b32 v3, 0xff800000
v_cmp_gt_i32 vcc, 0, v2
s_nop 1
v_cndmask_b32 v240, 0, v3, vcc
v_cmp_gt_i32 vcc, 1, v2
s_nop 1
v_cndmask_b32 v241, 0, v3, vcc
v_cmp_gt_i32 vcc, 2, v2
s_nop 1
v_cndmask_b32 v242, 0, v3, vcc
v_cmp_gt_i32 vcc, 3, v2
s_nop 1
v_cndmask_b32 v243, 0, v3, vcc
v_cmp_gt_i32 vcc, 8, v2
s_nop 1
v_cndmask_b32 v244, 0, v3, vcc
v_cmp_gt_i32 vcc, 9, v2
s_nop 1
v_cndmask_b32 v245, 0, v3, vcc
v_cmp_gt_i32 vcc, 10, v2
s_nop 1
v_cndmask_b32 v246, 0, v3, vcc
v_cmp_gt_i32 vcc, 11, v2
s_nop 1
v_cndmask_b32 v247, 0, v3, vcc
v_cmp_gt_i32 vcc, 16, v2
s_nop 1
v_cndmask_b32 v248, 0, v3, vcc
v_cmp_gt_i32 vcc, 17, v2
s_nop 1
v_cndmask_b32 v249, 0, v3, vcc
v_cmp_gt_i32 vcc, 18, v2
s_nop 1
v_cndmask_b32 v250, 0, v3, vcc
v_cmp_gt_i32 vcc, 19, v2
s_nop 1
v_cndmask_b32 v251, 0, v3, vcc
v_cmp_gt_i32 vcc, 24, v2
s_nop 1
v_cndmask_b32 v252, 0, v3, vcc
v_cmp_gt_i32 vcc, 25, v2
s_nop 1
v_cndmask_b32 v253, 0, v3, vcc
v_cmp_gt_i32 vcc, 26, v2
s_nop 1
v_cndmask_b32 v254, 0, v3, vcc
v_cmp_gt_i32 vcc, 27, v2
s_nop 1
v_cndmask_b32 v255, 0, v3, vcc
s_mov_b32 s54, 0x3e0293ee
s_sub_u32 s14, s50, 1
s_cmp_eq_u32 s50, 0
s_cselect_b32 s14, 12, s14
L_t5_38:
v_bfe_u32 v2, v1, 4, 1
v_lshlrev_b32 v2, 13, v2
v_bfe_u32 v6, v1, 2, 1
v_lshl_add_u32 v2, v6, 12, v2
v_lshrrev_b32 v6, 5, v1
v_lshl_add_u32 v2, v6, 8, v2
v_lshlrev_b32 v3, 8, v6
v_bfe_u32 v6, v1, 3, 1
v_lshl_add_u32 v2, v6, 6, v2
v_and_b32 v6, 3, v1
v_lshl_add_u32 v2, v6, 4, v2
v_bfe_u32 v6, v1, 4, 1
v_lshl_add_u32 v3, v6, 10, v3
v_and_b32 v6, 15, v1
v_lshl_add_u32 v3, v6, 4, v3
v_add_u32 v3, 0x1000, v3
s_lshl_b32 s16, s51, 2
s_add_u32 s16, s16, s9
s_lshl_b32 s17, s14, 5
s_add_u32 s17, s17, s16
s_lshl_b32 s18, s17, 13
s_add_u32 s18, s18, 58724352
s_add_u32 s32, s4, s18
s_addc_u32 s33, s5, 0
s_lshl_b32 s18, s17, 14
s_add_u32 s18, s18, 25165824
s_add_u32 s34, s4, s18
s_addc_u32 s35, s5, 0
s_lshl_b32 s18, s17, 12
s_add_u32 s18, s18, 12582912
s_add_u32 s36, s4, s18
s_addc_u32 s37, s5, 0
s_lshl_b32 s16, s16, 10
s_add_u32 s16, s16, 1081344
s_and_b32 s17, s14, 3
s_lshl_b32 s17, s17, 2
s_add_u32 s17, s17, s16
v_lshlrev_b32 v4, 7, v1
v_add_u32 v4, s17, v4
s_lshr_b32 s18, s14, 2
s_add_u32 s18, s18, 1
s_mov_b32 s10, 0
s_mov_b64 exec, 63
L_wt_40:
global_load_dword v6, v4, s[4:5] offset:0 sc1
s_add_u32 s10, s10, 1
s_cmp_gt_u32 s10, 400000
s_cbranch_scc1 L_fail
s_waitcnt vmcnt(0)
v_cmp_gt_u32 vcc, s18, v6
s_cbranch_vccz L_wd_41
s_sleep 4
s_branch L_wt_40
L_wd_41:
s_mov_b64 exec, -1
global_load_dwordx4 v[16:19], v0, s[32:33] offset:-4096 sc1
global_load_dwordx4 v[20:23], v0, s[32:33] offset:-3072 sc1
global_load_dwordx4 v[24:27], v0, s[32:33] offset:-2048 sc1
global_load_dwordx4 v[28:31], v0, s[32:33] offset:-1024 sc1
global_load_dwordx4 v[32:35], v0, s[32:33] offset:0 sc1
global_load_dwordx4 v[36:39], v0, s[32:33] offset:1024 sc1
global_load_dwordx4 v[40:43], v0, s[32:33] offset:2048 sc1
global_load_dwordx4 v[44:47], v0, s[32:33] offset:3072 sc1
global_load_dwordx4 v[48:51], v2, s[34:35] offset:0 sc1
global_load_dwordx4 v[52:55], v2, s[34:35] offset:128 sc1
global_load_dwordx4 v[56:59], v2, s[34:35] offset:512 sc1
global_load_dwordx4 v[60:63], v2, s[34:35] offset:640 sc1
global_load_dwordx4 v[64:67], v2, s[34:35] offset:1024 sc1
global_load_dwordx4 v[68:71], v2, s[34:35] offset:1152 sc1
global_load_dwordx4 v[72:75], v2, s[34:35] offset:1536 sc1
global_load_dwordx4 v[76:79], v2, s[34:35] offset:1664 sc1
global_load_dwordx4 v[80:83], v3, s[34:35] offset:-2048 sc1
global_load_dwordx4 v[84:87], v3, s[34:35] offset:-1536 sc1
global_load_dwordx4 v[88:91], v3, s[34:35] offset:2048 sc1
global_load_dwordx4 v[92:95], v3, s[34:35] offset:2560 sc1
v_add_u32 v3, 0x2000, v3
global_load_dwordx4 v[96:99], v3, s[34:35] offset:-2048 sc1
global_load_dwordx4 v[100:103], v3, s[34:35] offset:-1536 sc1
global_load_dwordx4 v[104:107], v3, s[34:35] offset:2048 sc1
global_load_dwordx4 v[108:111], v3, s[34:35] offset:2560 sc1
s_waitcnt vmcnt(8)
v_mfma_f32_32x32x16_bf16 v[128:143], v[48:51], v[16:19], v[240:255]
v_mfma_f32_32x32x16_bf16 v[128:143], v[52:55], v[20:23], v[128:143]
v_mfma_f32_32x32x16_bf16 v[128:143], v[56:59], v[24:27], v[128:143]
v_mfma_f32_32x32x16_bf16 v[128:143], v[60:63], v[28:31], v[128:143]
v_mfma_f32_32x32x16_bf16 v[128:143], v[64:67], v[32:35], v[128:143]
v_mfma_f32_32x32x16_bf16 v[128:143], v[68:71], v[36:39], v[128:143]
v_mfma_f32_32x32x16_bf16 v[128:143], v[72:75], v[40:43], v[128:143]
v_mfma_f32_32x32x16_bf16 v[128:143], v[76:79], v[44:47], v[128:143]
v_mov_b32 v4, s16
s_add_u32 s18, s14, 1
s_lshl_b32 s19, s9, 12
s_add_u32 s19, s19, 32768
v_and_b32 v2, 3, v1
v_lshlrev_b32 v2, 6, v2
v_lshrrev_b32 v6, 5, v1
v_lshl_add_u32 v2, v6, 5, v2
v_lshlrev_b32 v7, 6, v6
v_bfe_u32 v6, v1, 2, 2
v_lshl_add_u32 v2, v6, 3, v2
v_add_u32 v2, s19, v2
v_bfe_u32 v6, v1, 3, 1
v_lshl_add_u32 v7, v6, 8, v7
v_and_b32 v6, 7, v1
v_lshl_add_u32 v7, v6, 3, v7
v_bfe_u32 v6, v1, 4, 1
v_lshl_add_u32 v7, v6, 2, v7
v_add_u32 v7, s19, v7
v_add_u32 v7, 0x800, v7
s_mov_b32 s10, 0
s_mov_b64 exec, 1
L_wt_42:
global_load_dwordx4 v[8:11], v4, s[4:5] offset:768 sc1
s_add_u32 s10, s10, 1
s_cmp_gt_u32 s10, 400000
s_cbranch_scc1 L_fail
s_waitcnt vmcnt(0)
v_min3_u32 v8, v8, v9, v10
v_min_u32 v8, v8, v11
v_cmp_gt_u32 vcc, s18, v8
s_cbranch_vccz L_wd_43
s_sleep 1
s_branch L_wt_42
L_wd_43:
s_mov_b64 exec, -1
s_mov_b32 m0, s19
s_nop 0
global_load_lds_dwordx4 v0, s[36:37] offset:0 sc1
global_load_lds_dwordx4 v0, s[36:37] offset:1024 sc1
global_load_lds_dwordx4 v0, s[36:37] offset:2048 sc1
global_load_lds_dwordx4 v0, s[36:37] offset:3072 sc1
v_max3_f32 v5, v128, v129, v130
v_max3_f32 v5, v5, v131, v132
v_max3_f32 v5, v5, v133, v134
v_max3_f32 v5, v5, v135, v136
v_max3_f32 v5, v5, v137, v138
v_max3_f32 v5, v5, v139, v140
v_max3_f32 v5, v5, v141, v142
v_max_f32 v5, v5, v143
s_waitcnt vmcnt(0)
ds_read_b64_tr_b16 v[112:113], v2 offset:0
ds_read_b64_tr_b16 v[114:115], v2 offset:256
ds_read_b64_tr_b16 v[116:117], v2 offset:512
ds_read_b64_tr_b16 v[118:119], v2 offset:768
ds_read_b64_tr_b16 v[120:121], v2 offset:1024
ds_read_b64_tr_b16 v[122:123], v2 offset:1280
ds_read_b64_tr_b16 v[124:125], v2 offset:1536
ds_read_b64_tr_b16 v[126:127], v2 offset:1792
v_add_u32 v2, 0x400, v7
ds_read2_b32 v[8:9], v7 offset0:0 offset1:32
ds_read2_b32 v[10:11], v7 offset0:128 offset1:160
ds_read2_b32 v[12:13], v2 offset0:0 offset1:32
ds_read2_b32 v[14:15], v2 offset0:128 offset1:160
s_waitcnt lgkmcnt(10)
v_mfma_f32_32x32x16_bf16 v[144:159], v[112:115], v[16:19], 0
v_mfma_f32_32x32x16_bf16 v[160:175], v[112:115], v[20:23], 0
s_waitcnt lgkmcnt(8)
v_mfma_f32_32x32x16_bf16 v[144:159], v[116:119], v[24:27], v[144:159]
v_mfma_f32_32x32x16_bf16 v[160:175], v[116:119], v[28:31], v[160:175]
s_waitcnt lgkmcnt(6)
v_mfma_f32_32x32x16_bf16 v[144:159], v[120:123], v[32:35], v[144:159]
v_mfma_f32_32x32x16_bf16 v[160:175], v[120:123], v[36:39], v[160:175]
s_waitcnt lgkmcnt(4)
v_mfma_f32_32x32x16_bf16 v[144:159], v[124:127], v[40:43], v[144:159]
v_mfma_f32_32x32x16_bf16 v[160:175], v[124:127], v[44:47], v[160:175]
s_nop 11
v_add_f32 v144, v144, v162
v_add_f32 v145, v145, v163
v_add_f32 v148, v148, v166
v_add_f32 v149, v149, v167
v_max3_f32 v5, v5, v144, v145
v_max3_f32 v5, v5, v148, v149
v_mov_b32 v6, v5
s_nop 1
v_permlane32_swap_b32 v5, v6
v_max_f32 v5, v5, v6
v_mul_f32 v5, s54, v5
v_fma_f32 v128, v128, s54, -v5
v_fma_f32 v129, v129, s54, -v5
v_fma_f32 v130, v130, s54, -v5
v_fma_f32 v131, v131, s54, -v5
v_fma_f32 v132, v132, s54, -v5
v_fma_f32 v133, v133, s54, -v5
v_fma_f32 v134, v134, s54, -v5
v_fma_f32 v135, v135, s54, -v5
v_fma_f32 v136, v136, s54, -v5
v_fma_f32 v137, v137, s54, -v5
v_fma_f32 v138, v138, s54, -v5
v_fma_f32 v139, v139, s54, -v5
v_fma_f32 v140, v140, s54, -v5
v_fma_f32 v141, v141, s54, -v5
v_fma_f32 v142, v142, s54, -v5
v_fma_f32 v143, v143, s54, -v5
v_fma_f32 v144, v144, s54, -v5
v_fma_f32 v145, v145, s54, -v5
v_fma_f32 v148, v148, s54, -v5
v_fma_f32 v149, v149, s54, -v5
v_exp_f32 v128, v128
v_exp_f32 v129, v129
v_exp_f32 v130, v130
v_exp_f32 v131, v131
v_exp_f32 v132, v132
v_exp_f32 v133, v133
v_exp_f32 v134, v134
v_exp_f32 v135, v135
v_exp_f32 v136, v136
v_exp_f32 v137, v137
v_exp_f32 v138, v138
v_exp_f32 v139, v139
v_exp_f32 v140, v140
v_exp_f32 v141, v141
v_exp_f32 v142, v142
v_exp_f32 v143, v143
v_exp_f32 v144, v144
v_exp_f32 v145, v145
v_exp_f32 v148, v148
v_exp_f32 v149, v149
v_add_f32 v4, v128, v129
v_add_f32 v6, v130, v131
v_add_f32 v4, v4, v132
v_add_f32 v6, v6, v133
v_add_f32 v4, v4, v134
v_add_f32 v6, v6, v135
v_add_f32 v4, v4, v136
v_add_f32 v6, v6, v137
v_add_f32 v4, v4, v138
v_add_f32 v6, v6, v139
v_add_f32 v4, v4, v140
v_add_f32 v6, v6, v141
v_add_f32 v4, v4, v142
v_add_f32 v6, v6, v143
v_add_f32 v4, v4, v144
v_add_f32 v6, v6, v145
v_add_f32 v4, v4, v148
v_add_f32 v6, v6, v149
v_add_f32 v4, v4, v6
v_mov_b32 v6, v4
s_nop 1
v_permlane32_swap_b32 v4, v6
v_add_f32 v4, v4, v6
v_rcp_f32 v4, v4
s_nop 0
v_mul_f32 v128, v128, v4
v_mul_f32 v129, v129, v4
v_mul_f32 v130, v130, v4
v_mul_f32 v131, v131, v4
v_mul_f32 v132, v132, v4
v_mul_f32 v133, v133, v4
v_mul_f32 v134, v134, v4
v_mul_f32 v135, v135, v4
v_mul_f32 v136, v136, v4
v_mul_f32 v137, v137, v4
v_mul_f32 v138, v138, v4
v_mul_f32 v139, v139, v4
v_mul_f32 v140, v140, v4
v_mul_f32 v141, v141, v4
v_mul_f32 v142, v142, v4
v_mul_f32 v143, v143, v4
v_mul_f32 v144, v144, v4
v_mul_f32 v145, v145, v4
v_mul_f32 v148, v148, v4
v_mul_f32 v149, v149, v4
v_cvt_pk_bf16_f32 v48, v128, v129
v_cvt_pk_bf16_f32 v49, v130, v131
v_cvt_pk_bf16_f32 v50, v132, v133
v_cvt_pk_bf16_f32 v51, v134, v135
v_cvt_pk_bf16_f32 v52, v136, v137
v_cvt_pk_bf16_f32 v53, v138, v139
v_cvt_pk_bf16_f32 v54, v140, v141
v_cvt_pk_bf16_f32 v55, v142, v143
v_cvt_pk_bf16_f32 v56, v144, v145
v_cvt_pk_bf16_f32 v57, v148, v149
s_waitcnt lgkmcnt(0)
s_nop 0
v_mfma_f32_32x32x8_bf16 v[176:191], v[8:9], v[56:57], 0
v_mfma_f32_32x32x16_bf16 v[176:191], v[80:83], v[48:51], v[176:191]
v_mfma_f32_32x32x16_bf16 v[176:191], v[84:87], v[52:55], v[176:191]
v_mfma_f32_32x32x8_bf16 v[192:207], v[10:11], v[56:57], 0
v_mfma_f32_32x32x16_bf16 v[192:207], v[88:91], v[48:51], v[192:207]
v_mfma_f32_32x32x16_bf16 v[192:207], v[92:95], v[52:55], v[192:207]
v_mfma_f32_32x32x8_bf16 v[208:223], v[12:13], v[56:57], 0
v_mfma_f32_32x32x16_bf16 v[208:223], v[96:99], v[48:51], v[208:223]
v_mfma_f32_32x32x16_bf16 v[208:223], v[100:103], v[52:55], v[208:223]
v_mfma_f32_32x32x8_bf16 v[224:239], v[14:15], v[56:57], 0
v_mfma_f32_32x32x16_bf16 v[224:239], v[104:107], v[48:51], v[224:239]
v_mfma_f32_32x32x16_bf16 v[224:239], v[108:111], v[52:55], v[224:239]
s_lshl_b32 s19, s9, 13
v_add_u32 v2, s19, v0
v_cvt_pk_bf16_f32 v16, v176, v177
v_cvt_pk_bf16_f32 v17, v178, v179
v_cvt_pk_bf16_f32 v18, v180, v181
v_cvt_pk_bf16_f32 v19, v182, v183
v_cvt_pk_bf16_f32 v20, v184, v185
v_cvt_pk_bf16_f32 v21, v186, v187
v_cvt_pk_bf16_f32 v22, v188, v189
v_cvt_pk_bf16_f32 v23, v190, v191
ds_write_b128 v2, v[16:19] offset:0
ds_write_b128 v2, v[20:23] offset:1024
v_cvt_pk_bf16_f32 v24, v192, v193
v_cvt_pk_bf16_f32 v25, v194, v195
v_cvt_pk_bf16_f32 v26, v196, v197
v_cvt_pk_bf16_f32 v27, v198, v199
v_cvt_pk_bf16_f32 v28, v200, v201
v_cvt_pk_bf16_f32 v29, v202, v203
v_cvt_pk_bf16_f32 v30, v204, v205
v_cvt_pk_bf16_f32 v31, v206, v207
ds_write_b128 v2, v[24:27] offset:2048
ds_write_b128 v2, v[28:31] offset:3072
v_cvt_pk_bf16_f32 v32, v208, v209
v_cvt_pk_bf16_f32 v33, v210, v211
v_cvt_pk_bf16_f32 v34, v212, v213
v_cvt_pk_bf16_f32 v35, v214, v215
v_cvt_pk_bf16_f32 v36, v216, v217
v_cvt_pk_bf16_f32 v37, v218, v219
v_cvt_pk_bf16_f32 v38, v220, v221
v_cvt_pk_bf16_f32 v39, v222, v223
ds_write_b128 v2, v[32:35] offset:4096
ds_write_b128 v2, v[36:39] offset:5120
v_cvt_pk_bf16_f32 v40, v224, v225
v_cvt_pk_bf16_f32 v41, v226, v227
v_cvt_pk_bf16_f32 v42, v228, v229
v_cvt_pk_bf16_f32 v43, v230, v231
v_cvt_pk_bf16_f32 v44, v232, v233
v_cvt_pk_bf16_f32 v45, v234, v235
v_cvt_pk_bf16_f32 v46, v236, v237
v_cvt_pk_bf16_f32 v47, v238, v239
ds_write_b128 v2, v[40:43] offset:6144
ds_write_b128 v2, v[44:47] offset:7168
s_lshl_b32 s16, s14, 18
s_lshl_b32 s17, s51, 15
s_add_u32 s17, s17, s16
s_lshl_b32 s18, s52, 14
s_add_u32 s17, s17, s18
s_lshl_b32 s18, s9, 12
s_add_u32 s17, s17, s18
s_add_u32 s17, s17, 75497472
s_add_u32 s38, s4, s17
s_addc_u32 s39, s5, 0
s_waitcnt lgkmcnt(0)
s_barrier
ds_read_b128 v[48:51], v0 offset:0
ds_read_b128 v[52:55], v0 offset:1024
ds_read_b128 v[56:59], v0 offset:2048
ds_read_b128 v[60:63], v0 offset:3072
ds_read_b128 v[64:67], v0 offset:4096
ds_read_b128 v[68:71], v0 offset:5120
ds_read_b128 v[72:75], v0 offset:6144
ds_read_b128 v[76:79], v0 offset:7168
s_waitcnt lgkmcnt(7)
v_mfma_f32_32x32x16_bf16 v[128:143], a[0:3], v[48:51], 0
v_mfma_f32_32x32x16_bf16 v[144:159], a[128:131], v[48:51], 0
ds_read_b128 v[48:51], v0 offset:8192
s_waitcnt lgkmcnt(7)
v_mfma_f32_32x32x16_bf16 v[128:143], a[4:7], v[52:55], v[128:143]
v_mfma_f32_32x32x16_bf16 v[144:159], a[132:135], v[52:55], v[144:159]
ds_read_b128 v[52:55], v0 offset:9216
s_waitcnt lgkmcnt(7)
v_mfma_f32_32x32x16_bf16 v[128:143], a[8:11], v[56:59], v[128:143]
v_mfma_f32_32x32x16_bf16 v[144:159], a[136:139], v[56:59], v[144:159]
ds_read_b128 v[56:59], v0 offset:10240
s_waitcnt lgkmcnt(7)
v_mfma_f32_32x32x16_bf16 v[128:143], a[12:15], v[60:63], v[128:143]
v_mfma_f32_32x32x16_bf16 v[144:159], a[140:143], v[60:63], v[144:159]
ds_read_b128 v[60:63], v0 offset:11264
s_waitcnt lgkmcnt(7)
v_mfma_f32_32x32x16_bf16 v[128:143], a[16:19], v[64:67], v[128:143]
v_mfma_f32_32x32x16_bf16 v[144:159], a[144:147], v[64:67], v[144:159]
ds_read_b128 v[64:67], v0 offset:12288
s_waitcnt lgkmcnt(7)
v_mfma_f32_32x32x16_bf16 v[128:143], a[20:23], v[68:71], v[128:143]
v_mfma_f32_32x32x16_bf16 v[144:159], a[148:151], v[68:71], v[144:159]
ds_read_b128 v[68:71], v0 offset:13312
s_waitcnt lgkmcnt(7)
v_mfma_f32_32x32x16_bf16 v[128:143], a[24:27], v[72:75], v[128:143]
v_mfma_f32_32x32x16_bf16 v[144:159], a[152:155], v[72:75], v[144:159]
ds_read_b128 v[72:75], v0 offset:14336
s_waitcnt lgkmcnt(7)
v_mfma_f32_32x32x16_bf16 v[128:143], a[28:31], v[76:79], v[128:143]
v_mfma_f32_32x32x16_bf16 v[144:159], a[156:159], v[76:79], v[144:159]
ds_read_b128 v[76:79], v0 offset:15360
s_waitcnt lgkmcnt(7)
v_mfma_f32_32x32x16_bf16 v[128:143], a[32:35], v[48:51], v[128:143]
v_mfma_f32_32x32x16_bf16 v[144:159], a[160:163], v[48:51], v[144:159]
ds_read_b128 v[48:51], v0 offset:16384
s_waitcnt lgkmcnt(7)
v_mfma_f32_32x32x16_bf16 v[128:143], a[36:39], v[52:55], v[128:143]
v_mfma_f32_32x32x16_bf16 v[144:159], a[164:167], v[52:55], v[144:159]
ds_read_b128 v[52:55], v0 offset:17408
s_waitcnt lgkmcnt(7)
v_mfma_f32_32x32x16_bf16 v[128:143], a[40:43], v[56:59], v[128:143]
v_mfma_f32_32x32x16_bf16 v[144:159], a[168:171], v[56:59], v[144:159]
ds_read_b128 v[56:59], v0 offset:18432
s_waitcnt lgkmcnt(7)
v_mfma_f32_32x32x16_bf16 v[128:143], a[44:47], v[60:63], v[128:143]
v_mfma_f32_32x32x16_bf16 v[144:159], a[172:175], v[60:63], v[144:159]
ds_read_b128 v[60:63], v0 offset:19456
s_waitcnt lgkmcnt(7)
v_mfma_f32_32x32x16_bf16 v[128:143], a[48:51], v[64:67], v[128:143]
v_mfma_f32_32x32x16_bf16 v[144:159], a[176:179], v[64:67], v[144:159]
ds_read_b128 v[64:67], v0 offset:20480
s_waitcnt lgkmcnt(7)
v_mfma_f32_32x32x16_bf16 v[128:143], a[52:55], v[68:71], v[128:143]
v_mfma_f32_32x32x16_bf16 v[144:159], a[180:183], v[68:71], v[144:159]
ds_read_b128 v[68:71], v0 offset:21504
s_waitcnt lgkmcnt(7)
v_mfma_f32_32x32x16_bf16 v[128:143], a[56:59], v[72:75], v[128:143]
v_mfma_f32_32x32x16_bf16 v[144:159], a[184:187], v[72:75], v[144:159]
ds_read_b128 v[72:75], v0 offset:22528
s_waitcnt lgkmcnt(7)
v_mfma_f32_32x32x16_bf16 v[128:143], a[60:63], v[76:79], v[128:143]
v_mfma_f32_32x32x16_bf16 v[144:159], a[188:191], v[76:79], v[144:159]
ds_read_b128 v[76:79], v0 offset:23552
s_waitcnt lgkmcnt(7)
v_mfma_f32_32x32x16_bf16 v[128:143], a[64:67], v[48:51], v[128:143]
v_mfma_f32_32x32x16_bf16 v[144:159], a[192:195], v[48:51], v[144:159]
ds_read_b128 v[48:51], v0 offset:24576
s_waitcnt lgkmcnt(7)
v_mfma_f32_32x32x16_bf16 v[128:143], a[68:71], v[52:55], v[128:143]
v_mfma_f32_32x32x16_bf16 v[144:159], a[196:199], v[52:55], v[144:159]
ds_read_b128 v[52:55], v0 offset:25600
s_waitcnt lgkmcnt(7)
v_mfma_f32_32x32x16_bf16 v[128:143], a[72:75], v[56:59], v[128:143]
v_mfma_f32_32x32x16_bf16 v[144:159], a[200:203], v[56:59], v[144:159]
ds_read_b128 v[56:59], v0 offset:26624
s_waitcnt lgkmcnt(7)
v_mfma_f32_32x32x16_bf16 v[128:143], a[76:79], v[60:63], v[128:143]
v_mfma_f32_32x32x16_bf16 v[144:159], a[204:207], v[60:63], v[144:159]
ds_read_b128 v[60:63], v0 offset:27648
s_waitcnt lgkmcnt(7)
v_mfma_f32_32x32x16_bf16 v[128:143], a[80:83], v[64:67], v[128:143]
v_mfma_f32_32x32x16_bf16 v[144:159], a[208:211], v[64:67], v[144:159]
ds_read_b128 v[64:67], v0 offset:28672
s_waitcnt lgkmcnt(7)
v_mfma_f32_32x32x16_bf16 v[128:143], a[84:87], v[68:71], v[128:143]
v_mfma_f32_32x32x16_bf16 v[144:159], a[212:215], v[68:71], v[144:159]
ds_read_b128 v[68:71], v0 offset:29696
s_waitcnt lgkmcnt(7)
v_mfma_f32_32x32x16_bf16 v[128:143], a[88:91], v[72:75], v[128:143]
v_mfma_f32_32x32x16_bf16 v[144:159], a[216:219], v[72:75], v[144:159]
ds_read_b128 v[72:75], v0 offset:30720
s_waitcnt lgkmcnt(7)
v_mfma_f32_32x32x16_bf16 v[128:143], a[92:95], v[76:79], v[128:143]
v_mfma_f32_32x32x16_bf16 v[144:159], a[220:223], v[76:79], v[144:159]
ds_read_b128 v[76:79], v0 offset:31744
s_waitcnt lgkmcnt(7)
v_mfma_f32_32x32x16_bf16 v[128:143], a[96:99], v[48:51], v[128:143]
v_mfma_f32_32x32x16_bf16 v[144:159], a[224:227], v[48:51], v[144:159]
s_waitcnt lgkmcnt(6)
v_mfma_f32_32x32x16_bf16 v[128:143], a[100:103], v[52:55], v[128:143]
v_mfma_f32_32x32x16_bf16 v[144:159], a[228:231], v[52:55], v[144:159]
s_waitcnt lgkmcnt(5)
v_mfma_f32_32x32x16_bf16 v[128:143], a[104:107], v[56:59], v[128:143]
v_mfma_f32_32x32x16_bf16 v[144:159], a[232:235], v[56:59], v[144:159]
s_waitcnt lgkmcnt(4)
v_mfma_f32_32x32x16_bf16 v[128:143], a[108:111], v[60:63], v[128:143]
v_mfma_f32_32x32x16_bf16 v[144:159], a[236:239], v[60:63], v[144:159]
s_waitcnt lgkmcnt(3)
v_mfma_f32_32x32x16_bf16 v[128:143], a[112:115], v[64:67], v[128:143]
v_mfma_f32_32x32x16_bf16 v[144:159], a[240:243], v[64:67], v[144:159]
s_waitcnt lgkmcnt(2)
v_mfma_f32_32x32x16_bf16 v[128:143], a[116:119], v[68:71], v[128:143]
v_mfma_f32_32x32x16_bf16 v[144:159], a[244:247], v[68:71], v[144:159]
s_waitcnt lgkmcnt(1)
v_mfma_f32_32x32x16_bf16 v[128:143], a[120:123], v[72:75], v[128:143]
v_mfma_f32_32x32x16_bf16 v[144:159], a[248:251], v[72:75], v[144:159]
s_waitcnt lgkmcnt(0)
v_mfma_f32_32x32x16_bf16 v[128:143], a[124:127], v[76:79], v[128:143]
v_mfma_f32_32x32x16_bf16 v[144:159], a[252:255], v[76:79], v[144:159]
s_nop 3
v_cvt_pk_bf16_f32 v16, v128, v129
v_cvt_pk_bf16_f32 v17, v130, v131
v_cvt_pk_bf16_f32 v18, v132, v133
v_cvt_pk_bf16_f32 v19, v134, v135
v_cvt_pk_bf16_f32 v20, v136, v137
v_cvt_pk_bf16_f32 v21, v138, v139
v_cvt_pk_bf16_f32 v22, v140, v141
v_cvt_pk_bf16_f32 v23, v142, v143
global_store_dwordx4 v0, v[16:19], s[38:39] offset:0 sc1
global_store_dwordx4 v0, v[20:23], s[38:39] offset:1024 sc1
v_cvt_pk_bf16_f32 v24, v144, v145
v_cvt_pk_bf16_f32 v25, v146, v147
v_cvt_pk_bf16_f32 v26, v148, v149
v_cvt_pk_bf16_f32 v27, v150, v151
v_cvt_pk_bf16_f32 v28, v152, v153
v_cvt_pk_bf16_f32 v29, v154, v155
v_cvt_pk_bf16_f32 v30, v156, v157
v_cvt_pk_bf16_f32 v31, v158, v159
global_store_dwordx4 v0, v[24:27], s[38:39] offset:2048 sc1
global_store_dwordx4 v0, v[28:31], s[38:39] offset:3072 sc1
s_waitcnt vmcnt(0)
s_barrier
s_cmp_ge_u32 s9, 2
s_cbranch_scc1 L_r2s_44
s_lshl_b32 s20, s14, 9
s_add_u32 s20, s20, 1114112
s_cmp_lg_u32 s9, 0
s_cbranch_scc1 L_r2n_45
s_and_b32 s18, s53, 3
s_lshl_b32 s18, s18, 2
s_lshr_b32 s17, s53, 2
s_lshl_b32 s17, s17, 7
s_add_u32 s17, s17, s18
s_add_u32 s17, s17, s20
v_mov_b32 v2, s17
v_mov_b32 v3, 1
s_mov_b64 exec, 1
global_store_dword v2, v3, s[4:5] sc1
s_mov_b64 exec, -1
L_r2n_45:
s_lshl_b32 s21, s53, 1
s_add_u32 s21, s21, s9
s_lshl_b32 s17, s21, 10
s_lshl_b32 s18, s14, 15
s_add_u32 s18, s18, s17
s_add_u32 s19, s18, 4194304
s_add_u32 s40, s4, s19
s_addc_u32 s41, s5, 0
global_load_dwordx4 v[48:51], v0, s[40:41] sc1
s_add_u32 s17, s17, s16
s_add_u32 s17, s17, 75497472
s_add_u32 s38, s4, s17
s_addc_u32 s39, s5, 0
s_lshl_b32 s17, s52, 8
s_add_u32 s17, s17, s20
v_lshlrev_b32 v4, 7, v1
v_add_u32 v4, s17, v4
s_mov_b32 s10, 0
s_mov_b64 exec, 3
L_wt_46:
global_load_dwordx4 v[8:11], v4, s[4:5] offset:0 sc1
s_add_u32 s10, s10, 1
s_cmp_gt_u32 s10, 400000
s_cbranch_scc1 L_fail
s_waitcnt vmcnt(0)
v_min3_u32 v8, v8, v9, v10
v_min_u32 v8, v8, v11
v_cmp_gt_u32 vcc, 1, v8
s_cbranch_vccnz L_wt_46
s_mov_b64 exec, -1
v_mov_b32 v2, v0
global_load_dwordx4 v[16:19], v2, s[38:39] sc1
v_add_u32 v2, 0x8000, v2
global_load_dwordx4 v[20:23], v2, s[38:39] sc1
v_add_u32 v2, 0x8000, v2
global_load_dwordx4 v[24:27], v2, s[38:39] sc1
v_add_u32 v2, 0x8000, v2
global_load_dwordx4 v[28:31], v2, s[38:39] sc1
v_add_u32 v2, 0x8000, v2
global_load_dwordx4 v[32:35], v2, s[38:39] sc1
v_add_u32 v2, 0x8000, v2
global_load_dwordx4 v[36:39], v2, s[38:39] sc1
v_add_u32 v2, 0x8000, v2
global_load_dwordx4 v[40:43], v2, s[38:39] sc1
v_add_u32 v2, 0x8000, v2
global_load_dwordx4 v[44:47], v2, s[38:39] sc1
s_mov_b32 s19, 0xffff0000
s_load_dwordx2 s[40:41], s[0:1], 80
s_add_u32 s18, s18, 136314880
s_lshl_b32 s17, s14, 15
s_lshl_b32 s22, s21, 5
s_add_u32 s17, s17, s22
v_and_b32 v3, 31, v1
v_lshlrev_b32 v3, 10, v3
v_lshrrev_b32 v4, 5, v1
v_lshl_add_u32 v3, v4, 4, v3
s_cmp_eq_u32 s11, 0
s_cselect_b64 vcc, -1, 0
s_cselect_b32 s18, s18, s17
s_waitcnt lgkmcnt(0)
s_cselect_b64 s[40:41], s[4:5], s[40:41]
s_add_u32 s40, s40, s18
s_addc_u32 s41, s41, 0
v_cndmask_b32 v3, v3, v0, vcc
s_waitcnt vmcnt(7)
v_lshlrev_b32 v64, 16, v16
v_and_b32 v65, s19, v16
v_lshlrev_b32 v66, 16, v17
v_and_b32 v67, s19, v17
v_lshlrev_b32 v68, 16, v18
v_and_b32 v69, s19, v18
v_lshlrev_b32 v70, 16, v19
v_and_b32 v71, s19, v19
s_waitcnt vmcnt(6)
v_lshlrev_b32 v72, 16, v20
v_and_b32 v73, s19, v20
v_lshlrev_b32 v74, 16, v21
v_and_b32 v75, s19, v21
v_lshlrev_b32 v76, 16, v22
v_and_b32 v77, s19, v22
v_lshlrev_b32 v78, 16, v23
v_and_b32 v79, s19, v23
v_pk_add_f32 v[64:65], v[64:65], v[72:73]
v_pk_add_f32 v[66:67], v[66:67], v[74:75]
v_pk_add_f32 v[68:69], v[68:69], v[76:77]
v_pk_add_f32 v[70:71], v[70:71], v[78:79]
s_waitcnt vmcnt(5)
v_lshlrev_b32 v72, 16, v24
v_and_b32 v73, s19, v24
v_lshlrev_b32 v74, 16, v25
v_and_b32 v75, s19, v25
v_lshlrev_b32 v76, 16, v26
v_and_b32 v77, s19, v26
v_lshlrev_b32 v78, 16, v27
v_and_b32 v79, s19, v27
v_pk_add_f32 v[64:65], v[64:65], v[72:73]
v_pk_add_f32 v[66:67], v[66:67], v[74:75]
v_pk_add_f32 v[68:69], v[68:69], v[76:77]
v_pk_add_f32 v[70:71], v[70:71], v[78:79]
s_waitcnt vmcnt(4)
v_lshlrev_b32 v72, 16, v28
v_and_b32 v73, s19, v28
v_lshlrev_b32 v74, 16, v29
v_and_b32 v75, s19, v29
v_lshlrev_b32 v76, 16, v30
v_and_b32 v77, s19, v30
v_lshlrev_b32 v78, 16, v31
v_and_b32 v79, s19, v31
v_pk_add_f32 v[64:65], v[64:65], v[72:73]
v_pk_add_f32 v[66:67], v[66:67], v[74:75]
v_pk_add_f32 v[68:69], v[68:69], v[76:77]
v_pk_add_f32 v[70:71], v[70:71], v[78:79]
s_waitcnt vmcnt(3)
v_lshlrev_b32 v72, 16, v32
v_and_b32 v73, s19, v32
v_lshlrev_b32 v74, 16, v33
v_and_b32 v75, s19, v33
v_lshlrev_b32 v76, 16, v34
v_and_b32 v77, s19, v34
v_lshlrev_b32 v78, 16, v35
v_and_b32 v79, s19, v35
v_pk_add_f32 v[64:65], v[64:65], v[72:73]
v_pk_add_f32 v[66:67], v[66:67], v[74:75]
v_pk_add_f32 v[68:69], v[68:69], v[76:77]
v_pk_add_f32 v[70:71], v[70:71], v[78:79]
s_waitcnt vmcnt(2)
v_lshlrev_b32 v72, 16, v36
v_and_b32 v73, s19, v36
v_lshlrev_b32 v74, 16, v37
v_and_b32 v75, s19, v37
v_lshlrev_b32 v76, 16, v38
v_and_b32 v77, s19, v38
v_lshlrev_b32 v78, 16, v39
v_and_b32 v79, s19, v39
v_pk_add_f32 v[64:65], v[64:65], v[72:73]
v_pk_add_f32 v[66:67], v[66:67], v[74:75]
v_pk_add_f32 v[68:69], v[68:69], v[76:77]
v_pk_add_f32 v[70:71], v[70:71], v[78:79]
s_waitcnt vmcnt(1)
v_lshlrev_b32 v72, 16, v40
v_and_b32 v73, s19, v40
v_lshlrev_b32 v74, 16, v41
v_and_b32 v75, s19, v41
v_lshlrev_b32 v76, 16, v42
v_and_b32 v77, s19, v42
v_lshlrev_b32 v78, 16, v43
v_and_b32 v79, s19, v43
v_pk_add_f32 v[64:65], v[64:65], v[72:73]
v_pk_add_f32 v[66:67], v[66:67], v[74:75]
v_pk_add_f32 v[68:69], v[68:69], v[76:77]
v_pk_add_f32 v[70:71], v[70:71], v[78:79]
s_waitcnt vmcnt(0)
v_lshlrev_b32 v72, 16, v44
v_and_b32 v73, s19, v44
v_lshlrev_b32 v74, 16, v45
v_and_b32 v75, s19, v45
v_lshlrev_b32 v76, 16, v46
v_and_b32 v77, s19, v46
v_lshlrev_b32 v78, 16, v47
v_and_b32 v79, s19, v47
v_pk_add_f32 v[64:65], v[64:65], v[72:73]
v_pk_add_f32 v[66:67], v[66:67], v[74:75]
v_pk_add_f32 v[68:69], v[68:69], v[76:77]
v_pk_add_f32 v[70:71], v[70:71], v[78:79]
v_cvt_pk_bf16_f32 v16, v64, v65
v_cvt_pk_bf16_f32 v17, v66, v67
v_cvt_pk_bf16_f32 v18, v68, v69
v_cvt_pk_bf16_f32 v19, v70, v71
v_lshlrev_b32 v64, 16, v16
v_and_b32 v65, s19, v16
v_lshlrev_b32 v72, 16, v48
v_and_b32 v73, s19, v48
v_lshlrev_b32 v66, 16, v17
v_and_b32 v67, s19, v17
v_lshlrev_b32 v74, 16, v49
v_and_b32 v75, s19, v49
v_lshlrev_b32 v68, 16, v18
v_and_b32 v69, s19, v18
v_lshlrev_b32 v76, 16, v50
v_and_b32 v77, s19, v50
v_lshlrev_b32 v70, 16, v19
v_and_b32 v71, s19, v19
v_lshlrev_b32 v78, 16, v51
v_and_b32 v79, s19, v51
v_pk_add_f32 v[64:65], v[64:65], v[72:73]
v_pk_add_f32 v[66:67], v[66:67], v[74:75]
v_pk_add_f32 v[68:69], v[68:69], v[76:77]
v_pk_add_f32 v[70:71], v[70:71], v[78:79]
v_cvt_pk_bf16_f32 v16, v64, v65
v_cvt_pk_bf16_f32 v17, v66, v67
v_cvt_pk_bf16_f32 v18, v68, v69
v_cvt_pk_bf16_f32 v19, v70, v71
s_cmp_eq_u32 s11, 0
s_cbranch_scc0 L_r2o_47
global_store_dwordx4 v3, v[16:19], s[40:41] sc1
s_and_b32 s18, s21, 3
s_lshl_b32 s18, s18, 2
s_lshr_b32 s17, s21, 2
s_lshl_b32 s17, s17, 7
s_add_u32 s17, s17, s18
s_add_u32 s17, s17, 135397376
s_lshl_b32 s18, s14, 10
s_add_u32 s17, s17, s18
s_waitcnt vmcnt(0)
v_mov_b32 v2, s17
v_mov_b32 v3, 1
s_mov_b64 exec, 1
global_store_dword v2, v3, s[4:5] sc1
s_mov_b64 exec, -1
s_branch L_r2s_44
L_r2o_47:
global_store_dwordx4 v3, v[16:19], s[40:41]
L_r2s_44:
s_add_u32 s14, s14, 13
s_cmp_lt_u32 s14, 64
s_cbranch_scc1 L_t5_38
s_barrier
L_nl:
s_add_u32 s4, s4, 134217728
s_addc_u32 s5, s5, 0
s_add_u32 s11, s11, 1
s_cmp_ge_u32 s11, 2
s_cbranch_scc1 L_wd
s_cmp_lt_u32 s8, 208
s_cbranch_scc1 L_layer
s_bfe_u32 s14, s8, 0x20002
s_mov_b32 s62, 4
s_branch L_t1
L_wd:
s_add_u32 s8, s8, 32
L_done:
s_branch L_end
L_fail:
s_mov_b64 exec, 1
v_mov_b32 v2, 0
v_mov_b32 v3, 1
global_atomic_add v2, v3, s[6:7] offset:192
L_end:

s_endpgm
.section .rodata,"a"
.p2align 6
.amdhsa_kernel interleave_layers__spectral_gfnet__memory_aug_recurrent_mem_tr__prompt_kernel
  .amdhsa_next_free_vgpr 512
  .amdhsa_next_free_sgpr 102
  .amdhsa_accum_offset 256
  .amdhsa_group_segment_fixed_size 0
  .amdhsa_kernarg_size 104
  .amdhsa_user_sgpr_count 2
  .amdhsa_user_sgpr_kernarg_segment_ptr 1
  .amdhsa_system_sgpr_workgroup_id_x 1
  .amdhsa_float_denorm_mode_32 3
.end_amdhsa_kernel
.text
```
